```python
import torch

def _softmax(x, axis=-1):
    return torch.softmax(x, dim=axis)
def _gelu(x):
    return torch.nn.functional.gelu(x, approximate="tanh")
def _silu(x):
    return torch.nn.functional.silu(x)
def _sigmoid(x):
    return torch.sigmoid(x)
def _layernorm(x, axis=-1, eps=1e-5):
    m = x.mean(dim=axis, keepdim=True)
    v = x.var(dim=axis, keepdim=True, unbiased=False)
    return (x - m) / torch.sqrt(v + eps)
def _scatter_add(tgt, idx, src, axis=0):
    return tgt.clone().index_add_(axis, idx, src)
def _segment_sum(src, seg, n):
    out = torch.zeros((n,) + src.shape[1:], dtype=src.dtype)
    return out.index_add_(0, seg, src)
def _pad(x, pw):
    flat = tuple(v for pair in reversed(pw) for v in pair)
    return torch.nn.functional.pad(x, flat)

kernel_name = 'parallel_sum__softmax_full_mha__glu_gated_swiglu__prompt'

def setup_inputs():

    _w = (lambda a: (lambda t: t.to(torch.bfloat16) if t.is_floating_point() else t)(torch.as_tensor(a)))
    def _A_setup():
        B, S, D = 1, 2048, 640
        return {
            "x": _w((lambda *s: torch.randn(*s, dtype=torch.bfloat16) * 0.05)(B, S, D)),
            "wqkv": _w((lambda *s: torch.randn(*s, dtype=torch.bfloat16) * 0.05)(D, 3 * D)),
            "wo": _w((lambda *s: torch.randn(*s, dtype=torch.bfloat16) * 0.05)(D, D)),
        }
    _A_in = _A_setup()

    def _B_setup():
        B, S, D, F = 1, 2048, 640, 1536
        return {
            "x": _w((lambda *s: torch.randn(*s, dtype=torch.bfloat16) * 0.05)(B, S, D)),
            "w1": _w((lambda *s: torch.randn(*s, dtype=torch.bfloat16) * 0.4)(D, F) * (2.0 / D) ** 0.5),
            "w3": _w((lambda *s: torch.randn(*s, dtype=torch.bfloat16) * 0.4)(D, F) * (2.0 / D) ** 0.5),
            "w2": _w((lambda *s: torch.randn(*s, dtype=torch.bfloat16) * 0.4)(F, D) * (2.0 / F) ** 0.5),
        }
    _B_in = _B_setup()

    return {
        "A_x": _A_in["x"],
        "A_wqkv": _A_in["wqkv"],
        "A_wo": _A_in["wo"],
        "B_x": _B_in["x"],
        "B_w1": _B_in["w1"],
        "B_w3": _B_in["w3"],
        "B_w2": _B_in["w2"],
    }

def reference(A_x, A_wqkv, A_wo, B_x, B_w1, B_w3, B_w2):
    def _A_ref(x, wqkv, wo):
        B, S, D = x.shape
        H = 32; Dh = D // H
        qkv = (lambda x, *d: x.permute(*d))((x @ wqkv).reshape(B, S, 3, H, Dh), 2, 0, 3, 1, 4)
        q, k, v = qkv[0], qkv[1], qkv[2]
        scale = Dh ** -0.5
        scores = torch.einsum("bhqd,bhkd->bhqk", q, k) * scale
        p = _softmax(scores, axis=-1)
        o = torch.einsum("bhqk,bhkd->bhqd", p, v)
        return (lambda x, *d: x.permute(*d))(o, 0, 2, 1, 3).reshape(B, S, D) @ wo

    def _B_ref(x, w1, w3, w2):
        gate = torch.einsum("bsd,df->bsf", x, w1)
        up = torch.einsum("bsd,df->bsf", x, w3)
        h = _silu(gate) * up
        out = torch.einsum("bsf,fd->bsd", h, w2)
        return out

    x = A_x
    xn = _layernorm(x, axis=-1)
    return x + _A_ref(xn, A_wqkv, A_wo) + _B_ref(xn, B_w1, B_w3, B_w2)
```

```asm
; @launch grid=(512,1,1) block=(512,1,1) lds=81920
.amdgcn_target "amdgcn-amd-amdhsa--gfx950"
.text
.globl parallel_sum__softmax_full_mha__glu_gated_swiglu__prompt_kernel
.p2align 8
.type parallel_sum__softmax_full_mha__glu_gated_swiglu__prompt_kernel,@function
parallel_sum__softmax_full_mha__glu_gated_swiglu__prompt_kernel:
    s_load_dwordx16 s[48:63], s[0:1], 0
    s_load_dwordx4 s[64:67], s[0:1], 64
    v_lshrrev_b32 v1, 6, v0
    s_and_b32 s5, s2, 255
    v_readfirstlane_b32 s4, v1
    v_and_b32 v1, 63, v0
    v_lshlrev_b32 v2, 4, v1
    s_mov_b32 s6, 0
    s_setprio 3
    s_or_b32 s7, s2, s4
    s_cmp_lg_u32 s7, 0
    s_cbranch_scc1 L_notag
    s_memrealtime s[76:77]
    v_mov_b32 v3, 0
    s_mov_b32 s74, 256
    s_mov_b32 s75, 0x00020000
    s_waitcnt lgkmcnt(0)
    s_mov_b32 s72, s64
    s_mov_b32 s73, s65
    s_or_b32 s76, s76, 1
    v_mov_b32 v4, s76
    v_mov_b32 v5, s77
    s_mov_b64 exec, 1
    buffer_store_dwordx2 v[4:5], v3, s[72:75], 0 offen sc1
    s_mov_b64 exec, -1
L_notag:
    s_cmp_ge_u32 s2, 512
    s_cbranch_scc1 L_end
    s_cmp_lt_u32 s2, 256
    s_cbranch_scc1 L_roleF
    s_and_b32 s34, s5, 7
    s_lshr_b32 s35, s5, 3
    s_and_b32 s36, s34, 1
    s_lshl_b32 s36, s36, 3
    s_and_b32 s37, s35, 7
    s_add_u32 s32, s36, s37
    s_lshr_b32 s36, s34, 1
    s_lshl_b32 s36, s36, 2
    s_lshr_b32 s37, s35, 3
    s_add_u32 s33, s36, s37
    s_cmp_ge_u32 s33, 15
    s_cbranch_scc1 L_skipA1
    s_cmp_lt_u32 s4, 4
    s_cbranch_scc1 L_a1c
    s_and_b32 s36, s4, 3
    s_lshr_b32 s37, s36, 1
    s_lshl_b32 s37, s37, 6
    s_and_b32 s38, s36, 1
    s_add_u32 s37, s37, s38
    s_lshl_b32 s38, s36, 5
    s_cmp_lt_u32 s33, 10
    s_cselect_b32 s37, s37, s38
    s_mov_b32 s38, 1280
    s_cselect_b32 s38, 2560, s38
    s_lshl_b32 s39, s32, 7
    s_add_u32 s37, s37, s39
    s_mul_i32 s37, s37, 1280
    v_lshrrev_b32 v3, 3, v1
    v_lshrrev_b32 v10, 4, v1
    v_and_b32 v11, 7, v1
    v_mul_u32_u24 v12, s38, v3
    v_xor_b32 v13, v10, v11
    v_lshl_add_u32 v12, v13, 4, v12
    v_add_u32 v4, s37, v12
    s_lshl_b32 s39, s38, 3
    v_xor_b32 v5, 64, v4
    v_add_u32 v5, s39, v5
    s_lshl_b32 s39, s38, 4
    v_add_u32 v6, s39, v4
    v_add_u32 v7, s39, v5
    v_lshlrev_b32 v12, 2, v10
    v_and_b32 v13, 15, v1
    v_xor_b32 v13, v13, v12
    s_lshl_b32 s39, s36, 3
    v_add_u32 v12, s39, v10
    v_mul_u32_u24 v14, 3840, v12
    v_lshl_add_u32 v14, v13, 4, v14
    s_lshl_b32 s39, s33, 8
    v_add_u32 v8, s39, v14
    v_add_u32 v9, 15360, v8
    s_mul_i32 s40, s33, 3
    s_add_u32 s40, s40, s32
    s_cmp_ge_u32 s40, 40
    s_cselect_b32 s43, 40, 0
    s_sub_u32 s40, s40, s43
    s_cmp_ge_u32 s40, 20
    s_cselect_b32 s43, 20, 0
    s_sub_u32 s40, s40, s43
    s_cmp_ge_u32 s40, 10
    s_cselect_b32 s43, 10, 0
    s_sub_u32 s40, s40, s43
    s_mul_i32 s44, s40, 245760
    s_lshl_b32 s45, s40, 7
    s_lshl_b32 s42, s36, 12
    s_lshl_b32 s43, s36, 11
    s_add_u32 s43, s43, 49152
    s_waitcnt lgkmcnt(0)
    s_mov_b32 s12, s48
    s_mov_b32 s13, s49
    s_mov_b32 s14, 2621440
    s_mov_b32 s15, 0x00020000
    s_mov_b32 s8, s50
    s_mov_b32 s9, s51
    s_mov_b32 s10, 2457600
    s_mov_b32 s11, 0x00020000
    s_add_u32 m0, s42, 0
    s_nop 0
    buffer_load_dwordx4 v4, s[12:15], s45 offen lds
    s_add_u32 m0, s42, 1024
    s_nop 0
    buffer_load_dwordx4 v5, s[12:15], s45 offen lds
    s_add_u32 m0, s42, 2048
    s_nop 0
    buffer_load_dwordx4 v6, s[12:15], s45 offen lds
    s_add_u32 m0, s42, 3072
    s_nop 0
    buffer_load_dwordx4 v7, s[12:15], s45 offen lds
    s_add_u32 s45, s45, 128
    s_cmp_eq_u32 s45, 1280
    s_cselect_b32 s45, 0, s45
    s_add_u32 m0, s43, 0
    s_nop 0
    buffer_load_dwordx4 v8, s[8:11], s44 offen lds
    s_add_u32 m0, s43, 1024
    s_nop 0
    buffer_load_dwordx4 v9, s[8:11], s44 offen lds
    s_add_u32 s44, s44, 122880
    s_cmp_eq_u32 s44, 2457600
    s_cselect_b32 s44, 0, s44
    s_add_u32 m0, s43, 8192
    s_nop 0
    buffer_load_dwordx4 v8, s[8:11], s44 offen lds
    s_add_u32 m0, s43, 9216
    s_nop 0
    buffer_load_dwordx4 v9, s[8:11], s44 offen lds
    s_add_u32 s44, s44, 122880
    s_cmp_eq_u32 s44, 2457600
    s_cselect_b32 s44, 0, s44
    s_add_u32 s28, s66, 19693568
    s_addc_u32 s29, s67, 0
    s_mov_b32 s30, 196608
    s_mov_b32 s31, 0x00020000
    s_add_u32 s16, s66, 19398656
    s_addc_u32 s17, s67, 0
    s_mov_b32 s18, 278528
    s_mov_b32 s19, 0x00020000
    s_mov_b32 s72, s64
    s_mov_b32 s73, s65
    s_mov_b32 s74, 256
    s_mov_b32 s75, 0x00020000
    v_mov_b32 v44, 0
    v_and_b32 v41, 31, v1
    v_lshlrev_b32 v40, 4, v41
    s_lshl_b32 s46, s36, 5
    v_add_lshl_u32 v41, v41, s46, 2
    s_lshl_b32 s46, s32, 2
    s_add_u32 s46, s46, s36
    s_lshl_b32 s46, s46, 9
    s_lshl_b32 s47, s33, 14
    s_lshl_b32 s68, s36, 8
    s_add_u32 s47, s47, s68
    s_add_u32 s47, s47, 32768
    v_and_b32 v45, 15, v1
    v_lshlrev_b32 v46, 4, v45
    v_lshl_add_u32 v46, v10, 12, v46
    s_lshl_b32 s68, s36, 7
    v_lshl_add_u32 v45, v45, 3, s68
    s_waitcnt vmcnt(4)
    s_waitcnt vmcnt(2)
    s_barrier
    s_add_u32 m0, s42, 16384
    s_nop 0
    buffer_load_dwordx4 v4, s[12:15], s45 offen lds
    s_add_u32 m0, s42, 17408
    s_nop 0
    buffer_load_dwordx4 v5, s[12:15], s45 offen lds
    s_add_u32 m0, s42, 18432
    s_nop 0
    buffer_load_dwordx4 v6, s[12:15], s45 offen lds
    s_add_u32 m0, s42, 19456
    s_nop 0
    buffer_load_dwordx4 v7, s[12:15], s45 offen lds
    s_add_u32 s45, s45, 128
    s_cmp_eq_u32 s45, 1280
    s_cselect_b32 s45, 0, s45
    s_add_u32 m0, s43, 16384
    s_nop 0
    buffer_load_dwordx4 v8, s[8:11], s44 offen lds
    s_add_u32 m0, s43, 17408
    s_nop 0
    buffer_load_dwordx4 v9, s[8:11], s44 offen lds
    s_add_u32 s44, s44, 122880
    s_cmp_eq_u32 s44, 2457600
    s_cselect_b32 s44, 0, s44
    s_waitcnt vmcnt(6)
    s_barrier
    s_add_u32 m0, s43, 24576
    s_nop 0
    buffer_load_dwordx4 v8, s[8:11], s44 offen lds
    s_add_u32 m0, s43, 25600
    s_nop 0
    buffer_load_dwordx4 v9, s[8:11], s44 offen lds
    s_add_u32 s44, s44, 122880
    s_cmp_eq_u32 s44, 2457600
    s_cselect_b32 s44, 0, s44
    s_add_u32 m0, s42, 32768
    s_nop 0
    buffer_load_dwordx4 v4, s[12:15], s45 offen lds
    s_add_u32 m0, s42, 33792
    s_nop 0
    buffer_load_dwordx4 v5, s[12:15], s45 offen lds
    s_add_u32 m0, s42, 34816
    s_nop 0
    buffer_load_dwordx4 v6, s[12:15], s45 offen lds
    s_add_u32 m0, s42, 35840
    s_nop 0
    buffer_load_dwordx4 v7, s[12:15], s45 offen lds
    s_add_u32 s45, s45, 128
    s_cmp_eq_u32 s45, 1280
    s_cselect_b32 s45, 0, s45
    s_add_u32 m0, s43, 0
    s_nop 0
    buffer_load_dwordx4 v8, s[8:11], s44 offen lds
    s_add_u32 m0, s43, 1024
    s_nop 0
    buffer_load_dwordx4 v9, s[8:11], s44 offen lds
    s_add_u32 s44, s44, 122880
    s_cmp_eq_u32 s44, 2457600
    s_cselect_b32 s44, 0, s44
    s_waitcnt vmcnt(10)
    s_waitcnt vmcnt(8)
    s_barrier
    s_add_u32 m0, s43, 8192
    s_nop 0
    buffer_load_dwordx4 v8, s[8:11], s44 offen lds
    s_add_u32 m0, s43, 9216
    s_nop 0
    buffer_load_dwordx4 v9, s[8:11], s44 offen lds
    s_add_u32 s44, s44, 122880
    s_cmp_eq_u32 s44, 2457600
    s_cselect_b32 s44, 0, s44
    s_add_u32 m0, s42, 0
    s_nop 0
    buffer_load_dwordx4 v4, s[12:15], s45 offen lds
    s_add_u32 m0, s42, 1024
    s_nop 0
    buffer_load_dwordx4 v5, s[12:15], s45 offen lds
    buffer_load_dwordx2 v[42:43], v44, s[72:75], 0 offen sc1
    s_waitcnt vmcnt(11)
    s_barrier
    s_add_u32 m0, s43, 16384
    s_nop 0
    buffer_load_dwordx4 v8, s[8:11], s44 offen lds
    s_add_u32 m0, s43, 17408
    s_nop 0
    buffer_load_dwordx4 v9, s[8:11], s44 offen lds
    s_add_u32 s44, s44, 122880
    s_cmp_eq_u32 s44, 2457600
    s_cselect_b32 s44, 0, s44
    s_add_u32 m0, s42, 2048
    s_nop 0
    buffer_load_dwordx4 v6, s[12:15], s45 offen lds
    s_add_u32 m0, s42, 3072
    s_nop 0
    buffer_load_dwordx4 v7, s[12:15], s45 offen lds
    s_add_u32 s45, s45, 128
    s_cmp_eq_u32 s45, 1280
    s_cselect_b32 s45, 0, s45
    s_waitcnt vmcnt(11)
    s_waitcnt vmcnt(9)
    s_barrier
    s_add_u32 m0, s43, 24576
    s_nop 0
    buffer_load_dwordx4 v8, s[8:11], s44 offen lds
    s_add_u32 m0, s43, 25600
    s_nop 0
    buffer_load_dwordx4 v9, s[8:11], s44 offen lds
    s_add_u32 s44, s44, 122880
    s_cmp_eq_u32 s44, 2457600
    s_cselect_b32 s44, 0, s44
    s_add_u32 m0, s42, 16384
    s_nop 0
    buffer_load_dwordx4 v4, s[12:15], s45 offen lds
    s_add_u32 m0, s42, 17408
    s_nop 0
    buffer_load_dwordx4 v5, s[12:15], s45 offen lds
    s_waitcnt vmcnt(11)
    s_barrier
    s_add_u32 m0, s43, 0
    s_nop 0
    buffer_load_dwordx4 v8, s[8:11], s44 offen lds
    s_add_u32 m0, s43, 1024
    s_nop 0
    buffer_load_dwordx4 v9, s[8:11], s44 offen lds
    s_add_u32 s44, s44, 122880
    s_cmp_eq_u32 s44, 2457600
    s_cselect_b32 s44, 0, s44
    s_add_u32 m0, s42, 18432
    s_nop 0
    buffer_load_dwordx4 v6, s[12:15], s45 offen lds
    s_add_u32 m0, s42, 19456
    s_nop 0
    buffer_load_dwordx4 v7, s[12:15], s45 offen lds
    s_add_u32 s45, s45, 128
    s_cmp_eq_u32 s45, 1280
    s_cselect_b32 s45, 0, s45
    s_waitcnt vmcnt(8)
    s_barrier
    s_add_u32 m0, s43, 8192
    s_nop 0
    buffer_load_dwordx4 v8, s[8:11], s44 offen lds
    s_add_u32 m0, s43, 9216
    s_nop 0
    buffer_load_dwordx4 v9, s[8:11], s44 offen lds
    s_add_u32 s44, s44, 122880
    s_cmp_eq_u32 s44, 2457600
    s_cselect_b32 s44, 0, s44
    s_add_u32 m0, s42, 32768
    s_nop 0
    buffer_load_dwordx4 v4, s[12:15], s45 offen lds
    s_add_u32 m0, s42, 33792
    s_nop 0
    buffer_load_dwordx4 v5, s[12:15], s45 offen lds
    s_mov_b32 s79, 100000
    s_branch L_tgm_2_para
L_tg_1_para:
    buffer_load_dwordx2 v[42:43], v44, s[72:75], 0 offen sc1
    s_waitcnt vmcnt(0)
L_tgm_2_para:
    v_readfirstlane_b32 s6, v42
    v_readfirstlane_b32 s7, v43
    s_nop 1
    s_cmp_lg_u32 s6, 0
    s_cbranch_scc1 L_tgd_3_para
    s_sleep 2
    s_sub_u32 s79, s79, 1
    s_cmp_lg_u32 s79, 0
    s_cbranch_scc1 L_tg_1_para
L_tgd_3_para:
    s_waitcnt vmcnt(10)
    s_barrier
    s_add_u32 m0, s43, 16384
    s_nop 0
    buffer_load_dwordx4 v8, s[8:11], s44 offen lds
    s_add_u32 m0, s43, 17408
    s_nop 0
    buffer_load_dwordx4 v9, s[8:11], s44 offen lds
    s_add_u32 s44, s44, 122880
    s_cmp_eq_u32 s44, 2457600
    s_cselect_b32 s44, 0, s44
    s_add_u32 m0, s42, 34816
    s_nop 0
    buffer_load_dwordx4 v6, s[12:15], s45 offen lds
    s_add_u32 m0, s42, 35840
    s_nop 0
    buffer_load_dwordx4 v7, s[12:15], s45 offen lds
    s_add_u32 s45, s45, 128
    s_cmp_eq_u32 s45, 1280
    s_cselect_b32 s45, 0, s45
    s_waitcnt vmcnt(8)
    s_barrier
    s_add_u32 m0, s43, 24576
    s_nop 0
    buffer_load_dwordx4 v8, s[8:11], s44 offen lds
    s_add_u32 m0, s43, 25600
    s_nop 0
    buffer_load_dwordx4 v9, s[8:11], s44 offen lds
    s_add_u32 s44, s44, 122880
    s_cmp_eq_u32 s44, 2457600
    s_cselect_b32 s44, 0, s44
    s_add_u32 m0, s42, 0
    s_nop 0
    buffer_load_dwordx4 v4, s[12:15], s45 offen lds
    s_add_u32 m0, s42, 1024
    s_nop 0
    buffer_load_dwordx4 v5, s[12:15], s45 offen lds
    s_waitcnt vmcnt(10)
    s_barrier
    s_add_u32 m0, s43, 0
    s_nop 0
    buffer_load_dwordx4 v8, s[8:11], s44 offen lds
    s_add_u32 m0, s43, 1024
    s_nop 0
    buffer_load_dwordx4 v9, s[8:11], s44 offen lds
    s_add_u32 s44, s44, 122880
    s_cmp_eq_u32 s44, 2457600
    s_cselect_b32 s44, 0, s44
    s_add_u32 m0, s42, 2048
    s_nop 0
    buffer_load_dwordx4 v6, s[12:15], s45 offen lds
    s_add_u32 m0, s42, 3072
    s_nop 0
    buffer_load_dwordx4 v7, s[12:15], s45 offen lds
    s_add_u32 s45, s45, 128
    s_cmp_eq_u32 s45, 1280
    s_cselect_b32 s45, 0, s45
    s_waitcnt vmcnt(8)
    s_barrier
    s_add_u32 m0, s43, 8192
    s_nop 0
    buffer_load_dwordx4 v8, s[8:11], s44 offen lds
    s_add_u32 m0, s43, 9216
    s_nop 0
    buffer_load_dwordx4 v9, s[8:11], s44 offen lds
    s_add_u32 s44, s44, 122880
    s_cmp_eq_u32 s44, 2457600
    s_cselect_b32 s44, 0, s44
    s_add_u32 m0, s42, 16384
    s_nop 0
    buffer_load_dwordx4 v4, s[12:15], s45 offen lds
    s_add_u32 m0, s42, 17408
    s_nop 0
    buffer_load_dwordx4 v5, s[12:15], s45 offen lds
    buffer_load_dwordx4 v[16:19], v40, s[16:19], s46 offen sc1
    buffer_load_dwordx4 v[20:23], v46, s[16:19], s47 offen offset:0 sc1
    buffer_load_dwordx4 v[24:27], v46, s[16:19], s47 offen offset:1024 sc1
    buffer_load_dwordx4 v[28:31], v46, s[16:19], s47 offen offset:2048 sc1
    buffer_load_dwordx4 v[32:35], v46, s[16:19], s47 offen offset:3072 sc1
    s_waitcnt vmcnt(15)
    s_barrier
    s_add_u32 m0, s43, 16384
    s_nop 0
    buffer_load_dwordx4 v8, s[8:11], s44 offen lds
    s_add_u32 m0, s43, 17408
    s_nop 0
    buffer_load_dwordx4 v9, s[8:11], s44 offen lds
    s_add_u32 s44, s44, 122880
    s_cmp_eq_u32 s44, 2457600
    s_cselect_b32 s44, 0, s44
    s_add_u32 m0, s42, 18432
    s_nop 0
    buffer_load_dwordx4 v6, s[12:15], s45 offen lds
    s_add_u32 m0, s42, 19456
    s_nop 0
    buffer_load_dwordx4 v7, s[12:15], s45 offen lds
    s_add_u32 s45, s45, 128
    s_cmp_eq_u32 s45, 1280
    s_cselect_b32 s45, 0, s45
    s_waitcnt vmcnt(13)
    s_barrier
    s_add_u32 m0, s43, 24576
    s_nop 0
    buffer_load_dwordx4 v8, s[8:11], s44 offen lds
    s_add_u32 m0, s43, 25600
    s_nop 0
    buffer_load_dwordx4 v9, s[8:11], s44 offen lds
    s_add_u32 s44, s44, 122880
    s_cmp_eq_u32 s44, 2457600
    s_cselect_b32 s44, 0, s44
    s_add_u32 m0, s42, 32768
    s_nop 0
    buffer_load_dwordx4 v4, s[12:15], s45 offen lds
    s_add_u32 m0, s42, 33792
    s_nop 0
    buffer_load_dwordx4 v5, s[12:15], s45 offen lds
    s_waitcnt vmcnt(15)
    s_barrier
    s_add_u32 m0, s43, 0
    s_nop 0
    buffer_load_dwordx4 v8, s[8:11], s44 offen lds
    s_add_u32 m0, s43, 1024
    s_nop 0
    buffer_load_dwordx4 v9, s[8:11], s44 offen lds
    s_add_u32 s44, s44, 122880
    s_cmp_eq_u32 s44, 2457600
    s_cselect_b32 s44, 0, s44
    s_add_u32 m0, s42, 34816
    s_nop 0
    buffer_load_dwordx4 v6, s[12:15], s45 offen lds
    s_add_u32 m0, s42, 35840
    s_nop 0
    buffer_load_dwordx4 v7, s[12:15], s45 offen lds
    s_add_u32 s45, s45, 128
    s_cmp_eq_u32 s45, 1280
    s_cselect_b32 s45, 0, s45
    s_waitcnt vmcnt(8)
    s_barrier
    s_add_u32 m0, s43, 8192
    s_nop 0
    buffer_load_dwordx4 v8, s[8:11], s44 offen lds
    s_add_u32 m0, s43, 9216
    s_nop 0
    buffer_load_dwordx4 v9, s[8:11], s44 offen lds
    s_add_u32 s44, s44, 122880
    s_cmp_eq_u32 s44, 2457600
    s_cselect_b32 s44, 0, s44
    s_add_u32 m0, s42, 0
    s_nop 0
    buffer_load_dwordx4 v4, s[12:15], s45 offen lds
    s_add_u32 m0, s42, 1024
    s_nop 0
    buffer_load_dwordx4 v5, s[12:15], s45 offen lds
    s_mov_b32 s79, 100000
L_gr_4_para:
    v_cmp_ne_u64 s[68:69], s[6:7], v[18:19]
    v_cmp_ne_u64 vcc, s[6:7], v[22:23]
    s_nop 0
    s_or_b64 s[68:69], s[68:69], vcc
    v_cmp_ne_u64 vcc, s[6:7], v[26:27]
    s_nop 0
    s_or_b64 s[68:69], s[68:69], vcc
    v_cmp_ne_u64 vcc, s[6:7], v[30:31]
    s_nop 0
    s_or_b64 s[68:69], s[68:69], vcc
    v_cmp_ne_u64 vcc, s[6:7], v[34:35]
    s_nop 0
    s_or_b64 s[68:69], s[68:69], vcc
    s_cbranch_scc0 L_grd_5_para
    s_sleep 2
    buffer_load_dwordx4 v[16:19], v40, s[16:19], s46 offen sc1
    buffer_load_dwordx4 v[20:23], v46, s[16:19], s47 offen offset:0 sc1
    buffer_load_dwordx4 v[24:27], v46, s[16:19], s47 offen offset:1024 sc1
    buffer_load_dwordx4 v[28:31], v46, s[16:19], s47 offen offset:2048 sc1
    buffer_load_dwordx4 v[32:35], v46, s[16:19], s47 offen offset:3072 sc1
    s_waitcnt vmcnt(0)
    s_sub_u32 s79, s79, 1
    s_cmp_lg_u32 s79, 0
    s_cbranch_scc1 L_gr_4_para
L_grd_5_para:
    s_waitcnt vmcnt(10)
    s_barrier
    s_add_u32 m0, s43, 16384
    s_nop 0
    buffer_load_dwordx4 v8, s[8:11], s44 offen lds
    s_add_u32 m0, s43, 17408
    s_nop 0
    buffer_load_dwordx4 v9, s[8:11], s44 offen lds
    s_add_u32 s44, s44, 122880
    s_cmp_eq_u32 s44, 2457600
    s_cselect_b32 s44, 0, s44
    s_add_u32 m0, s42, 2048
    s_nop 0
    buffer_load_dwordx4 v6, s[12:15], s45 offen lds
    s_add_u32 m0, s42, 3072
    s_nop 0
    buffer_load_dwordx4 v7, s[12:15], s45 offen lds
    s_add_u32 s45, s45, 128
    s_cmp_eq_u32 s45, 1280
    s_cselect_b32 s45, 0, s45
    v_add_f32 v20, v20, v24
    v_add_f32 v21, v21, v25
    v_add_f32 v28, v28, v32
    v_add_f32 v29, v29, v33
    v_add_f32 v20, v20, v28
    v_add_f32 v21, v21, v29
    v_mov_b32 v22, v20
    v_mov_b32 v23, v21
    s_nop 1
    v_permlane16_swap_b32 v20, v22
    v_permlane16_swap_b32 v21, v23
    s_nop 1
    v_add_f32 v20, v20, v22
    v_add_f32 v21, v21, v23
    v_mov_b32 v22, v20
    v_mov_b32 v23, v21
    s_nop 1
    v_permlane32_swap_b32 v20, v22
    v_permlane32_swap_b32 v21, v23
    s_nop 1
    v_add_f32 v20, v20, v22
    v_add_f32 v21, v21, v23
    s_waitcnt vmcnt(8)
    s_barrier
    s_add_u32 m0, s43, 24576
    s_nop 0
    buffer_load_dwordx4 v8, s[8:11], s44 offen lds
    s_add_u32 m0, s43, 25600
    s_nop 0
    buffer_load_dwordx4 v9, s[8:11], s44 offen lds
    s_add_u32 s44, s44, 122880
    s_cmp_eq_u32 s44, 2457600
    s_cselect_b32 s44, 0, s44
    ds_write_b32 v41, v16 offset:17408
    ds_write_b32 v41, v17 offset:17920
    ds_write_b64 v45, v[20:21] offset:16384
    s_waitcnt vmcnt(8)
    s_barrier
    s_waitcnt lgkmcnt(0)
    s_waitcnt vmcnt(2)
    s_barrier
    s_waitcnt vmcnt(0)
    s_barrier
    s_barrier
    s_cmp_lg_u32 s4, 4
    s_cbranch_scc1 L_a2
    s_lshl_b32 s78, s33, 4
    s_add_u32 s78, s78, s32
    s_add_u32 s78, s78, 256
    s_lshl_b32 s78, s78, 7
    v_mov_b32 v40, s6
    v_mov_b32 v41, s7
    v_mov_b32 v42, 0
    s_mov_b64 exec, 1
    buffer_store_dwordx2 v[40:41], v42, s[28:31], s78 offen sc1
    s_mov_b64 exec, -1
    s_branch L_a2
L_roleF:
    s_setprio 3
    s_and_b32 s34, s5, 7
    s_lshr_b32 s35, s5, 3
    s_and_b32 s36, s34, 1
    s_lshl_b32 s36, s36, 3
    s_and_b32 s37, s35, 7
    s_add_u32 s41, s36, s37
    s_lshr_b32 s36, s34, 1
    s_lshl_b32 s36, s36, 2
    s_lshr_b32 s37, s35, 3
    s_add_u32 s42, s36, s37
    s_and_b32 s40, s34, 1
    s_lshl_b32 s40, s40, 2
    s_lshr_b32 s36, s34, 1
    s_add_u32 s40, s40, s36
    s_lshl_b32 s40, s40, 5
    s_add_u32 s40, s40, s35
    s_lshl_b32 s32, s40, 3
    s_add_u32 s32, s32, s4
    s_mul_i32 s33, s32, 1280
    v_lshlrev_b32 v3, 2, v1
    s_mul_i32 s38, s41, 40
    s_mul_i32 s39, s4, 5
    s_add_u32 s38, s38, s39
    s_mul_i32 s38, s38, 3840
    s_min_u32 s39, s42, 14
    s_lshl_b32 s39, s39, 8
    s_add_u32 s38, s38, s39
    s_waitcnt lgkmcnt(0)
    s_mov_b32 s8, s48
    s_mov_b32 s9, s49
    s_mov_b32 s10, 2621440
    s_mov_b32 s11, 0x00020000
    buffer_load_dword v8, v3, s[8:11], s33 offen offset:0
    buffer_load_dword v9, v3, s[8:11], s33 offen offset:256
    buffer_load_dword v10, v3, s[8:11], s33 offen offset:512
    buffer_load_dword v11, v3, s[8:11], s33 offen offset:768
    buffer_load_dword v12, v3, s[8:11], s33 offen offset:1024
    s_mov_b32 s20, s50
    s_mov_b32 s21, s51
    s_mov_b32 s22, 2457600
    s_mov_b32 s23, 0x00020000
    buffer_load_dword v48, v3, s[20:23], s38 offen
    s_add_u32 s38, s38, 3840
    buffer_load_dword v49, v3, s[20:23], s38 offen
    s_add_u32 s38, s38, 3840
    buffer_load_dword v50, v3, s[20:23], s38 offen
    s_add_u32 s38, s38, 3840
    buffer_load_dword v51, v3, s[20:23], s38 offen
    s_add_u32 s38, s38, 3840
    buffer_load_dword v52, v3, s[20:23], s38 offen
    s_mov_b32 s72, s64
    s_mov_b32 s73, s65
    s_mov_b32 s74, 256
    s_mov_b32 s75, 0x00020000
    v_mov_b32 v46, 0
    s_add_u32 s28, s66, 19693568
    s_addc_u32 s29, s67, 0
    s_mov_b32 s30, 196608
    s_mov_b32 s31, 0x00020000
    s_mov_b32 s12, s66
    s_mov_b32 s13, s67
    s_mov_b32 s14, 2621440
    s_mov_b32 s15, 0x00020000
    s_add_u32 s16, s66, 19398656
    s_addc_u32 s17, s67, 0
    s_mov_b32 s18, 278528
    s_mov_b32 s19, 0x00020000
    s_mul_i32 s34, s4, 1312
    s_add_u32 s34, s34, 49408
    v_add_u32 v4, s34, v3
    v_and_b32 v5, 7, v0
    v_lshrrev_b32 v6, 3, v0
    v_mul_u32_u24 v7, 1312, v5
    v_lshrrev_b32 v42, 1, v6
    v_lshl_add_u32 v7, v42, 5, v7
    v_and_b32 v42, 1, v6
    v_lshl_add_u32 v7, v42, 3, v7
    v_add_u32 v7, 49408, v7
    v_lshlrev_b32 v6, 9, v6
    v_lshl_add_u32 v6, v5, 4, v6
    s_lshr_b32 s35, s40, 2
    s_mul_i32 s35, s35, 40960
    s_and_b32 s36, s40, 3
    s_lshl_b32 s36, s36, 7
    s_add_u32 s35, s35, s36
    s_add_u32 s36, s35, 32768
    s_lshl_b32 s37, s32, 4
    v_lshlrev_b32 v47, 3, v0
    v_lshlrev_b32 v43, 3, v1
    s_lshl_b32 s38, s42, 4
    s_add_u32 s38, s38, s41
    s_lshl_b32 s38, s38, 10
    s_add_u32 s38, s38, 32768
    s_waitcnt vmcnt(9)
    v_lshlrev_b32 v16, 16, v8
    v_and_b32 v17, 0xffff0000, v8
    s_waitcnt vmcnt(8)
    v_lshlrev_b32 v18, 16, v9
    v_and_b32 v19, 0xffff0000, v9
    s_waitcnt vmcnt(7)
    v_lshlrev_b32 v20, 16, v10
    v_and_b32 v21, 0xffff0000, v10
    s_waitcnt vmcnt(6)
    v_lshlrev_b32 v22, 16, v11
    v_and_b32 v23, 0xffff0000, v11
    s_waitcnt vmcnt(5)
    buffer_load_dwordx2 v[44:45], v46, s[72:75], 0 offen sc1
    v_lshlrev_b32 v24, 16, v12
    v_and_b32 v25, 0xffff0000, v12
    v_add_f32 v28, v16, v17
    v_add_f32 v30, v18, v19
    v_add_f32 v28, v28, v20
    v_add_f32 v30, v30, v21
    v_add_f32 v28, v28, v22
    v_add_f32 v30, v30, v23
    v_add_f32 v28, v28, v24
    v_add_f32 v30, v30, v25
    v_add_f32 v28, v28, v30
    s_nop 1
    v_add_f32_dpp v28, v28, v28 row_ror:8 row_mask:0xf bank_mask:0xf
    s_nop 1
    v_add_f32_dpp v28, v28, v28 row_ror:4 row_mask:0xf bank_mask:0xf
    s_nop 1
    v_add_f32_dpp v28, v28, v28 row_ror:2 row_mask:0xf bank_mask:0xf
    s_nop 1
    v_add_f32_dpp v28, v28, v28 row_ror:1 row_mask:0xf bank_mask:0xf
    v_mov_b32 v30, v28
    s_nop 1
    v_permlane16_swap_b32 v28, v30
    s_nop 1
    v_add_f32 v28, v28, v30
    v_mov_b32 v30, v28
    s_nop 1
    v_permlane32_swap_b32 v28, v30
    s_nop 1
    v_add_f32 v28, v28, v30
    v_mul_f32 v28, 0x3acccccd, v28
    v_sub_f32 v32, v16, v28
    v_sub_f32 v33, v17, v28
    v_sub_f32 v34, v18, v28
    v_sub_f32 v35, v19, v28
    v_sub_f32 v36, v20, v28
    v_sub_f32 v37, v21, v28
    v_sub_f32 v38, v22, v28
    v_sub_f32 v39, v23, v28
    v_sub_f32 v40, v24, v28
    v_sub_f32 v41, v25, v28
    v_mul_f32 v29, v32, v32
    v_mul_f32 v30, v33, v33
    v_fmac_f32 v29, v34, v34
    v_fmac_f32 v30, v35, v35
    v_fmac_f32 v29, v36, v36
    v_fmac_f32 v30, v37, v37
    v_fmac_f32 v29, v38, v38
    v_fmac_f32 v30, v39, v39
    v_fmac_f32 v29, v40, v40
    v_fmac_f32 v30, v41, v41
    v_add_f32 v29, v29, v30
    s_nop 1
    v_add_f32_dpp v29, v29, v29 row_ror:8 row_mask:0xf bank_mask:0xf
    s_nop 1
    v_add_f32_dpp v29, v29, v29 row_ror:4 row_mask:0xf bank_mask:0xf
    s_nop 1
    v_add_f32_dpp v29, v29, v29 row_ror:2 row_mask:0xf bank_mask:0xf
    s_nop 1
    v_add_f32_dpp v29, v29, v29 row_ror:1 row_mask:0xf bank_mask:0xf
    v_mov_b32 v30, v29
    s_nop 1
    v_permlane16_swap_b32 v29, v30
    s_nop 1
    v_add_f32 v29, v29, v30
    v_mov_b32 v30, v29
    s_nop 1
    v_permlane32_swap_b32 v29, v30
    s_nop 1
    v_add_f32 v29, v29, v30
    v_mul_f32 v29, 0x3acccccd, v29
    v_cvt_pk_bf16_f32 v28, v28, v28
    v_lshlrev_b32 v28, 16, v28
    v_cvt_pk_bf16_f32 v29, v29, v29
    v_lshlrev_b32 v29, 16, v29
    v_add_f32 v29, 0x3727c5ac, v29
    v_cvt_pk_bf16_f32 v29, v29, v29
    v_lshlrev_b32 v29, 16, v29
    v_sqrt_f32 v29, v29
    s_nop 0
    v_cvt_pk_bf16_f32 v29, v29, v29
    v_lshlrev_b32 v29, 16, v29
    v_rcp_f32 v29, v29
    s_waitcnt vmcnt(0)
    s_mov_b32 s79, 100000
    s_branch L_tgm_7_para
L_tg_6_para:
    buffer_load_dwordx2 v[44:45], v46, s[72:75], 0 offen sc1
    s_waitcnt vmcnt(0)
L_tgm_7_para:
    v_readfirstlane_b32 s6, v44
    v_readfirstlane_b32 s7, v45
    s_nop 1
    s_cmp_lg_u32 s6, 0
    s_cbranch_scc1 L_tgd_8_para
    s_sleep 2
    s_sub_u32 s79, s79, 1
    s_cmp_lg_u32 s79, 0
    s_cbranch_scc1 L_tg_6_para
L_tgd_8_para:
    v_mov_b32 v30, s6
    v_mov_b32 v31, s7
    s_mov_b64 exec, 1
    buffer_store_dwordx4 v[28:31], v46, s[16:19], s37 offen sc1
    s_mov_b64 exec, -1
    v_lshlrev_b32 v32, 16, v48
    v_and_b32 v33, 0xffff0000, v48
    v_lshlrev_b32 v34, 16, v49
    v_and_b32 v35, 0xffff0000, v49
    v_add_f32 v32, v32, v34
    v_add_f32 v33, v33, v35
    v_lshlrev_b32 v34, 16, v50
    v_and_b32 v35, 0xffff0000, v50
    v_add_f32 v32, v32, v34
    v_add_f32 v33, v33, v35
    v_lshlrev_b32 v34, 16, v51
    v_and_b32 v35, 0xffff0000, v51
    v_add_f32 v32, v32, v34
    v_add_f32 v33, v33, v35
    v_lshlrev_b32 v34, 16, v52
    v_and_b32 v35, 0xffff0000, v52
    v_add_f32 v32, v32, v34
    v_add_f32 v33, v33, v35
    ds_write_b64 v47, v[32:33] offset:59904
    v_sub_f32 v16, v16, v28
    v_sub_f32 v17, v17, v28
    v_cvt_pk_bf16_f32 v17, v16, v17
    v_lshlrev_b32 v16, 16, v17
    v_and_b32 v17, 0xffff0000, v17
    v_mul_f32 v16, v16, v29
    v_mul_f32 v17, v17, v29
    v_cvt_pk_bf16_f32 v8, v16, v17
    ds_write_b32 v4, v8 offset:0
    v_sub_f32 v18, v18, v28
    v_sub_f32 v19, v19, v28
    v_cvt_pk_bf16_f32 v19, v18, v19
    v_lshlrev_b32 v18, 16, v19
    v_and_b32 v19, 0xffff0000, v19
    v_mul_f32 v18, v18, v29
    v_mul_f32 v19, v19, v29
    v_cvt_pk_bf16_f32 v9, v18, v19
    ds_write_b32 v4, v9 offset:256
    v_sub_f32 v20, v20, v28
    v_sub_f32 v21, v21, v28
    v_cvt_pk_bf16_f32 v21, v20, v21
    v_lshlrev_b32 v20, 16, v21
    v_and_b32 v21, 0xffff0000, v21
    v_mul_f32 v20, v20, v29
    v_mul_f32 v21, v21, v29
    v_cvt_pk_bf16_f32 v10, v20, v21
    ds_write_b32 v4, v10 offset:512
    v_sub_f32 v22, v22, v28
    v_sub_f32 v23, v23, v28
    v_cvt_pk_bf16_f32 v23, v22, v23
    v_lshlrev_b32 v22, 16, v23
    v_and_b32 v23, 0xffff0000, v23
    v_mul_f32 v22, v22, v29
    v_mul_f32 v23, v23, v29
    v_cvt_pk_bf16_f32 v11, v22, v23
    ds_write_b32 v4, v11 offset:768
    v_sub_f32 v24, v24, v28
    v_sub_f32 v25, v25, v28
    v_cvt_pk_bf16_f32 v25, v24, v25
    v_lshlrev_b32 v24, 16, v25
    v_and_b32 v25, 0xffff0000, v25
    v_mul_f32 v24, v24, v29
    v_mul_f32 v25, v25, v29
    v_cvt_pk_bf16_f32 v12, v24, v25
    ds_write_b32 v4, v12 offset:1024
    s_waitcnt lgkmcnt(0)
    s_barrier
    ds_read2_b64 v[8:11], v7 offset0:0 offset1:2
    s_cmp_lg_u32 s4, 2
    s_cbranch_scc1 L_f0c_10_para
    ds_read_b64 v[48:49], v43 offset:59904
    ds_read_b64 v[50:51], v43 offset:60416
    ds_read_b64 v[52:53], v43 offset:60928
    ds_read_b64 v[54:55], v43 offset:61440
    ds_read_b64 v[56:57], v43 offset:61952
    ds_read_b64 v[58:59], v43 offset:62464
    ds_read_b64 v[60:61], v43 offset:62976
    ds_read_b64 v[62:63], v43 offset:63488
    s_waitcnt lgkmcnt(0)
    v_add_f32 v48, v48, v56
    v_add_f32 v49, v49, v57
    v_add_f32 v50, v50, v58
    v_add_f32 v51, v51, v59
    v_add_f32 v52, v52, v60
    v_add_f32 v53, v53, v61
    v_add_f32 v54, v54, v62
    v_add_f32 v55, v55, v63
    v_add_f32 v48, v48, v52
    v_add_f32 v49, v49, v53
    v_add_f32 v50, v50, v54
    v_add_f32 v51, v51, v55
    v_add_f32 v48, v48, v50
    v_add_f32 v49, v49, v51
    v_mov_b32 v50, s6
    v_mov_b32 v51, s7
    buffer_store_dwordx4 v[48:51], v2, s[16:19], s38 offen sc1
L_f0c_10_para:
    s_cmp_ge_u32 s4, 2
    s_cbranch_scc1 L_f0w_9_para
    ds_read2_b64 v[12:15], v7 offset0:128 offset1:130
    s_waitcnt lgkmcnt(0)
    buffer_store_dwordx4 v[12:15], v6, s[12:15], s36 offen sc1
L_f0w_9_para:
    s_waitcnt lgkmcnt(0)
    buffer_store_dwordx4 v[8:11], v6, s[12:15], s35 offen sc1
    s_waitcnt vmcnt(0)
    s_barrier
    s_cmp_lg_u32 s4, 0
    s_cbranch_scc1 L_f0p_11_para
    s_add_u32 s78, s40, 0
    s_lshl_b32 s78, s78, 7
    v_mov_b32 v8, s6
    v_mov_b32 v9, s7
    v_mov_b32 v10, 0
    s_mov_b64 exec, 1
    buffer_store_dwordx2 v[8:9], v10, s[28:31], s78 offen sc1
    s_mov_b64 exec, -1
L_f0p_11_para:
    s_setprio 2
    s_lshr_b32 s43, s5, 5
    s_mul_i32 s43, s43, 160
    s_mul_i32 s39, s4, 160
    s_movk_i32 s36, 1280
    v_add_u32 v3, s39, v1
    v_add_u32 v3, 0, v3
    v_mul_u32_u24 v14, 6554, v3
    v_lshrrev_b32 v14, 16, v14
    v_mul_u32_u24 v13, 10, v14
    v_sub_u32 v13, v3, v13
    v_lshl_add_u32 v13, v13, 4, s43
    v_lshrrev_b32 v3, 2, v14
    v_lshl_add_u32 v3, v3, 4, v14
    v_add_u32 v3, 16, v3
    v_mad_u32_u24 v110, v3, s36, v13
    v_add_u32 v3, s39, v1
    v_add_u32 v3, 64, v3
    v_mul_u32_u24 v14, 6554, v3
    v_lshrrev_b32 v14, 16, v14
    v_mul_u32_u24 v13, 10, v14
    v_sub_u32 v13, v3, v13
    v_lshl_add_u32 v13, v13, 4, s43
    v_lshrrev_b32 v3, 2, v14
    v_lshl_add_u32 v3, v3, 4, v14
    v_add_u32 v3, 16, v3
    v_mad_u32_u24 v111, v3, s36, v13
    v_add_u32 v3, s39, v1
    v_add_u32 v3, 128, v3
    v_mul_u32_u24 v14, 6554, v3
    v_lshrrev_b32 v14, 16, v14
    v_mul_u32_u24 v13, 10, v14
    v_sub_u32 v13, v3, v13
    v_lshl_add_u32 v13, v13, 4, s43
    v_lshrrev_b32 v3, 2, v14
    v_lshl_add_u32 v3, v3, 4, v14
    v_add_u32 v3, 16, v3
    v_mad_u32_u24 v112, v3, s36, v13
    v_lshrrev_b32 v3, 5, v1
    v_lshlrev_b32 v13, 4, v3
    v_bfe_u32 v14, v1, 2, 3
    v_add_u32 v13, v13, v14
    s_lshr_b32 s44, s4, 1
    s_lshl_b32 s44, s44, 5
    v_add_u32 v13, s44, v13
    v_mul_u32_u24 v13, 160, v13
    v_and_b32 v14, 3, v1
    v_lshl_add_u32 v113, v14, 3, v13
    v_xor_b32 v13, v3, v1
    s_mul_i32 s44, s4, 10240
    v_lshl_add_u32 v115, v13, 4, s44
    v_lshrrev_b32 v3, 4, v1
    v_lshlrev_b32 v3, 9, v3
    v_and_b32 v15, 15, v1
    v_lshl_add_u32 v114, v15, 4, v3
    s_and_b32 s44, s5, 7
    s_lshl_b32 s44, s44, 2
    s_bfe_u32 s45, s5, 0x20003
    s_add_u32 s44, s44, s45
    s_lshl_b32 s44, s44, 6
    v_add_u32 v3, 0, v1
    v_mul_u32_u24 v14, 6554, v3
    v_lshrrev_b32 v14, 16, v14
    v_mul_u32_u24 v13, 10, v14
    v_sub_u32 v13, v3, v13
    v_lshl_add_u32 v13, v13, 4, s39
    v_mad_u32_u24 v122, v14, s36, v13
    v_add_u32 v3, 64, v1
    v_mul_u32_u24 v14, 6554, v3
    v_lshrrev_b32 v14, 16, v14
    v_mul_u32_u24 v13, 10, v14
    v_sub_u32 v13, v3, v13
    v_lshl_add_u32 v13, v13, 4, s39
    v_mad_u32_u24 v123, v14, s36, v13
    s_sub_u32 s45, s5, 192
    s_lshr_b32 s72, s45, 1
    s_mul_i32 s72, s72, 20
    s_and_b32 s45, s45, 1
    s_lshl_b32 s45, s45, 3
    s_add_u32 s72, s72, s45
    s_lshl_b32 s45, s5, 3
    s_cmp_lt_u32 s5, 192
    s_cselect_b32 s72, s45, s72
    s_cselect_b32 s20, s60, s52
    s_cselect_b32 s21, s61, s53
    s_mov_b32 s22, 819200
    s_cselect_b32 s22, 1966080, s22
    s_mov_b32 s23, 0x00020000
    s_mul_i32 s72, s72, 1280
    s_mul_i32 s73, s4, 327680
    s_mul_i32 s45, s5, 1280
    s_add_u32 s73, s73, s45
    s_add_u32 s24, s66, 19955712
    s_addc_u32 s25, s67, 0
    s_mov_b32 s26, 2621440
    s_mov_b32 s27, 0x00020000
    v_add_u32 v3, 0, v0
    v_mul_u32_u24 v13, 6554, v3
    v_lshrrev_b32 v13, 16, v13
    v_mul_u32_u24 v14, 10, v13
    v_sub_u32 v14, v3, v14
    v_lshrrev_b32 v3, 4, v13
    v_mul_u32_u24 v3, 5120, v3
    v_lshl_add_u32 v3, v14, 9, v3
    v_xor_b32 v15, v13, v14
    v_and_b32 v15, 15, v15
    v_lshl_add_u32 v124, v15, 4, v3
    v_add_u32 v3, s44, v13
    v_mul_u32_u24 v3, 1280, v3
    v_lshl_add_u32 v126, v14, 4, v3
    v_add_u32 v3, 512, v0
    v_mul_u32_u24 v13, 6554, v3
    v_lshrrev_b32 v13, 16, v13
    v_mul_u32_u24 v14, 10, v13
    v_sub_u32 v14, v3, v14
    v_lshrrev_b32 v3, 4, v13
    v_mul_u32_u24 v3, 5120, v3
    v_lshl_add_u32 v3, v14, 9, v3
    v_xor_b32 v15, v13, v14
    v_and_b32 v15, 15, v15
    v_lshl_add_u32 v125, v15, 4, v3
    v_add_u32 v3, s44, v13
    v_mul_u32_u24 v3, 1280, v3
    v_lshl_add_u32 v127, v14, 4, v3
    s_and_b32 s34, s5, 7
    s_lshr_b32 s35, s5, 3
    s_and_b32 s36, s34, 1
    s_lshl_b32 s36, s36, 3
    s_and_b32 s37, s35, 7
    s_add_u32 s32, s36, s37
    s_lshr_b32 s36, s34, 1
    s_lshl_b32 s36, s36, 2
    s_lshr_b32 s37, s35, 3
    s_add_u32 s33, s36, s37
    s_and_b32 s36, s4, 3
    s_lshl_b32 s37, s36, 11
    v_lshrrev_b32 v12, 4, v1
    v_lshlrev_b32 v12, 9, v12
    v_and_b32 v4, 15, v1
    v_lshl_add_u32 v4, v4, 4, v12
    v_add_u32 v4, s37, v4
    v_lshrrev_b32 v12, 5, v1
    v_bfe_u32 v13, v1, 2, 3
    v_lshl_add_u32 v14, v12, 4, v13
    v_mul_u32_u24 v14, 192, v14
    v_and_b32 v15, 1, v1
    v_lshl_add_u32 v14, v15, 4, v14
    v_bfe_u32 v15, v1, 1, 1
    v_lshl_add_u32 v14, v15, 3, v14
    v_add_u32 v14, 8192, v14
    v_bfe_u32 v15, v1, 4, 1
    v_lshl_add_u32 v5, v15, 5, v14
    v_lshlrev_b32 v15, 5, v15
    v_sub_u32 v6, v14, v15
    v_add_u32 v120, 6144, v5
    v_add_u32 v121, 6144, v6
    s_mul_i32 s40, s32, 5
    s_lshr_b32 s40, s40, 1
    s_mul_i32 s43, s33, 5
    s_add_u32 s40, s40, s43
    s_lshl_b32 s46, s32, 2
    s_add_u32 s46, s46, s36
    s_cmp_ge_u32 s40, 80
    s_cselect_b32 s43, 80, 0
    s_sub_u32 s40, s40, s43
    s_cmp_ge_u32 s40, 40
    s_cselect_b32 s43, 40, 0
    s_sub_u32 s40, s40, s43
    s_cmp_ge_u32 s40, 20
    s_cselect_b32 s43, 20, 0
    s_sub_u32 s40, s40, s43
    s_add_u32 s16, s66, 13107200
    s_addc_u32 s17, s67, 0
    s_mov_b32 s18, 6291456
    s_mov_b32 s19, 0x00020000
    s_cmp_ge_u32 s4, 4
    s_cbranch_scc1 L_f1b_12_para
    s_cmp_lt_u32 s4, 2
    s_cselect_b32 s8, s56, s58
    s_cselect_b32 s9, s57, s59
    s_mov_b32 s10, 1966080
    s_mov_b32 s11, 0x00020000
    s_mul_i32 s42, s4, 3072
    s_add_u32 s42, s42, 8192
    s_and_b32 s36, s4, 1
    s_lshl_b32 s36, s36, 4
    s_mul_i32 s37, s33, 192
    s_mul_i32 s44, s40, 98304
    v_add_u32 v3, 0, v1
    v_mul_u32_u24 v10, 5462, v3
    v_lshrrev_b32 v10, 16, v10
    v_mul_u32_u24 v11, 12, v10
    v_sub_u32 v11, v3, v11
    v_bfe_u32 v3, v10, 2, 1
    v_lshlrev_b32 v3, 1, v3
    v_xor_b32 v11, v3, v11
    v_add_u32 v10, s36, v10
    v_mul_u32_u24 v10, 3072, v10
    v_lshl_add_u32 v10, v11, 4, v10
    v_add_u32 v7, s37, v10
    v_add_u32 v3, 64, v1
    v_mul_u32_u24 v10, 5462, v3
    v_lshrrev_b32 v10, 16, v10
    v_mul_u32_u24 v11, 12, v10
    v_sub_u32 v11, v3, v11
    v_bfe_u32 v3, v10, 2, 1
    v_lshlrev_b32 v3, 1, v3
    v_xor_b32 v11, v3, v11
    v_add_u32 v10, s36, v10
    v_mul_u32_u24 v10, 3072, v10
    v_lshl_add_u32 v10, v11, 4, v10
    v_add_u32 v8, s37, v10
    v_add_u32 v3, 128, v1
    v_mul_u32_u24 v10, 5462, v3
    v_lshrrev_b32 v10, 16, v10
    v_mul_u32_u24 v11, 12, v10
    v_sub_u32 v11, v3, v11
    v_bfe_u32 v3, v10, 2, 1
    v_lshlrev_b32 v3, 1, v3
    v_xor_b32 v11, v3, v11
    v_add_u32 v10, s36, v10
    v_mul_u32_u24 v10, 3072, v10
    v_lshl_add_u32 v10, v11, 4, v10
    v_add_u32 v9, s37, v10
    s_add_u32 m0, s42, 0
    s_nop 0
    buffer_load_dwordx4 v7, s[8:11], s44 offen lds
    s_add_u32 m0, s42, 1024
    s_nop 0
    buffer_load_dwordx4 v8, s[8:11], s44 offen lds
    s_add_u32 m0, s42, 2048
    s_nop 0
    buffer_load_dwordx4 v9, s[8:11], s44 offen lds
    s_add_u32 s44, s44, 98304
    s_cmp_eq_u32 s44, 1966080
    s_cselect_b32 s44, 0, s44
    s_add_u32 m0, s42, 20480
    s_nop 0
    buffer_load_dwordx4 v7, s[8:11], s44 offen lds
    s_add_u32 m0, s42, 21504
    s_nop 0
    buffer_load_dwordx4 v8, s[8:11], s44 offen lds
    s_add_u32 m0, s42, 22528
    s_nop 0
    buffer_load_dwordx4 v9, s[8:11], s44 offen lds
    s_add_u32 s44, s44, 98304
    s_cmp_eq_u32 s44, 1966080
    s_cselect_b32 s44, 0, s44
    s_add_u32 m0, s42, 40960
    s_nop 0
    buffer_load_dwordx4 v7, s[8:11], s44 offen lds
    s_add_u32 m0, s42, 41984
    s_nop 0
    buffer_load_dwordx4 v8, s[8:11], s44 offen lds
    s_add_u32 m0, s42, 43008
    s_nop 0
    buffer_load_dwordx4 v9, s[8:11], s44 offen lds
    s_add_u32 s44, s44, 98304
    s_cmp_eq_u32 s44, 1966080
    s_cselect_b32 s44, 0, s44
    s_add_u32 m0, s42, 61440
    s_nop 0
    buffer_load_dwordx4 v7, s[8:11], s44 offen lds
    s_add_u32 m0, s42, 62464
    s_nop 0
    buffer_load_dwordx4 v8, s[8:11], s44 offen lds
    s_add_u32 m0, s42, 63488
    s_nop 0
    buffer_load_dwordx4 v9, s[8:11], s44 offen lds
    s_add_u32 s44, s44, 98304
    s_cmp_eq_u32 s44, 1966080
    s_cselect_b32 s44, 0, s44
    s_waitcnt vmcnt(9)
    s_barrier
    ds_read_b128 v[88:91], v4 offset:0
    ds_read_b128 v[92:95], v4 offset:256
    ds_read_b64_tr_b16 v[64:65], v5 offset:0
    ds_read_b64_tr_b16 v[66:67], v5 offset:1536
    ds_read_b64_tr_b16 v[68:69], v120 offset:0
    ds_read_b64_tr_b16 v[70:71], v120 offset:1536
    ds_read_b64_tr_b16 v[72:73], v6 offset:32
    ds_read_b64_tr_b16 v[74:75], v6 offset:1568
    ds_read_b64_tr_b16 v[76:77], v121 offset:32
    ds_read_b64_tr_b16 v[78:79], v121 offset:1568
    ds_read_b64_tr_b16 v[80:81], v5 offset:64
    ds_read_b64_tr_b16 v[82:83], v5 offset:1600
    ds_read_b64_tr_b16 v[84:85], v120 offset:64
    ds_read_b64_tr_b16 v[86:87], v120 offset:1600
    s_waitcnt lgkmcnt(0)
    v_mfma_f32_16x16x32_bf16 v[16:19], v[64:67], v[88:91], 0
    v_mfma_f32_16x16x32_bf16 v[20:23], v[64:67], v[92:95], 0
    s_waitcnt vmcnt(6)
    s_barrier
    ds_read_b128 v[96:99], v4 offset:20480
    ds_read_b128 v[100:103], v4 offset:20736
    ds_read_b64_tr_b16 v[64:65], v5 offset:20480
    ds_read_b64_tr_b16 v[66:67], v5 offset:22016
    v_mfma_f32_16x16x32_bf16 v[24:27], v[68:71], v[88:91], 0
    v_mfma_f32_16x16x32_bf16 v[28:31], v[68:71], v[92:95], 0
    ds_read_b64_tr_b16 v[68:69], v120 offset:20480
    ds_read_b64_tr_b16 v[70:71], v120 offset:22016
    s_add_u32 m0, s42, 0
    s_nop 0
    buffer_load_dwordx4 v7, s[8:11], s44 offen lds
    s_add_u32 m0, s42, 1024
    s_nop 0
    buffer_load_dwordx4 v8, s[8:11], s44 offen lds
    v_mfma_f32_16x16x32_bf16 v[32:35], v[72:75], v[88:91], 0
    v_mfma_f32_16x16x32_bf16 v[36:39], v[72:75], v[92:95], 0
    ds_read_b64_tr_b16 v[72:73], v6 offset:20512
    ds_read_b64_tr_b16 v[74:75], v6 offset:22048
    v_mfma_f32_16x16x32_bf16 v[40:43], v[76:79], v[88:91], 0
    v_mfma_f32_16x16x32_bf16 v[44:47], v[76:79], v[92:95], 0
    ds_read_b64_tr_b16 v[76:77], v121 offset:20512
    ds_read_b64_tr_b16 v[78:79], v121 offset:22048
    s_add_u32 m0, s42, 2048
    s_nop 0
    buffer_load_dwordx4 v9, s[8:11], s44 offen lds
    s_add_u32 s44, s44, 98304
    s_cmp_eq_u32 s44, 1966080
    s_cselect_b32 s44, 0, s44
    v_mfma_f32_16x16x32_bf16 v[48:51], v[80:83], v[88:91], 0
    v_mfma_f32_16x16x32_bf16 v[52:55], v[80:83], v[92:95], 0
    ds_read_b64_tr_b16 v[80:81], v5 offset:20544
    ds_read_b64_tr_b16 v[82:83], v5 offset:22080
    v_mfma_f32_16x16x32_bf16 v[56:59], v[84:87], v[88:91], 0
    v_mfma_f32_16x16x32_bf16 v[60:63], v[84:87], v[92:95], 0
    ds_read_b64_tr_b16 v[84:85], v120 offset:20544
    ds_read_b64_tr_b16 v[86:87], v120 offset:22080
    s_waitcnt lgkmcnt(0)
    v_mfma_f32_16x16x32_bf16 v[16:19], v[64:67], v[96:99], v[16:19]
    v_mfma_f32_16x16x32_bf16 v[20:23], v[64:67], v[100:103], v[20:23]
    s_waitcnt vmcnt(6)
    s_barrier
    ds_read_b128 v[88:91], v4 offset:40960
    ds_read_b128 v[92:95], v4 offset:41216
    ds_read_b64_tr_b16 v[64:65], v5 offset:40960
    ds_read_b64_tr_b16 v[66:67], v5 offset:42496
    v_mfma_f32_16x16x32_bf16 v[24:27], v[68:71], v[96:99], v[24:27]
    v_mfma_f32_16x16x32_bf16 v[28:31], v[68:71], v[100:103], v[28:31]
    ds_read_b64_tr_b16 v[68:69], v120 offset:40960
    ds_read_b64_tr_b16 v[70:71], v120 offset:42496
    s_add_u32 m0, s42, 20480
    s_nop 0
    buffer_load_dwordx4 v7, s[8:11], s44 offen lds
    s_add_u32 m0, s42, 21504
    s_nop 0
    buffer_load_dwordx4 v8, s[8:11], s44 offen lds
    v_mfma_f32_16x16x32_bf16 v[32:35], v[72:75], v[96:99], v[32:35]
    v_mfma_f32_16x16x32_bf16 v[36:39], v[72:75], v[100:103], v[36:39]
    ds_read_b64_tr_b16 v[72:73], v6 offset:40992
    ds_read_b64_tr_b16 v[74:75], v6 offset:42528
    v_mfma_f32_16x16x32_bf16 v[40:43], v[76:79], v[96:99], v[40:43]
    v_mfma_f32_16x16x32_bf16 v[44:47], v[76:79], v[100:103], v[44:47]
    ds_read_b64_tr_b16 v[76:77], v121 offset:40992
    ds_read_b64_tr_b16 v[78:79], v121 offset:42528
    s_add_u32 m0, s42, 22528
    s_nop 0
    buffer_load_dwordx4 v9, s[8:11], s44 offen lds
    s_add_u32 s44, s44, 98304
    s_cmp_eq_u32 s44, 1966080
    s_cselect_b32 s44, 0, s44
    v_mfma_f32_16x16x32_bf16 v[48:51], v[80:83], v[96:99], v[48:51]
    v_mfma_f32_16x16x32_bf16 v[52:55], v[80:83], v[100:103], v[52:55]
    ds_read_b64_tr_b16 v[80:81], v5 offset:41024
    ds_read_b64_tr_b16 v[82:83], v5 offset:42560
    v_mfma_f32_16x16x32_bf16 v[56:59], v[84:87], v[96:99], v[56:59]
    v_mfma_f32_16x16x32_bf16 v[60:63], v[84:87], v[100:103], v[60:63]
    ds_read_b64_tr_b16 v[84:85], v120 offset:41024
    ds_read_b64_tr_b16 v[86:87], v120 offset:42560
    s_waitcnt lgkmcnt(0)
    v_mfma_f32_16x16x32_bf16 v[16:19], v[64:67], v[88:91], v[16:19]
    v_mfma_f32_16x16x32_bf16 v[20:23], v[64:67], v[92:95], v[20:23]
    s_waitcnt vmcnt(6)
    s_barrier
    ds_read_b128 v[96:99], v4 offset:61440
    ds_read_b128 v[100:103], v4 offset:61696
    ds_read_b64_tr_b16 v[64:65], v5 offset:61440
    ds_read_b64_tr_b16 v[66:67], v5 offset:62976
    v_mfma_f32_16x16x32_bf16 v[24:27], v[68:71], v[88:91], v[24:27]
    v_mfma_f32_16x16x32_bf16 v[28:31], v[68:71], v[92:95], v[28:31]
    ds_read_b64_tr_b16 v[68:69], v120 offset:61440
    ds_read_b64_tr_b16 v[70:71], v120 offset:62976
    s_add_u32 m0, s42, 40960
    s_nop 0
    buffer_load_dwordx4 v7, s[8:11], s44 offen lds
    s_add_u32 m0, s42, 41984
    s_nop 0
    buffer_load_dwordx4 v8, s[8:11], s44 offen lds
    v_mfma_f32_16x16x32_bf16 v[32:35], v[72:75], v[88:91], v[32:35]
    v_mfma_f32_16x16x32_bf16 v[36:39], v[72:75], v[92:95], v[36:39]
    ds_read_b64_tr_b16 v[72:73], v6 offset:61472
    ds_read_b64_tr_b16 v[74:75], v6 offset:63008
    v_mfma_f32_16x16x32_bf16 v[40:43], v[76:79], v[88:91], v[40:43]
    v_mfma_f32_16x16x32_bf16 v[44:47], v[76:79], v[92:95], v[44:47]
    ds_read_b64_tr_b16 v[76:77], v121 offset:61472
    ds_read_b64_tr_b16 v[78:79], v121 offset:63008
    s_add_u32 m0, s42, 43008
    s_nop 0
    buffer_load_dwordx4 v9, s[8:11], s44 offen lds
    s_add_u32 s44, s44, 98304
    s_cmp_eq_u32 s44, 1966080
    s_cselect_b32 s44, 0, s44
    v_mfma_f32_16x16x32_bf16 v[48:51], v[80:83], v[88:91], v[48:51]
    v_mfma_f32_16x16x32_bf16 v[52:55], v[80:83], v[92:95], v[52:55]
    ds_read_b64_tr_b16 v[80:81], v5 offset:61504
    ds_read_b64_tr_b16 v[82:83], v5 offset:63040
    v_mfma_f32_16x16x32_bf16 v[56:59], v[84:87], v[88:91], v[56:59]
    v_mfma_f32_16x16x32_bf16 v[60:63], v[84:87], v[92:95], v[60:63]
    ds_read_b64_tr_b16 v[84:85], v120 offset:61504
    ds_read_b64_tr_b16 v[86:87], v120 offset:63040
    s_waitcnt lgkmcnt(0)
    v_mfma_f32_16x16x32_bf16 v[16:19], v[64:67], v[96:99], v[16:19]
    v_mfma_f32_16x16x32_bf16 v[20:23], v[64:67], v[100:103], v[20:23]
    s_waitcnt vmcnt(6)
    s_barrier
    ds_read_b128 v[88:91], v4 offset:0
    ds_read_b128 v[92:95], v4 offset:256
    ds_read_b64_tr_b16 v[64:65], v5 offset:0
    ds_read_b64_tr_b16 v[66:67], v5 offset:1536
    v_mfma_f32_16x16x32_bf16 v[24:27], v[68:71], v[96:99], v[24:27]
    v_mfma_f32_16x16x32_bf16 v[28:31], v[68:71], v[100:103], v[28:31]
    ds_read_b64_tr_b16 v[68:69], v120 offset:0
    ds_read_b64_tr_b16 v[70:71], v120 offset:1536
    s_add_u32 m0, s42, 61440
    s_nop 0
    buffer_load_dwordx4 v7, s[8:11], s44 offen lds
    s_add_u32 m0, s42, 62464
    s_nop 0
    buffer_load_dwordx4 v8, s[8:11], s44 offen lds
    v_mfma_f32_16x16x32_bf16 v[32:35], v[72:75], v[96:99], v[32:35]
    v_mfma_f32_16x16x32_bf16 v[36:39], v[72:75], v[100:103], v[36:39]
    ds_read_b64_tr_b16 v[72:73], v6 offset:32
    ds_read_b64_tr_b16 v[74:75], v6 offset:1568
    v_mfma_f32_16x16x32_bf16 v[40:43], v[76:79], v[96:99], v[40:43]
    v_mfma_f32_16x16x32_bf16 v[44:47], v[76:79], v[100:103], v[44:47]
    ds_read_b64_tr_b16 v[76:77], v121 offset:32
    ds_read_b64_tr_b16 v[78:79], v121 offset:1568
    s_add_u32 m0, s42, 63488
    s_nop 0
    buffer_load_dwordx4 v9, s[8:11], s44 offen lds
    s_add_u32 s44, s44, 98304
    s_cmp_eq_u32 s44, 1966080
    s_cselect_b32 s44, 0, s44
    v_mfma_f32_16x16x32_bf16 v[48:51], v[80:83], v[96:99], v[48:51]
    v_mfma_f32_16x16x32_bf16 v[52:55], v[80:83], v[100:103], v[52:55]
    ds_read_b64_tr_b16 v[80:81], v5 offset:64
    ds_read_b64_tr_b16 v[82:83], v5 offset:1600
    v_mfma_f32_16x16x32_bf16 v[56:59], v[84:87], v[96:99], v[56:59]
    v_mfma_f32_16x16x32_bf16 v[60:63], v[84:87], v[100:103], v[60:63]
    ds_read_b64_tr_b16 v[84:85], v120 offset:64
    ds_read_b64_tr_b16 v[86:87], v120 offset:1600
    s_waitcnt lgkmcnt(0)
    v_mfma_f32_16x16x32_bf16 v[16:19], v[64:67], v[88:91], v[16:19]
    v_mfma_f32_16x16x32_bf16 v[20:23], v[64:67], v[92:95], v[20:23]
    s_waitcnt vmcnt(6)
    s_barrier
    ds_read_b128 v[96:99], v4 offset:20480
    ds_read_b128 v[100:103], v4 offset:20736
    ds_read_b64_tr_b16 v[64:65], v5 offset:20480
    ds_read_b64_tr_b16 v[66:67], v5 offset:22016
    v_mfma_f32_16x16x32_bf16 v[24:27], v[68:71], v[88:91], v[24:27]
    v_mfma_f32_16x16x32_bf16 v[28:31], v[68:71], v[92:95], v[28:31]
    ds_read_b64_tr_b16 v[68:69], v120 offset:20480
    ds_read_b64_tr_b16 v[70:71], v120 offset:22016
    s_add_u32 m0, s42, 0
    s_nop 0
    buffer_load_dwordx4 v7, s[8:11], s44 offen lds
    s_add_u32 m0, s42, 1024
    s_nop 0
    buffer_load_dwordx4 v8, s[8:11], s44 offen lds
    v_mfma_f32_16x16x32_bf16 v[32:35], v[72:75], v[88:91], v[32:35]
    v_mfma_f32_16x16x32_bf16 v[36:39], v[72:75], v[92:95], v[36:39]
    ds_read_b64_tr_b16 v[72:73], v6 offset:20512
    ds_read_b64_tr_b16 v[74:75], v6 offset:22048
    v_mfma_f32_16x16x32_bf16 v[40:43], v[76:79], v[88:91], v[40:43]
    v_mfma_f32_16x16x32_bf16 v[44:47], v[76:79], v[92:95], v[44:47]
    ds_read_b64_tr_b16 v[76:77], v121 offset:20512
    ds_read_b64_tr_b16 v[78:79], v121 offset:22048
    s_add_u32 m0, s42, 2048
    s_nop 0
    buffer_load_dwordx4 v9, s[8:11], s44 offen lds
    s_add_u32 s44, s44, 98304
    s_cmp_eq_u32 s44, 1966080
    s_cselect_b32 s44, 0, s44
    v_mfma_f32_16x16x32_bf16 v[48:51], v[80:83], v[88:91], v[48:51]
    v_mfma_f32_16x16x32_bf16 v[52:55], v[80:83], v[92:95], v[52:55]
    ds_read_b64_tr_b16 v[80:81], v5 offset:20544
    ds_read_b64_tr_b16 v[82:83], v5 offset:22080
    v_mfma_f32_16x16x32_bf16 v[56:59], v[84:87], v[88:91], v[56:59]
    v_mfma_f32_16x16x32_bf16 v[60:63], v[84:87], v[92:95], v[60:63]
    ds_read_b64_tr_b16 v[84:85], v120 offset:20544
    ds_read_b64_tr_b16 v[86:87], v120 offset:22080
    s_setprio 1
    s_waitcnt lgkmcnt(0)
    v_mfma_f32_16x16x32_bf16 v[16:19], v[64:67], v[96:99], v[16:19]
    v_mfma_f32_16x16x32_bf16 v[20:23], v[64:67], v[100:103], v[20:23]
    s_waitcnt vmcnt(6)
    s_barrier
    ds_read_b128 v[88:91], v4 offset:40960
    ds_read_b128 v[92:95], v4 offset:41216
    ds_read_b64_tr_b16 v[64:65], v5 offset:40960
    ds_read_b64_tr_b16 v[66:67], v5 offset:42496
    v_mfma_f32_16x16x32_bf16 v[24:27], v[68:71], v[96:99], v[24:27]
    v_mfma_f32_16x16x32_bf16 v[28:31], v[68:71], v[100:103], v[28:31]
    ds_read_b64_tr_b16 v[68:69], v120 offset:40960
    ds_read_b64_tr_b16 v[70:71], v120 offset:42496
    s_add_u32 m0, s42, 20480
    s_nop 0
    buffer_load_dwordx4 v7, s[8:11], s44 offen lds
    s_add_u32 m0, s42, 21504
    s_nop 0
    buffer_load_dwordx4 v8, s[8:11], s44 offen lds
    v_mfma_f32_16x16x32_bf16 v[32:35], v[72:75], v[96:99], v[32:35]
    v_mfma_f32_16x16x32_bf16 v[36:39], v[72:75], v[100:103], v[36:39]
    ds_read_b64_tr_b16 v[72:73], v6 offset:40992
    ds_read_b64_tr_b16 v[74:75], v6 offset:42528
    v_mfma_f32_16x16x32_bf16 v[40:43], v[76:79], v[96:99], v[40:43]
    v_mfma_f32_16x16x32_bf16 v[44:47], v[76:79], v[100:103], v[44:47]
    ds_read_b64_tr_b16 v[76:77], v121 offset:40992
    ds_read_b64_tr_b16 v[78:79], v121 offset:42528
    s_add_u32 m0, s42, 22528
    s_nop 0
    buffer_load_dwordx4 v9, s[8:11], s44 offen lds
    s_add_u32 s44, s44, 98304
    s_cmp_eq_u32 s44, 1966080
    s_cselect_b32 s44, 0, s44
    v_mfma_f32_16x16x32_bf16 v[48:51], v[80:83], v[96:99], v[48:51]
    v_mfma_f32_16x16x32_bf16 v[52:55], v[80:83], v[100:103], v[52:55]
    ds_read_b64_tr_b16 v[80:81], v5 offset:41024
    ds_read_b64_tr_b16 v[82:83], v5 offset:42560
    v_mfma_f32_16x16x32_bf16 v[56:59], v[84:87], v[96:99], v[56:59]
    v_mfma_f32_16x16x32_bf16 v[60:63], v[84:87], v[100:103], v[60:63]
    ds_read_b64_tr_b16 v[84:85], v120 offset:41024
    ds_read_b64_tr_b16 v[86:87], v120 offset:42560
    s_waitcnt lgkmcnt(0)
    v_mfma_f32_16x16x32_bf16 v[16:19], v[64:67], v[88:91], v[16:19]
    v_mfma_f32_16x16x32_bf16 v[20:23], v[64:67], v[92:95], v[20:23]
    s_waitcnt vmcnt(6)
    s_barrier
    ds_read_b128 v[96:99], v4 offset:61440
    ds_read_b128 v[100:103], v4 offset:61696
    ds_read_b64_tr_b16 v[64:65], v5 offset:61440
    ds_read_b64_tr_b16 v[66:67], v5 offset:62976
    v_mfma_f32_16x16x32_bf16 v[24:27], v[68:71], v[88:91], v[24:27]
    v_mfma_f32_16x16x32_bf16 v[28:31], v[68:71], v[92:95], v[28:31]
    ds_read_b64_tr_b16 v[68:69], v120 offset:61440
    ds_read_b64_tr_b16 v[70:71], v120 offset:62976
    s_add_u32 m0, s42, 40960
    s_nop 0
    buffer_load_dwordx4 v7, s[8:11], s44 offen lds
    s_add_u32 m0, s42, 41984
    s_nop 0
    buffer_load_dwordx4 v8, s[8:11], s44 offen lds
    v_mfma_f32_16x16x32_bf16 v[32:35], v[72:75], v[88:91], v[32:35]
    v_mfma_f32_16x16x32_bf16 v[36:39], v[72:75], v[92:95], v[36:39]
    ds_read_b64_tr_b16 v[72:73], v6 offset:61472
    ds_read_b64_tr_b16 v[74:75], v6 offset:63008
    v_mfma_f32_16x16x32_bf16 v[40:43], v[76:79], v[88:91], v[40:43]
    v_mfma_f32_16x16x32_bf16 v[44:47], v[76:79], v[92:95], v[44:47]
    ds_read_b64_tr_b16 v[76:77], v121 offset:61472
    ds_read_b64_tr_b16 v[78:79], v121 offset:63008
    s_add_u32 m0, s42, 43008
    s_nop 0
    buffer_load_dwordx4 v9, s[8:11], s44 offen lds
    s_add_u32 s44, s44, 98304
    s_cmp_eq_u32 s44, 1966080
    s_cselect_b32 s44, 0, s44
    v_mfma_f32_16x16x32_bf16 v[48:51], v[80:83], v[88:91], v[48:51]
    v_mfma_f32_16x16x32_bf16 v[52:55], v[80:83], v[92:95], v[52:55]
    ds_read_b64_tr_b16 v[80:81], v5 offset:61504
    ds_read_b64_tr_b16 v[82:83], v5 offset:63040
    v_mfma_f32_16x16x32_bf16 v[56:59], v[84:87], v[88:91], v[56:59]
    v_mfma_f32_16x16x32_bf16 v[60:63], v[84:87], v[92:95], v[60:63]
    ds_read_b64_tr_b16 v[84:85], v120 offset:61504
    ds_read_b64_tr_b16 v[86:87], v120 offset:63040
    s_waitcnt lgkmcnt(0)
    v_mfma_f32_16x16x32_bf16 v[16:19], v[64:67], v[96:99], v[16:19]
    v_mfma_f32_16x16x32_bf16 v[20:23], v[64:67], v[100:103], v[20:23]
    s_waitcnt vmcnt(6)
    s_barrier
    ds_read_b128 v[88:91], v4 offset:0
    ds_read_b128 v[92:95], v4 offset:256
    ds_read_b64_tr_b16 v[64:65], v5 offset:0
    ds_read_b64_tr_b16 v[66:67], v5 offset:1536
    v_mfma_f32_16x16x32_bf16 v[24:27], v[68:71], v[96:99], v[24:27]
    v_mfma_f32_16x16x32_bf16 v[28:31], v[68:71], v[100:103], v[28:31]
    ds_read_b64_tr_b16 v[68:69], v120 offset:0
    ds_read_b64_tr_b16 v[70:71], v120 offset:1536
    s_add_u32 m0, s42, 61440
    s_nop 0
    buffer_load_dwordx4 v7, s[8:11], s44 offen lds
    s_add_u32 m0, s42, 62464
    s_nop 0
    buffer_load_dwordx4 v8, s[8:11], s44 offen lds
    v_mfma_f32_16x16x32_bf16 v[32:35], v[72:75], v[96:99], v[32:35]
    v_mfma_f32_16x16x32_bf16 v[36:39], v[72:75], v[100:103], v[36:39]
    ds_read_b64_tr_b16 v[72:73], v6 offset:32
    ds_read_b64_tr_b16 v[74:75], v6 offset:1568
    v_mfma_f32_16x16x32_bf16 v[40:43], v[76:79], v[96:99], v[40:43]
    v_mfma_f32_16x16x32_bf16 v[44:47], v[76:79], v[100:103], v[44:47]
    ds_read_b64_tr_b16 v[76:77], v121 offset:32
    ds_read_b64_tr_b16 v[78:79], v121 offset:1568
    s_add_u32 m0, s42, 63488
    s_nop 0
    buffer_load_dwordx4 v9, s[8:11], s44 offen lds
    s_add_u32 s44, s44, 98304
    s_cmp_eq_u32 s44, 1966080
    s_cselect_b32 s44, 0, s44
    v_mfma_f32_16x16x32_bf16 v[48:51], v[80:83], v[96:99], v[48:51]
    v_mfma_f32_16x16x32_bf16 v[52:55], v[80:83], v[100:103], v[52:55]
    ds_read_b64_tr_b16 v[80:81], v5 offset:64
    ds_read_b64_tr_b16 v[82:83], v5 offset:1600
    v_mfma_f32_16x16x32_bf16 v[56:59], v[84:87], v[96:99], v[56:59]
    v_mfma_f32_16x16x32_bf16 v[60:63], v[84:87], v[100:103], v[60:63]
    ds_read_b64_tr_b16 v[84:85], v120 offset:64
    ds_read_b64_tr_b16 v[86:87], v120 offset:1600
    s_waitcnt lgkmcnt(0)
    v_mfma_f32_16x16x32_bf16 v[16:19], v[64:67], v[88:91], v[16:19]
    v_mfma_f32_16x16x32_bf16 v[20:23], v[64:67], v[92:95], v[20:23]
    s_waitcnt vmcnt(6)
    s_barrier
    ds_read_b128 v[96:99], v4 offset:20480
    ds_read_b128 v[100:103], v4 offset:20736
    ds_read_b64_tr_b16 v[64:65], v5 offset:20480
    ds_read_b64_tr_b16 v[66:67], v5 offset:22016
    v_mfma_f32_16x16x32_bf16 v[24:27], v[68:71], v[88:91], v[24:27]
    v_mfma_f32_16x16x32_bf16 v[28:31], v[68:71], v[92:95], v[28:31]
    ds_read_b64_tr_b16 v[68:69], v120 offset:20480
    ds_read_b64_tr_b16 v[70:71], v120 offset:22016
    s_add_u32 m0, s42, 0
    s_nop 0
    buffer_load_dwordx4 v7, s[8:11], s44 offen lds
    s_add_u32 m0, s42, 1024
    s_nop 0
    buffer_load_dwordx4 v8, s[8:11], s44 offen lds
    v_mfma_f32_16x16x32_bf16 v[32:35], v[72:75], v[88:91], v[32:35]
    v_mfma_f32_16x16x32_bf16 v[36:39], v[72:75], v[92:95], v[36:39]
    ds_read_b64_tr_b16 v[72:73], v6 offset:20512
    ds_read_b64_tr_b16 v[74:75], v6 offset:22048
    v_mfma_f32_16x16x32_bf16 v[40:43], v[76:79], v[88:91], v[40:43]
    v_mfma_f32_16x16x32_bf16 v[44:47], v[76:79], v[92:95], v[44:47]
    ds_read_b64_tr_b16 v[76:77], v121 offset:20512
    ds_read_b64_tr_b16 v[78:79], v121 offset:22048
    s_add_u32 m0, s42, 2048
    s_nop 0
    buffer_load_dwordx4 v9, s[8:11], s44 offen lds
    s_add_u32 s44, s44, 98304
    s_cmp_eq_u32 s44, 1966080
    s_cselect_b32 s44, 0, s44
    v_mfma_f32_16x16x32_bf16 v[48:51], v[80:83], v[88:91], v[48:51]
    v_mfma_f32_16x16x32_bf16 v[52:55], v[80:83], v[92:95], v[52:55]
    ds_read_b64_tr_b16 v[80:81], v5 offset:20544
    ds_read_b64_tr_b16 v[82:83], v5 offset:22080
    v_mfma_f32_16x16x32_bf16 v[56:59], v[84:87], v[88:91], v[56:59]
    v_mfma_f32_16x16x32_bf16 v[60:63], v[84:87], v[92:95], v[60:63]
    ds_read_b64_tr_b16 v[84:85], v120 offset:20544
    ds_read_b64_tr_b16 v[86:87], v120 offset:22080
    s_waitcnt lgkmcnt(0)
    v_mfma_f32_16x16x32_bf16 v[16:19], v[64:67], v[96:99], v[16:19]
    v_mfma_f32_16x16x32_bf16 v[20:23], v[64:67], v[100:103], v[20:23]
    s_waitcnt vmcnt(6)
    s_barrier
    ds_read_b128 v[88:91], v4 offset:40960
    ds_read_b128 v[92:95], v4 offset:41216
    ds_read_b64_tr_b16 v[64:65], v5 offset:40960
    ds_read_b64_tr_b16 v[66:67], v5 offset:42496
    v_mfma_f32_16x16x32_bf16 v[24:27], v[68:71], v[96:99], v[24:27]
    v_mfma_f32_16x16x32_bf16 v[28:31], v[68:71], v[100:103], v[28:31]
    ds_read_b64_tr_b16 v[68:69], v120 offset:40960
    ds_read_b64_tr_b16 v[70:71], v120 offset:42496
    s_add_u32 m0, s42, 20480
    s_nop 0
    buffer_load_dwordx4 v7, s[8:11], s44 offen lds
    s_add_u32 m0, s42, 21504
    s_nop 0
    buffer_load_dwordx4 v8, s[8:11], s44 offen lds
    v_mfma_f32_16x16x32_bf16 v[32:35], v[72:75], v[96:99], v[32:35]
    v_mfma_f32_16x16x32_bf16 v[36:39], v[72:75], v[100:103], v[36:39]
    ds_read_b64_tr_b16 v[72:73], v6 offset:40992
    ds_read_b64_tr_b16 v[74:75], v6 offset:42528
    v_mfma_f32_16x16x32_bf16 v[40:43], v[76:79], v[96:99], v[40:43]
    v_mfma_f32_16x16x32_bf16 v[44:47], v[76:79], v[100:103], v[44:47]
    ds_read_b64_tr_b16 v[76:77], v121 offset:40992
    ds_read_b64_tr_b16 v[78:79], v121 offset:42528
    s_add_u32 m0, s42, 22528
    s_nop 0
    buffer_load_dwordx4 v9, s[8:11], s44 offen lds
    s_add_u32 s44, s44, 98304
    s_cmp_eq_u32 s44, 1966080
    s_cselect_b32 s44, 0, s44
    v_mfma_f32_16x16x32_bf16 v[48:51], v[80:83], v[96:99], v[48:51]
    v_mfma_f32_16x16x32_bf16 v[52:55], v[80:83], v[100:103], v[52:55]
    ds_read_b64_tr_b16 v[80:81], v5 offset:41024
    ds_read_b64_tr_b16 v[82:83], v5 offset:42560
    v_mfma_f32_16x16x32_bf16 v[56:59], v[84:87], v[96:99], v[56:59]
    v_mfma_f32_16x16x32_bf16 v[60:63], v[84:87], v[100:103], v[60:63]
    ds_read_b64_tr_b16 v[84:85], v120 offset:41024
    ds_read_b64_tr_b16 v[86:87], v120 offset:42560
    s_waitcnt lgkmcnt(0)
    v_mfma_f32_16x16x32_bf16 v[16:19], v[64:67], v[88:91], v[16:19]
    v_mfma_f32_16x16x32_bf16 v[20:23], v[64:67], v[92:95], v[20:23]
    s_waitcnt vmcnt(6)
    s_barrier
    ds_read_b128 v[96:99], v4 offset:61440
    ds_read_b128 v[100:103], v4 offset:61696
    ds_read_b64_tr_b16 v[64:65], v5 offset:61440
    ds_read_b64_tr_b16 v[66:67], v5 offset:62976
    v_mfma_f32_16x16x32_bf16 v[24:27], v[68:71], v[88:91], v[24:27]
    v_mfma_f32_16x16x32_bf16 v[28:31], v[68:71], v[92:95], v[28:31]
    ds_read_b64_tr_b16 v[68:69], v120 offset:61440
    ds_read_b64_tr_b16 v[70:71], v120 offset:62976
    s_add_u32 m0, s42, 40960
    s_nop 0
    buffer_load_dwordx4 v7, s[8:11], s44 offen lds
    s_add_u32 m0, s42, 41984
    s_nop 0
    buffer_load_dwordx4 v8, s[8:11], s44 offen lds
    v_mfma_f32_16x16x32_bf16 v[32:35], v[72:75], v[88:91], v[32:35]
    v_mfma_f32_16x16x32_bf16 v[36:39], v[72:75], v[92:95], v[36:39]
    ds_read_b64_tr_b16 v[72:73], v6 offset:61472
    ds_read_b64_tr_b16 v[74:75], v6 offset:63008
    v_mfma_f32_16x16x32_bf16 v[40:43], v[76:79], v[88:91], v[40:43]
    v_mfma_f32_16x16x32_bf16 v[44:47], v[76:79], v[92:95], v[44:47]
    ds_read_b64_tr_b16 v[76:77], v121 offset:61472
    ds_read_b64_tr_b16 v[78:79], v121 offset:63008
    s_add_u32 m0, s42, 43008
    s_nop 0
    buffer_load_dwordx4 v9, s[8:11], s44 offen lds
    s_add_u32 s44, s44, 98304
    s_cmp_eq_u32 s44, 1966080
    s_cselect_b32 s44, 0, s44
    v_mfma_f32_16x16x32_bf16 v[48:51], v[80:83], v[88:91], v[48:51]
    v_mfma_f32_16x16x32_bf16 v[52:55], v[80:83], v[92:95], v[52:55]
    ds_read_b64_tr_b16 v[80:81], v5 offset:61504
    ds_read_b64_tr_b16 v[82:83], v5 offset:63040
    v_mfma_f32_16x16x32_bf16 v[56:59], v[84:87], v[88:91], v[56:59]
    v_mfma_f32_16x16x32_bf16 v[60:63], v[84:87], v[92:95], v[60:63]
    ds_read_b64_tr_b16 v[84:85], v120 offset:61504
    ds_read_b64_tr_b16 v[86:87], v120 offset:63040
    s_waitcnt lgkmcnt(0)
    v_mfma_f32_16x16x32_bf16 v[16:19], v[64:67], v[96:99], v[16:19]
    v_mfma_f32_16x16x32_bf16 v[20:23], v[64:67], v[100:103], v[20:23]
    s_waitcnt vmcnt(6)
    s_barrier
    ds_read_b128 v[88:91], v4 offset:0
    ds_read_b128 v[92:95], v4 offset:256
    ds_read_b64_tr_b16 v[64:65], v5 offset:0
    ds_read_b64_tr_b16 v[66:67], v5 offset:1536
    v_mfma_f32_16x16x32_bf16 v[24:27], v[68:71], v[96:99], v[24:27]
    v_mfma_f32_16x16x32_bf16 v[28:31], v[68:71], v[100:103], v[28:31]
    ds_read_b64_tr_b16 v[68:69], v120 offset:0
    ds_read_b64_tr_b16 v[70:71], v120 offset:1536
    s_add_u32 m0, s42, 61440
    s_nop 0
    buffer_load_dwordx4 v7, s[8:11], s44 offen lds
    s_add_u32 m0, s42, 62464
    s_nop 0
    buffer_load_dwordx4 v8, s[8:11], s44 offen lds
    v_mfma_f32_16x16x32_bf16 v[32:35], v[72:75], v[96:99], v[32:35]
    v_mfma_f32_16x16x32_bf16 v[36:39], v[72:75], v[100:103], v[36:39]
    ds_read_b64_tr_b16 v[72:73], v6 offset:32
    ds_read_b64_tr_b16 v[74:75], v6 offset:1568
    v_mfma_f32_16x16x32_bf16 v[40:43], v[76:79], v[96:99], v[40:43]
    v_mfma_f32_16x16x32_bf16 v[44:47], v[76:79], v[100:103], v[44:47]
    ds_read_b64_tr_b16 v[76:77], v121 offset:32
    ds_read_b64_tr_b16 v[78:79], v121 offset:1568
    s_add_u32 m0, s42, 63488
    s_nop 0
    buffer_load_dwordx4 v9, s[8:11], s44 offen lds
    s_add_u32 s44, s44, 98304
    s_cmp_eq_u32 s44, 1966080
    s_cselect_b32 s44, 0, s44
    v_mfma_f32_16x16x32_bf16 v[48:51], v[80:83], v[96:99], v[48:51]
    v_mfma_f32_16x16x32_bf16 v[52:55], v[80:83], v[100:103], v[52:55]
    ds_read_b64_tr_b16 v[80:81], v5 offset:64
    ds_read_b64_tr_b16 v[82:83], v5 offset:1600
    v_mfma_f32_16x16x32_bf16 v[56:59], v[84:87], v[96:99], v[56:59]
    v_mfma_f32_16x16x32_bf16 v[60:63], v[84:87], v[100:103], v[60:63]
    ds_read_b64_tr_b16 v[84:85], v120 offset:64
    ds_read_b64_tr_b16 v[86:87], v120 offset:1600
    buffer_load_dwordx4 v[104:107], v122, s[20:23], s72 offen
    s_mov_b64 exec, 0xffff
    buffer_load_dwordx4 v[116:119], v123, s[20:23], s72 offen
    s_mov_b64 exec, -1
    s_waitcnt lgkmcnt(0)
    v_mfma_f32_16x16x32_bf16 v[16:19], v[64:67], v[88:91], v[16:19]
    v_mfma_f32_16x16x32_bf16 v[20:23], v[64:67], v[92:95], v[20:23]
    s_waitcnt vmcnt(8)
    s_barrier
    ds_read_b128 v[96:99], v4 offset:20480
    ds_read_b128 v[100:103], v4 offset:20736
    ds_read_b64_tr_b16 v[64:65], v5 offset:20480
    ds_read_b64_tr_b16 v[66:67], v5 offset:22016
    v_mfma_f32_16x16x32_bf16 v[24:27], v[68:71], v[88:91], v[24:27]
    v_mfma_f32_16x16x32_bf16 v[28:31], v[68:71], v[92:95], v[28:31]
    ds_read_b64_tr_b16 v[68:69], v120 offset:20480
    ds_read_b64_tr_b16 v[70:71], v120 offset:22016
    s_add_u32 m0, s42, 0
    s_nop 0
    buffer_load_dwordx4 v7, s[8:11], s44 offen lds
    s_add_u32 m0, s42, 1024
    s_nop 0
    buffer_load_dwordx4 v8, s[8:11], s44 offen lds
    v_mfma_f32_16x16x32_bf16 v[32:35], v[72:75], v[88:91], v[32:35]
    v_mfma_f32_16x16x32_bf16 v[36:39], v[72:75], v[92:95], v[36:39]
    ds_read_b64_tr_b16 v[72:73], v6 offset:20512
    ds_read_b64_tr_b16 v[74:75], v6 offset:22048
    v_mfma_f32_16x16x32_bf16 v[40:43], v[76:79], v[88:91], v[40:43]
    v_mfma_f32_16x16x32_bf16 v[44:47], v[76:79], v[92:95], v[44:47]
    ds_read_b64_tr_b16 v[76:77], v121 offset:20512
    ds_read_b64_tr_b16 v[78:79], v121 offset:22048
    s_add_u32 m0, s42, 2048
    s_nop 0
    buffer_load_dwordx4 v9, s[8:11], s44 offen lds
    s_add_u32 s44, s44, 98304
    s_cmp_eq_u32 s44, 1966080
    s_cselect_b32 s44, 0, s44
    v_mfma_f32_16x16x32_bf16 v[48:51], v[80:83], v[88:91], v[48:51]
    v_mfma_f32_16x16x32_bf16 v[52:55], v[80:83], v[92:95], v[52:55]
    ds_read_b64_tr_b16 v[80:81], v5 offset:20544
    ds_read_b64_tr_b16 v[82:83], v5 offset:22080
    v_mfma_f32_16x16x32_bf16 v[56:59], v[84:87], v[88:91], v[56:59]
    v_mfma_f32_16x16x32_bf16 v[60:63], v[84:87], v[92:95], v[60:63]
    ds_read_b64_tr_b16 v[84:85], v120 offset:20544
    ds_read_b64_tr_b16 v[86:87], v120 offset:22080
    s_waitcnt lgkmcnt(0)
    v_mfma_f32_16x16x32_bf16 v[16:19], v[64:67], v[96:99], v[16:19]
    v_mfma_f32_16x16x32_bf16 v[20:23], v[64:67], v[100:103], v[20:23]
    s_waitcnt vmcnt(8)
    s_barrier
    ds_read_b128 v[88:91], v4 offset:40960
    ds_read_b128 v[92:95], v4 offset:41216
    ds_read_b64_tr_b16 v[64:65], v5 offset:40960
    ds_read_b64_tr_b16 v[66:67], v5 offset:42496
    v_mfma_f32_16x16x32_bf16 v[24:27], v[68:71], v[96:99], v[24:27]
    v_mfma_f32_16x16x32_bf16 v[28:31], v[68:71], v[100:103], v[28:31]
    ds_read_b64_tr_b16 v[68:69], v120 offset:40960
    ds_read_b64_tr_b16 v[70:71], v120 offset:42496
    s_add_u32 m0, s42, 20480
    s_nop 0
    buffer_load_dwordx4 v7, s[8:11], s44 offen lds
    s_add_u32 m0, s42, 21504
    s_nop 0
    buffer_load_dwordx4 v8, s[8:11], s44 offen lds
    v_mfma_f32_16x16x32_bf16 v[32:35], v[72:75], v[96:99], v[32:35]
    v_mfma_f32_16x16x32_bf16 v[36:39], v[72:75], v[100:103], v[36:39]
    ds_read_b64_tr_b16 v[72:73], v6 offset:40992
    ds_read_b64_tr_b16 v[74:75], v6 offset:42528
    v_mfma_f32_16x16x32_bf16 v[40:43], v[76:79], v[96:99], v[40:43]
    v_mfma_f32_16x16x32_bf16 v[44:47], v[76:79], v[100:103], v[44:47]
    ds_read_b64_tr_b16 v[76:77], v121 offset:40992
    ds_read_b64_tr_b16 v[78:79], v121 offset:42528
    s_add_u32 m0, s42, 22528
    s_nop 0
    buffer_load_dwordx4 v9, s[8:11], s44 offen lds
    s_add_u32 s44, s44, 98304
    s_cmp_eq_u32 s44, 1966080
    s_cselect_b32 s44, 0, s44
    v_mfma_f32_16x16x32_bf16 v[48:51], v[80:83], v[96:99], v[48:51]
    v_mfma_f32_16x16x32_bf16 v[52:55], v[80:83], v[100:103], v[52:55]
    ds_read_b64_tr_b16 v[80:81], v5 offset:41024
    ds_read_b64_tr_b16 v[82:83], v5 offset:42560
    v_mfma_f32_16x16x32_bf16 v[56:59], v[84:87], v[96:99], v[56:59]
    v_mfma_f32_16x16x32_bf16 v[60:63], v[84:87], v[100:103], v[60:63]
    ds_read_b64_tr_b16 v[84:85], v120 offset:41024
    ds_read_b64_tr_b16 v[86:87], v120 offset:42560
    s_waitcnt lgkmcnt(0)
    v_mfma_f32_16x16x32_bf16 v[16:19], v[64:67], v[88:91], v[16:19]
    v_mfma_f32_16x16x32_bf16 v[20:23], v[64:67], v[92:95], v[20:23]
    s_waitcnt vmcnt(8)
    s_barrier
    ds_read_b128 v[96:99], v4 offset:61440
    ds_read_b128 v[100:103], v4 offset:61696
    ds_read_b64_tr_b16 v[64:65], v5 offset:61440
    ds_read_b64_tr_b16 v[66:67], v5 offset:62976
    v_mfma_f32_16x16x32_bf16 v[24:27], v[68:71], v[88:91], v[24:27]
    v_mfma_f32_16x16x32_bf16 v[28:31], v[68:71], v[92:95], v[28:31]
    ds_read_b64_tr_b16 v[68:69], v120 offset:61440
    ds_read_b64_tr_b16 v[70:71], v120 offset:62976
    s_add_u32 m0, s42, 40960
    s_nop 0
    buffer_load_dwordx4 v7, s[8:11], s44 offen lds
    s_add_u32 m0, s42, 41984
    s_nop 0
    buffer_load_dwordx4 v8, s[8:11], s44 offen lds
    v_mfma_f32_16x16x32_bf16 v[32:35], v[72:75], v[88:91], v[32:35]
    v_mfma_f32_16x16x32_bf16 v[36:39], v[72:75], v[92:95], v[36:39]
    ds_read_b64_tr_b16 v[72:73], v6 offset:61472
    ds_read_b64_tr_b16 v[74:75], v6 offset:63008
    v_mfma_f32_16x16x32_bf16 v[40:43], v[76:79], v[88:91], v[40:43]
    v_mfma_f32_16x16x32_bf16 v[44:47], v[76:79], v[92:95], v[44:47]
    ds_read_b64_tr_b16 v[76:77], v121 offset:61472
    ds_read_b64_tr_b16 v[78:79], v121 offset:63008
    s_add_u32 m0, s42, 43008
    s_nop 0
    buffer_load_dwordx4 v9, s[8:11], s44 offen lds
    s_add_u32 s44, s44, 98304
    s_cmp_eq_u32 s44, 1966080
    s_cselect_b32 s44, 0, s44
    v_mfma_f32_16x16x32_bf16 v[48:51], v[80:83], v[88:91], v[48:51]
    v_mfma_f32_16x16x32_bf16 v[52:55], v[80:83], v[92:95], v[52:55]
    ds_read_b64_tr_b16 v[80:81], v5 offset:61504
    ds_read_b64_tr_b16 v[82:83], v5 offset:63040
    v_mfma_f32_16x16x32_bf16 v[56:59], v[84:87], v[88:91], v[56:59]
    v_mfma_f32_16x16x32_bf16 v[60:63], v[84:87], v[92:95], v[60:63]
    ds_read_b64_tr_b16 v[84:85], v120 offset:61504
    ds_read_b64_tr_b16 v[86:87], v120 offset:63040
    s_waitcnt vmcnt(9)
    buffer_store_dwordx4 v[104:107], v2, s[24:27], s73 offen sc1
    s_mov_b64 exec, 0xffff
    buffer_store_dwordx4 v[116:119], v2, s[24:27], s73 offen offset:1024 sc1
    s_mov_b64 exec, -1
    s_waitcnt lgkmcnt(0)
    v_mfma_f32_16x16x32_bf16 v[16:19], v[64:67], v[96:99], v[16:19]
    v_mfma_f32_16x16x32_bf16 v[20:23], v[64:67], v[100:103], v[20:23]
    s_waitcnt vmcnt(8)
    s_barrier
    ds_read_b128 v[88:91], v4 offset:0
    ds_read_b128 v[92:95], v4 offset:256
    ds_read_b64_tr_b16 v[64:65], v5 offset:0
    ds_read_b64_tr_b16 v[66:67], v5 offset:1536
    v_mfma_f32_16x16x32_bf16 v[24:27], v[68:71], v[96:99], v[24:27]
    v_mfma_f32_16x16x32_bf16 v[28:31], v[68:71], v[100:103], v[28:31]
    ds_read_b64_tr_b16 v[68:69], v120 offset:0
    ds_read_b64_tr_b16 v[70:71], v120 offset:1536
    s_add_u32 m0, s42, 61440
    s_nop 0
    buffer_load_dwordx4 v7, s[8:11], s44 offen lds
    s_add_u32 m0, s42, 62464
    s_nop 0
    buffer_load_dwordx4 v8, s[8:11], s44 offen lds
    v_mfma_f32_16x16x32_bf16 v[32:35], v[72:75], v[96:99], v[32:35]
    v_mfma_f32_16x16x32_bf16 v[36:39], v[72:75], v[100:103], v[36:39]
    ds_read_b64_tr_b16 v[72:73], v6 offset:32
    ds_read_b64_tr_b16 v[74:75], v6 offset:1568
    v_mfma_f32_16x16x32_bf16 v[40:43], v[76:79], v[96:99], v[40:43]
    v_mfma_f32_16x16x32_bf16 v[44:47], v[76:79], v[100:103], v[44:47]
    ds_read_b64_tr_b16 v[76:77], v121 offset:32
    ds_read_b64_tr_b16 v[78:79], v121 offset:1568
    s_add_u32 m0, s42, 63488
    s_nop 0
    buffer_load_dwordx4 v9, s[8:11], s44 offen lds
    s_add_u32 s44, s44, 98304
    s_cmp_eq_u32 s44, 1966080
    s_cselect_b32 s44, 0, s44
    v_mfma_f32_16x16x32_bf16 v[48:51], v[80:83], v[96:99], v[48:51]
    v_mfma_f32_16x16x32_bf16 v[52:55], v[80:83], v[100:103], v[52:55]
    ds_read_b64_tr_b16 v[80:81], v5 offset:64
    ds_read_b64_tr_b16 v[82:83], v5 offset:1600
    v_mfma_f32_16x16x32_bf16 v[56:59], v[84:87], v[96:99], v[56:59]
    v_mfma_f32_16x16x32_bf16 v[60:63], v[84:87], v[100:103], v[60:63]
    ds_read_b64_tr_b16 v[84:85], v120 offset:64
    ds_read_b64_tr_b16 v[86:87], v120 offset:1600
    s_waitcnt lgkmcnt(0)
    v_mfma_f32_16x16x32_bf16 v[16:19], v[64:67], v[88:91], v[16:19]
    v_mfma_f32_16x16x32_bf16 v[20:23], v[64:67], v[92:95], v[20:23]
    s_waitcnt vmcnt(8)
    s_barrier
    ds_read_b128 v[96:99], v4 offset:20480
    ds_read_b128 v[100:103], v4 offset:20736
    ds_read_b64_tr_b16 v[64:65], v5 offset:20480
    ds_read_b64_tr_b16 v[66:67], v5 offset:22016
    v_mfma_f32_16x16x32_bf16 v[24:27], v[68:71], v[88:91], v[24:27]
    v_mfma_f32_16x16x32_bf16 v[28:31], v[68:71], v[92:95], v[28:31]
    ds_read_b64_tr_b16 v[68:69], v120 offset:20480
    ds_read_b64_tr_b16 v[70:71], v120 offset:22016
    v_mfma_f32_16x16x32_bf16 v[32:35], v[72:75], v[88:91], v[32:35]
    v_mfma_f32_16x16x32_bf16 v[36:39], v[72:75], v[92:95], v[36:39]
    ds_read_b64_tr_b16 v[72:73], v6 offset:20512
    ds_read_b64_tr_b16 v[74:75], v6 offset:22048
    v_mfma_f32_16x16x32_bf16 v[40:43], v[76:79], v[88:91], v[40:43]
    v_mfma_f32_16x16x32_bf16 v[44:47], v[76:79], v[92:95], v[44:47]
    ds_read_b64_tr_b16 v[76:77], v121 offset:20512
    ds_read_b64_tr_b16 v[78:79], v121 offset:22048
    v_mfma_f32_16x16x32_bf16 v[48:51], v[80:83], v[88:91], v[48:51]
    v_mfma_f32_16x16x32_bf16 v[52:55], v[80:83], v[92:95], v[52:55]
    ds_read_b64_tr_b16 v[80:81], v5 offset:20544
    ds_read_b64_tr_b16 v[82:83], v5 offset:22080
    v_mfma_f32_16x16x32_bf16 v[56:59], v[84:87], v[88:91], v[56:59]
    v_mfma_f32_16x16x32_bf16 v[60:63], v[84:87], v[92:95], v[60:63]
    ds_read_b64_tr_b16 v[84:85], v120 offset:20544
    ds_read_b64_tr_b16 v[86:87], v120 offset:22080
    s_waitcnt lgkmcnt(0)
    v_mfma_f32_16x16x32_bf16 v[16:19], v[64:67], v[96:99], v[16:19]
    v_mfma_f32_16x16x32_bf16 v[20:23], v[64:67], v[100:103], v[20:23]
    s_waitcnt vmcnt(5)
    s_barrier
    ds_read_b128 v[88:91], v4 offset:40960
    ds_read_b128 v[92:95], v4 offset:41216
    ds_read_b64_tr_b16 v[64:65], v5 offset:40960
    ds_read_b64_tr_b16 v[66:67], v5 offset:42496
    v_mfma_f32_16x16x32_bf16 v[24:27], v[68:71], v[96:99], v[24:27]
    v_mfma_f32_16x16x32_bf16 v[28:31], v[68:71], v[100:103], v[28:31]
    ds_read_b64_tr_b16 v[68:69], v120 offset:40960
    ds_read_b64_tr_b16 v[70:71], v120 offset:42496
    v_mfma_f32_16x16x32_bf16 v[32:35], v[72:75], v[96:99], v[32:35]
    v_mfma_f32_16x16x32_bf16 v[36:39], v[72:75], v[100:103], v[36:39]
    ds_read_b64_tr_b16 v[72:73], v6 offset:40992
    ds_read_b64_tr_b16 v[74:75], v6 offset:42528
    v_mfma_f32_16x16x32_bf16 v[40:43], v[76:79], v[96:99], v[40:43]
    v_mfma_f32_16x16x32_bf16 v[44:47], v[76:79], v[100:103], v[44:47]
    ds_read_b64_tr_b16 v[76:77], v121 offset:40992
    ds_read_b64_tr_b16 v[78:79], v121 offset:42528
    v_mfma_f32_16x16x32_bf16 v[48:51], v[80:83], v[96:99], v[48:51]
    v_mfma_f32_16x16x32_bf16 v[52:55], v[80:83], v[100:103], v[52:55]
    ds_read_b64_tr_b16 v[80:81], v5 offset:41024
    ds_read_b64_tr_b16 v[82:83], v5 offset:42560
    v_mfma_f32_16x16x32_bf16 v[56:59], v[84:87], v[96:99], v[56:59]
    v_mfma_f32_16x16x32_bf16 v[60:63], v[84:87], v[100:103], v[60:63]
    ds_read_b64_tr_b16 v[84:85], v120 offset:41024
    ds_read_b64_tr_b16 v[86:87], v120 offset:42560
    s_waitcnt vmcnt(3)
    s_waitcnt lgkmcnt(0)
    v_mfma_f32_16x16x32_bf16 v[16:19], v[64:67], v[88:91], v[16:19]
    v_mfma_f32_16x16x32_bf16 v[20:23], v[64:67], v[92:95], v[20:23]
    s_waitcnt vmcnt(0)
    s_barrier
    ds_read_b128 v[96:99], v4 offset:61440
    ds_read_b128 v[100:103], v4 offset:61696
    ds_read_b64_tr_b16 v[64:65], v5 offset:61440
    ds_read_b64_tr_b16 v[66:67], v5 offset:62976
    v_mfma_f32_16x16x32_bf16 v[24:27], v[68:71], v[88:91], v[24:27]
    v_mfma_f32_16x16x32_bf16 v[28:31], v[68:71], v[92:95], v[28:31]
    ds_read_b64_tr_b16 v[68:69], v120 offset:61440
    ds_read_b64_tr_b16 v[70:71], v120 offset:62976
    v_mfma_f32_16x16x32_bf16 v[32:35], v[72:75], v[88:91], v[32:35]
    v_mfma_f32_16x16x32_bf16 v[36:39], v[72:75], v[92:95], v[36:39]
    ds_read_b64_tr_b16 v[72:73], v6 offset:61472
    ds_read_b64_tr_b16 v[74:75], v6 offset:63008
    v_mfma_f32_16x16x32_bf16 v[40:43], v[76:79], v[88:91], v[40:43]
    v_mfma_f32_16x16x32_bf16 v[44:47], v[76:79], v[92:95], v[44:47]
    ds_read_b64_tr_b16 v[76:77], v121 offset:61472
    ds_read_b64_tr_b16 v[78:79], v121 offset:63008
    v_mfma_f32_16x16x32_bf16 v[48:51], v[80:83], v[88:91], v[48:51]
    v_mfma_f32_16x16x32_bf16 v[52:55], v[80:83], v[92:95], v[52:55]
    ds_read_b64_tr_b16 v[80:81], v5 offset:61504
    ds_read_b64_tr_b16 v[82:83], v5 offset:63040
    v_mfma_f32_16x16x32_bf16 v[56:59], v[84:87], v[88:91], v[56:59]
    v_mfma_f32_16x16x32_bf16 v[60:63], v[84:87], v[92:95], v[60:63]
    ds_read_b64_tr_b16 v[84:85], v120 offset:61504
    ds_read_b64_tr_b16 v[86:87], v120 offset:63040
    s_cmp_lg_u32 s4, 0
    s_cbranch_scc1 L_pkf_14_para
    s_add_u32 s78, s5, 512
    s_lshl_b32 s78, s78, 7
    v_mov_b32 v104, s6
    v_mov_b32 v105, s7
    v_mov_b32 v106, 0
    s_mov_b64 exec, 1
    buffer_store_dwordx2 v[104:105], v106, s[28:31], s78 offen sc1
    s_mov_b64 exec, -1
L_pkf_14_para:
    s_waitcnt lgkmcnt(0)
    v_mfma_f32_16x16x32_bf16 v[16:19], v[64:67], v[96:99], v[16:19]
    v_mfma_f32_16x16x32_bf16 v[20:23], v[64:67], v[100:103], v[20:23]
    v_mfma_f32_16x16x32_bf16 v[24:27], v[68:71], v[96:99], v[24:27]
    v_mfma_f32_16x16x32_bf16 v[28:31], v[68:71], v[100:103], v[28:31]
    v_mfma_f32_16x16x32_bf16 v[32:35], v[72:75], v[96:99], v[32:35]
    v_mfma_f32_16x16x32_bf16 v[36:39], v[72:75], v[100:103], v[36:39]
    v_mfma_f32_16x16x32_bf16 v[40:43], v[76:79], v[96:99], v[40:43]
    v_mfma_f32_16x16x32_bf16 v[44:47], v[76:79], v[100:103], v[44:47]
    v_mfma_f32_16x16x32_bf16 v[48:51], v[80:83], v[96:99], v[48:51]
    v_mfma_f32_16x16x32_bf16 v[52:55], v[80:83], v[100:103], v[52:55]
    v_mfma_f32_16x16x32_bf16 v[56:59], v[84:87], v[96:99], v[56:59]
    v_mfma_f32_16x16x32_bf16 v[60:63], v[84:87], v[100:103], v[60:63]
    s_mov_b32 s37, 0
    s_branch L_f1e_13_para
L_f1b_12_para:
    s_mov_b32 s8, s66
    s_mov_b32 s9, s67
    s_mov_b32 s10, 2621440
    s_mov_b32 s11, 0x00020000
    s_mul_i32 s41, s46, 40960
    s_lshl_b32 s44, s40, 11
    s_add_u32 s44, s44, s41
    s_add_u32 s47, s41, 40960
    s_lshl_b32 s78, s46, 2
    s_add_u32 s78, s78, 0
    s_lshl_b32 s78, s78, 7
    v_lshlrev_b32 v12, 7, v1
    s_mov_b32 exec_lo, 0xf
    s_mov_b32 exec_hi, 0
    s_mov_b32 s79, 100000
L_poll_15_para:
    buffer_load_dwordx2 v[10:11], v12, s[28:31], s78 offen sc1
    s_waitcnt vmcnt(0)
L_pmid_17_para:
    v_cmp_ne_u64 vcc, s[6:7], v[10:11]
    s_nop 1
    s_and_b64 exec, exec, vcc
    s_cbranch_scc0 L_polled_16_para
    s_sleep 4
    s_sub_u32 s79, s79, 1
    s_cmp_lg_u32 s79, 0
    s_cbranch_scc1 L_poll_15_para
L_polled_16_para:
    s_mov_b64 exec, -1
    s_add_u32 m0, s37, 0
    s_nop 0
    buffer_load_dwordx4 v2, s[8:11], s44 offen sc1 lds
    buffer_load_dwordx4 v2, s[8:11], s44 offen offset:1024 sc1 lds
    s_add_u32 s44, s44, 2048
    s_cmp_eq_u32 s44, s47
    s_cselect_b32 s44, s41, s44
    s_add_u32 m0, s37, 20480
    s_nop 0
    buffer_load_dwordx4 v2, s[8:11], s44 offen sc1 lds
    buffer_load_dwordx4 v2, s[8:11], s44 offen offset:1024 sc1 lds
    s_add_u32 s44, s44, 2048
    s_cmp_eq_u32 s44, s47
    s_cselect_b32 s44, s41, s44
    s_add_u32 m0, s37, 40960
    s_nop 0
    buffer_load_dwordx4 v2, s[8:11], s44 offen sc1 lds
    buffer_load_dwordx4 v2, s[8:11], s44 offen offset:1024 sc1 lds
    s_add_u32 s44, s44, 2048
    s_cmp_eq_u32 s44, s47
    s_cselect_b32 s44, s41, s44
    s_add_u32 m0, s37, 61440
    s_nop 0
    buffer_load_dwordx4 v2, s[8:11], s44 offen sc1 lds
    buffer_load_dwordx4 v2, s[8:11], s44 offen offset:1024 sc1 lds
    s_add_u32 s44, s44, 2048
    s_cmp_eq_u32 s44, s47
    s_cselect_b32 s44, s41, s44
    s_waitcnt vmcnt(6)
    s_barrier
    ds_read_b128 v[88:91], v4 offset:0
    ds_read_b128 v[92:95], v4 offset:256
    ds_read_b64_tr_b16 v[64:65], v6 offset:96
    ds_read_b64_tr_b16 v[66:67], v6 offset:1632
    ds_read_b64_tr_b16 v[68:69], v121 offset:96
    ds_read_b64_tr_b16 v[70:71], v121 offset:1632
    ds_read_b64_tr_b16 v[72:73], v5 offset:128
    ds_read_b64_tr_b16 v[74:75], v5 offset:1664
    ds_read_b64_tr_b16 v[76:77], v120 offset:128
    ds_read_b64_tr_b16 v[78:79], v120 offset:1664
    ds_read_b64_tr_b16 v[80:81], v6 offset:160
    ds_read_b64_tr_b16 v[82:83], v6 offset:1696
    ds_read_b64_tr_b16 v[84:85], v121 offset:160
    ds_read_b64_tr_b16 v[86:87], v121 offset:1696
    s_waitcnt lgkmcnt(0)
    v_mfma_f32_16x16x32_bf16 v[16:19], v[64:67], v[88:91], 0
    v_mfma_f32_16x16x32_bf16 v[20:23], v[64:67], v[92:95], 0
    s_waitcnt vmcnt(4)
    s_barrier
    ds_read_b128 v[96:99], v4 offset:20480
    ds_read_b128 v[100:103], v4 offset:20736
    ds_read_b64_tr_b16 v[64:65], v6 offset:20576
    ds_read_b64_tr_b16 v[66:67], v6 offset:22112
    v_mfma_f32_16x16x32_bf16 v[24:27], v[68:71], v[88:91], 0
    v_mfma_f32_16x16x32_bf16 v[28:31], v[68:71], v[92:95], 0
    ds_read_b64_tr_b16 v[68:69], v121 offset:20576
    ds_read_b64_tr_b16 v[70:71], v121 offset:22112
    s_add_u32 m0, s37, 0
    s_nop 0
    buffer_load_dwordx4 v2, s[8:11], s44 offen sc1 lds
    buffer_load_dwordx4 v2, s[8:11], s44 offen offset:1024 sc1 lds
    s_add_u32 s44, s44, 2048
    s_cmp_eq_u32 s44, s47
    s_cselect_b32 s44, s41, s44
    v_mfma_f32_16x16x32_bf16 v[32:35], v[72:75], v[88:91], 0
    v_mfma_f32_16x16x32_bf16 v[36:39], v[72:75], v[92:95], 0
    ds_read_b64_tr_b16 v[72:73], v5 offset:20608
    ds_read_b64_tr_b16 v[74:75], v5 offset:22144
    v_mfma_f32_16x16x32_bf16 v[40:43], v[76:79], v[88:91], 0
    v_mfma_f32_16x16x32_bf16 v[44:47], v[76:79], v[92:95], 0
    ds_read_b64_tr_b16 v[76:77], v120 offset:20608
    ds_read_b64_tr_b16 v[78:79], v120 offset:22144
    v_mfma_f32_16x16x32_bf16 v[48:51], v[80:83], v[88:91], 0
    v_mfma_f32_16x16x32_bf16 v[52:55], v[80:83], v[92:95], 0
    ds_read_b64_tr_b16 v[80:81], v6 offset:20640
    ds_read_b64_tr_b16 v[82:83], v6 offset:22176
    v_mfma_f32_16x16x32_bf16 v[56:59], v[84:87], v[88:91], 0
    v_mfma_f32_16x16x32_bf16 v[60:63], v[84:87], v[92:95], 0
    ds_read_b64_tr_b16 v[84:85], v121 offset:20640
    ds_read_b64_tr_b16 v[86:87], v121 offset:22176
    s_waitcnt lgkmcnt(0)
    v_mfma_f32_16x16x32_bf16 v[16:19], v[64:67], v[96:99], v[16:19]
    v_mfma_f32_16x16x32_bf16 v[20:23], v[64:67], v[100:103], v[20:23]
    s_waitcnt vmcnt(4)
    s_barrier
    ds_read_b128 v[88:91], v4 offset:40960
    ds_read_b128 v[92:95], v4 offset:41216
    ds_read_b64_tr_b16 v[64:65], v6 offset:41056
    ds_read_b64_tr_b16 v[66:67], v6 offset:42592
    v_mfma_f32_16x16x32_bf16 v[24:27], v[68:71], v[96:99], v[24:27]
    v_mfma_f32_16x16x32_bf16 v[28:31], v[68:71], v[100:103], v[28:31]
    ds_read_b64_tr_b16 v[68:69], v121 offset:41056
    ds_read_b64_tr_b16 v[70:71], v121 offset:42592
    s_add_u32 m0, s37, 20480
    s_nop 0
    buffer_load_dwordx4 v2, s[8:11], s44 offen sc1 lds
    buffer_load_dwordx4 v2, s[8:11], s44 offen offset:1024 sc1 lds
    s_add_u32 s44, s44, 2048
    s_cmp_eq_u32 s44, s47
    s_cselect_b32 s44, s41, s44
    v_mfma_f32_16x16x32_bf16 v[32:35], v[72:75], v[96:99], v[32:35]
    v_mfma_f32_16x16x32_bf16 v[36:39], v[72:75], v[100:103], v[36:39]
    ds_read_b64_tr_b16 v[72:73], v5 offset:41088
    ds_read_b64_tr_b16 v[74:75], v5 offset:42624
    v_mfma_f32_16x16x32_bf16 v[40:43], v[76:79], v[96:99], v[40:43]
    v_mfma_f32_16x16x32_bf16 v[44:47], v[76:79], v[100:103], v[44:47]
    ds_read_b64_tr_b16 v[76:77], v120 offset:41088
    ds_read_b64_tr_b16 v[78:79], v120 offset:42624
    v_mfma_f32_16x16x32_bf16 v[48:51], v[80:83], v[96:99], v[48:51]
    v_mfma_f32_16x16x32_bf16 v[52:55], v[80:83], v[100:103], v[52:55]
    ds_read_b64_tr_b16 v[80:81], v6 offset:41120
    ds_read_b64_tr_b16 v[82:83], v6 offset:42656
    v_mfma_f32_16x16x32_bf16 v[56:59], v[84:87], v[96:99], v[56:59]
    v_mfma_f32_16x16x32_bf16 v[60:63], v[84:87], v[100:103], v[60:63]
    ds_read_b64_tr_b16 v[84:85], v121 offset:41120
    ds_read_b64_tr_b16 v[86:87], v121 offset:42656
    s_waitcnt lgkmcnt(0)
    v_mfma_f32_16x16x32_bf16 v[16:19], v[64:67], v[88:91], v[16:19]
    v_mfma_f32_16x16x32_bf16 v[20:23], v[64:67], v[92:95], v[20:23]
    s_waitcnt vmcnt(4)
    s_barrier
    ds_read_b128 v[96:99], v4 offset:61440
    ds_read_b128 v[100:103], v4 offset:61696
    ds_read_b64_tr_b16 v[64:65], v6 offset:61536
    ds_read_b64_tr_b16 v[66:67], v6 offset:63072
    v_mfma_f32_16x16x32_bf16 v[24:27], v[68:71], v[88:91], v[24:27]
    v_mfma_f32_16x16x32_bf16 v[28:31], v[68:71], v[92:95], v[28:31]
    ds_read_b64_tr_b16 v[68:69], v121 offset:61536
    ds_read_b64_tr_b16 v[70:71], v121 offset:63072
    s_add_u32 m0, s37, 40960
    s_nop 0
    buffer_load_dwordx4 v2, s[8:11], s44 offen sc1 lds
    buffer_load_dwordx4 v2, s[8:11], s44 offen offset:1024 sc1 lds
    s_add_u32 s44, s44, 2048
    s_cmp_eq_u32 s44, s47
    s_cselect_b32 s44, s41, s44
    v_mfma_f32_16x16x32_bf16 v[32:35], v[72:75], v[88:91], v[32:35]
    v_mfma_f32_16x16x32_bf16 v[36:39], v[72:75], v[92:95], v[36:39]
    ds_read_b64_tr_b16 v[72:73], v5 offset:61568
    ds_read_b64_tr_b16 v[74:75], v5 offset:63104
    v_mfma_f32_16x16x32_bf16 v[40:43], v[76:79], v[88:91], v[40:43]
    v_mfma_f32_16x16x32_bf16 v[44:47], v[76:79], v[92:95], v[44:47]
    ds_read_b64_tr_b16 v[76:77], v120 offset:61568
    ds_read_b64_tr_b16 v[78:79], v120 offset:63104
    v_mfma_f32_16x16x32_bf16 v[48:51], v[80:83], v[88:91], v[48:51]
    v_mfma_f32_16x16x32_bf16 v[52:55], v[80:83], v[92:95], v[52:55]
    ds_read_b64_tr_b16 v[80:81], v6 offset:61600
    ds_read_b64_tr_b16 v[82:83], v6 offset:63136
    v_mfma_f32_16x16x32_bf16 v[56:59], v[84:87], v[88:91], v[56:59]
    v_mfma_f32_16x16x32_bf16 v[60:63], v[84:87], v[92:95], v[60:63]
    ds_read_b64_tr_b16 v[84:85], v121 offset:61600
    ds_read_b64_tr_b16 v[86:87], v121 offset:63136
    s_waitcnt lgkmcnt(0)
    v_mfma_f32_16x16x32_bf16 v[16:19], v[64:67], v[96:99], v[16:19]
    v_mfma_f32_16x16x32_bf16 v[20:23], v[64:67], v[100:103], v[20:23]
    s_waitcnt vmcnt(4)
    s_barrier
    ds_read_b128 v[88:91], v4 offset:0
    ds_read_b128 v[92:95], v4 offset:256
    ds_read_b64_tr_b16 v[64:65], v6 offset:96
    ds_read_b64_tr_b16 v[66:67], v6 offset:1632
    v_mfma_f32_16x16x32_bf16 v[24:27], v[68:71], v[96:99], v[24:27]
    v_mfma_f32_16x16x32_bf16 v[28:31], v[68:71], v[100:103], v[28:31]
    ds_read_b64_tr_b16 v[68:69], v121 offset:96
    ds_read_b64_tr_b16 v[70:71], v121 offset:1632
    s_add_u32 m0, s37, 61440
    s_nop 0
    buffer_load_dwordx4 v2, s[8:11], s44 offen sc1 lds
    buffer_load_dwordx4 v2, s[8:11], s44 offen offset:1024 sc1 lds
    s_add_u32 s44, s44, 2048
    s_cmp_eq_u32 s44, s47
    s_cselect_b32 s44, s41, s44
    v_mfma_f32_16x16x32_bf16 v[32:35], v[72:75], v[96:99], v[32:35]
    v_mfma_f32_16x16x32_bf16 v[36:39], v[72:75], v[100:103], v[36:39]
    ds_read_b64_tr_b16 v[72:73], v5 offset:128
    ds_read_b64_tr_b16 v[74:75], v5 offset:1664
    v_mfma_f32_16x16x32_bf16 v[40:43], v[76:79], v[96:99], v[40:43]
    v_mfma_f32_16x16x32_bf16 v[44:47], v[76:79], v[100:103], v[44:47]
    ds_read_b64_tr_b16 v[76:77], v120 offset:128
    ds_read_b64_tr_b16 v[78:79], v120 offset:1664
    v_mfma_f32_16x16x32_bf16 v[48:51], v[80:83], v[96:99], v[48:51]
    v_mfma_f32_16x16x32_bf16 v[52:55], v[80:83], v[100:103], v[52:55]
    ds_read_b64_tr_b16 v[80:81], v6 offset:160
    ds_read_b64_tr_b16 v[82:83], v6 offset:1696
    v_mfma_f32_16x16x32_bf16 v[56:59], v[84:87], v[96:99], v[56:59]
    v_mfma_f32_16x16x32_bf16 v[60:63], v[84:87], v[100:103], v[60:63]
    ds_read_b64_tr_b16 v[84:85], v121 offset:160
    ds_read_b64_tr_b16 v[86:87], v121 offset:1696
    s_waitcnt lgkmcnt(0)
    v_mfma_f32_16x16x32_bf16 v[16:19], v[64:67], v[88:91], v[16:19]
    v_mfma_f32_16x16x32_bf16 v[20:23], v[64:67], v[92:95], v[20:23]
    s_waitcnt vmcnt(4)
    s_barrier
    ds_read_b128 v[96:99], v4 offset:20480
    ds_read_b128 v[100:103], v4 offset:20736
    ds_read_b64_tr_b16 v[64:65], v6 offset:20576
    ds_read_b64_tr_b16 v[66:67], v6 offset:22112
    v_mfma_f32_16x16x32_bf16 v[24:27], v[68:71], v[88:91], v[24:27]
    v_mfma_f32_16x16x32_bf16 v[28:31], v[68:71], v[92:95], v[28:31]
    ds_read_b64_tr_b16 v[68:69], v121 offset:20576
    ds_read_b64_tr_b16 v[70:71], v121 offset:22112
    s_add_u32 m0, s37, 0
    s_nop 0
    buffer_load_dwordx4 v2, s[8:11], s44 offen sc1 lds
    buffer_load_dwordx4 v2, s[8:11], s44 offen offset:1024 sc1 lds
    s_add_u32 s44, s44, 2048
    s_cmp_eq_u32 s44, s47
    s_cselect_b32 s44, s41, s44
    v_mfma_f32_16x16x32_bf16 v[32:35], v[72:75], v[88:91], v[32:35]
    v_mfma_f32_16x16x32_bf16 v[36:39], v[72:75], v[92:95], v[36:39]
    ds_read_b64_tr_b16 v[72:73], v5 offset:20608
    ds_read_b64_tr_b16 v[74:75], v5 offset:22144
    v_mfma_f32_16x16x32_bf16 v[40:43], v[76:79], v[88:91], v[40:43]
    v_mfma_f32_16x16x32_bf16 v[44:47], v[76:79], v[92:95], v[44:47]
    ds_read_b64_tr_b16 v[76:77], v120 offset:20608
    ds_read_b64_tr_b16 v[78:79], v120 offset:22144
    v_mfma_f32_16x16x32_bf16 v[48:51], v[80:83], v[88:91], v[48:51]
    v_mfma_f32_16x16x32_bf16 v[52:55], v[80:83], v[92:95], v[52:55]
    ds_read_b64_tr_b16 v[80:81], v6 offset:20640
    ds_read_b64_tr_b16 v[82:83], v6 offset:22176
    v_mfma_f32_16x16x32_bf16 v[56:59], v[84:87], v[88:91], v[56:59]
    v_mfma_f32_16x16x32_bf16 v[60:63], v[84:87], v[92:95], v[60:63]
    ds_read_b64_tr_b16 v[84:85], v121 offset:20640
    ds_read_b64_tr_b16 v[86:87], v121 offset:22176
    s_setprio 1
    s_waitcnt lgkmcnt(0)
    v_mfma_f32_16x16x32_bf16 v[16:19], v[64:67], v[96:99], v[16:19]
    v_mfma_f32_16x16x32_bf16 v[20:23], v[64:67], v[100:103], v[20:23]
    s_waitcnt vmcnt(4)
    s_barrier
    ds_read_b128 v[88:91], v4 offset:40960
    ds_read_b128 v[92:95], v4 offset:41216
    ds_read_b64_tr_b16 v[64:65], v6 offset:41056
    ds_read_b64_tr_b16 v[66:67], v6 offset:42592
    v_mfma_f32_16x16x32_bf16 v[24:27], v[68:71], v[96:99], v[24:27]
    v_mfma_f32_16x16x32_bf16 v[28:31], v[68:71], v[100:103], v[28:31]
    ds_read_b64_tr_b16 v[68:69], v121 offset:41056
    ds_read_b64_tr_b16 v[70:71], v121 offset:42592
    s_add_u32 m0, s37, 20480
    s_nop 0
    buffer_load_dwordx4 v2, s[8:11], s44 offen sc1 lds
    buffer_load_dwordx4 v2, s[8:11], s44 offen offset:1024 sc1 lds
    s_add_u32 s44, s44, 2048
    s_cmp_eq_u32 s44, s47
    s_cselect_b32 s44, s41, s44
    v_mfma_f32_16x16x32_bf16 v[32:35], v[72:75], v[96:99], v[32:35]
    v_mfma_f32_16x16x32_bf16 v[36:39], v[72:75], v[100:103], v[36:39]
    ds_read_b64_tr_b16 v[72:73], v5 offset:41088
    ds_read_b64_tr_b16 v[74:75], v5 offset:42624
    v_mfma_f32_16x16x32_bf16 v[40:43], v[76:79], v[96:99], v[40:43]
    v_mfma_f32_16x16x32_bf16 v[44:47], v[76:79], v[100:103], v[44:47]
    ds_read_b64_tr_b16 v[76:77], v120 offset:41088
    ds_read_b64_tr_b16 v[78:79], v120 offset:42624
    v_mfma_f32_16x16x32_bf16 v[48:51], v[80:83], v[96:99], v[48:51]
    v_mfma_f32_16x16x32_bf16 v[52:55], v[80:83], v[100:103], v[52:55]
    ds_read_b64_tr_b16 v[80:81], v6 offset:41120
    ds_read_b64_tr_b16 v[82:83], v6 offset:42656
    v_mfma_f32_16x16x32_bf16 v[56:59], v[84:87], v[96:99], v[56:59]
    v_mfma_f32_16x16x32_bf16 v[60:63], v[84:87], v[100:103], v[60:63]
    ds_read_b64_tr_b16 v[84:85], v121 offset:41120
    ds_read_b64_tr_b16 v[86:87], v121 offset:42656
    s_waitcnt lgkmcnt(0)
    v_mfma_f32_16x16x32_bf16 v[16:19], v[64:67], v[88:91], v[16:19]
    v_mfma_f32_16x16x32_bf16 v[20:23], v[64:67], v[92:95], v[20:23]
    s_waitcnt vmcnt(4)
    s_barrier
    ds_read_b128 v[96:99], v4 offset:61440
    ds_read_b128 v[100:103], v4 offset:61696
    ds_read_b64_tr_b16 v[64:65], v6 offset:61536
    ds_read_b64_tr_b16 v[66:67], v6 offset:63072
    v_mfma_f32_16x16x32_bf16 v[24:27], v[68:71], v[88:91], v[24:27]
    v_mfma_f32_16x16x32_bf16 v[28:31], v[68:71], v[92:95], v[28:31]
    ds_read_b64_tr_b16 v[68:69], v121 offset:61536
    ds_read_b64_tr_b16 v[70:71], v121 offset:63072
    s_add_u32 m0, s37, 40960
    s_nop 0
    buffer_load_dwordx4 v2, s[8:11], s44 offen sc1 lds
    buffer_load_dwordx4 v2, s[8:11], s44 offen offset:1024 sc1 lds
    s_add_u32 s44, s44, 2048
    s_cmp_eq_u32 s44, s47
    s_cselect_b32 s44, s41, s44
    v_mfma_f32_16x16x32_bf16 v[32:35], v[72:75], v[88:91], v[32:35]
    v_mfma_f32_16x16x32_bf16 v[36:39], v[72:75], v[92:95], v[36:39]
    ds_read_b64_tr_b16 v[72:73], v5 offset:61568
    ds_read_b64_tr_b16 v[74:75], v5 offset:63104
    v_mfma_f32_16x16x32_bf16 v[40:43], v[76:79], v[88:91], v[40:43]
    v_mfma_f32_16x16x32_bf16 v[44:47], v[76:79], v[92:95], v[44:47]
    ds_read_b64_tr_b16 v[76:77], v120 offset:61568
    ds_read_b64_tr_b16 v[78:79], v120 offset:63104
    v_mfma_f32_16x16x32_bf16 v[48:51], v[80:83], v[88:91], v[48:51]
    v_mfma_f32_16x16x32_bf16 v[52:55], v[80:83], v[92:95], v[52:55]
    ds_read_b64_tr_b16 v[80:81], v6 offset:61600
    ds_read_b64_tr_b16 v[82:83], v6 offset:63136
    v_mfma_f32_16x16x32_bf16 v[56:59], v[84:87], v[88:91], v[56:59]
    v_mfma_f32_16x16x32_bf16 v[60:63], v[84:87], v[92:95], v[60:63]
    ds_read_b64_tr_b16 v[84:85], v121 offset:61600
    ds_read_b64_tr_b16 v[86:87], v121 offset:63136
    s_waitcnt lgkmcnt(0)
    v_mfma_f32_16x16x32_bf16 v[16:19], v[64:67], v[96:99], v[16:19]
    v_mfma_f32_16x16x32_bf16 v[20:23], v[64:67], v[100:103], v[20:23]
    s_waitcnt vmcnt(4)
    s_barrier
    ds_read_b128 v[88:91], v4 offset:0
    ds_read_b128 v[92:95], v4 offset:256
    ds_read_b64_tr_b16 v[64:65], v6 offset:96
    ds_read_b64_tr_b16 v[66:67], v6 offset:1632
    v_mfma_f32_16x16x32_bf16 v[24:27], v[68:71], v[96:99], v[24:27]
    v_mfma_f32_16x16x32_bf16 v[28:31], v[68:71], v[100:103], v[28:31]
    ds_read_b64_tr_b16 v[68:69], v121 offset:96
    ds_read_b64_tr_b16 v[70:71], v121 offset:1632
    s_add_u32 m0, s37, 61440
    s_nop 0
    buffer_load_dwordx4 v2, s[8:11], s44 offen sc1 lds
    buffer_load_dwordx4 v2, s[8:11], s44 offen offset:1024 sc1 lds
    s_add_u32 s44, s44, 2048
    s_cmp_eq_u32 s44, s47
    s_cselect_b32 s44, s41, s44
    v_mfma_f32_16x16x32_bf16 v[32:35], v[72:75], v[96:99], v[32:35]
    v_mfma_f32_16x16x32_bf16 v[36:39], v[72:75], v[100:103], v[36:39]
    ds_read_b64_tr_b16 v[72:73], v5 offset:128
    ds_read_b64_tr_b16 v[74:75], v5 offset:1664
    v_mfma_f32_16x16x32_bf16 v[40:43], v[76:79], v[96:99], v[40:43]
    v_mfma_f32_16x16x32_bf16 v[44:47], v[76:79], v[100:103], v[44:47]
    ds_read_b64_tr_b16 v[76:77], v120 offset:128
    ds_read_b64_tr_b16 v[78:79], v120 offset:1664
    v_mfma_f32_16x16x32_bf16 v[48:51], v[80:83], v[96:99], v[48:51]
    v_mfma_f32_16x16x32_bf16 v[52:55], v[80:83], v[100:103], v[52:55]
    ds_read_b64_tr_b16 v[80:81], v6 offset:160
    ds_read_b64_tr_b16 v[82:83], v6 offset:1696
    v_mfma_f32_16x16x32_bf16 v[56:59], v[84:87], v[96:99], v[56:59]
    v_mfma_f32_16x16x32_bf16 v[60:63], v[84:87], v[100:103], v[60:63]
    ds_read_b64_tr_b16 v[84:85], v121 offset:160
    ds_read_b64_tr_b16 v[86:87], v121 offset:1696
    s_waitcnt lgkmcnt(0)
    v_mfma_f32_16x16x32_bf16 v[16:19], v[64:67], v[88:91], v[16:19]
    v_mfma_f32_16x16x32_bf16 v[20:23], v[64:67], v[92:95], v[20:23]
    s_waitcnt vmcnt(4)
    s_barrier
    ds_read_b128 v[96:99], v4 offset:20480
    ds_read_b128 v[100:103], v4 offset:20736
    ds_read_b64_tr_b16 v[64:65], v6 offset:20576
    ds_read_b64_tr_b16 v[66:67], v6 offset:22112
    v_mfma_f32_16x16x32_bf16 v[24:27], v[68:71], v[88:91], v[24:27]
    v_mfma_f32_16x16x32_bf16 v[28:31], v[68:71], v[92:95], v[28:31]
    ds_read_b64_tr_b16 v[68:69], v121 offset:20576
    ds_read_b64_tr_b16 v[70:71], v121 offset:22112
    s_add_u32 m0, s37, 0
    s_nop 0
    buffer_load_dwordx4 v2, s[8:11], s44 offen sc1 lds
    buffer_load_dwordx4 v2, s[8:11], s44 offen offset:1024 sc1 lds
    s_add_u32 s44, s44, 2048
    s_cmp_eq_u32 s44, s47
    s_cselect_b32 s44, s41, s44
    v_mfma_f32_16x16x32_bf16 v[32:35], v[72:75], v[88:91], v[32:35]
    v_mfma_f32_16x16x32_bf16 v[36:39], v[72:75], v[92:95], v[36:39]
    ds_read_b64_tr_b16 v[72:73], v5 offset:20608
    ds_read_b64_tr_b16 v[74:75], v5 offset:22144
    v_mfma_f32_16x16x32_bf16 v[40:43], v[76:79], v[88:91], v[40:43]
    v_mfma_f32_16x16x32_bf16 v[44:47], v[76:79], v[92:95], v[44:47]
    ds_read_b64_tr_b16 v[76:77], v120 offset:20608
    ds_read_b64_tr_b16 v[78:79], v120 offset:22144
    v_mfma_f32_16x16x32_bf16 v[48:51], v[80:83], v[88:91], v[48:51]
    v_mfma_f32_16x16x32_bf16 v[52:55], v[80:83], v[92:95], v[52:55]
    ds_read_b64_tr_b16 v[80:81], v6 offset:20640
    ds_read_b64_tr_b16 v[82:83], v6 offset:22176
    v_mfma_f32_16x16x32_bf16 v[56:59], v[84:87], v[88:91], v[56:59]
    v_mfma_f32_16x16x32_bf16 v[60:63], v[84:87], v[92:95], v[60:63]
    ds_read_b64_tr_b16 v[84:85], v121 offset:20640
    ds_read_b64_tr_b16 v[86:87], v121 offset:22176
    s_waitcnt lgkmcnt(0)
    v_mfma_f32_16x16x32_bf16 v[16:19], v[64:67], v[96:99], v[16:19]
    v_mfma_f32_16x16x32_bf16 v[20:23], v[64:67], v[100:103], v[20:23]
    s_waitcnt vmcnt(4)
    s_barrier
    ds_read_b128 v[88:91], v4 offset:40960
    ds_read_b128 v[92:95], v4 offset:41216
    ds_read_b64_tr_b16 v[64:65], v6 offset:41056
    ds_read_b64_tr_b16 v[66:67], v6 offset:42592
    v_mfma_f32_16x16x32_bf16 v[24:27], v[68:71], v[96:99], v[24:27]
    v_mfma_f32_16x16x32_bf16 v[28:31], v[68:71], v[100:103], v[28:31]
    ds_read_b64_tr_b16 v[68:69], v121 offset:41056
    ds_read_b64_tr_b16 v[70:71], v121 offset:42592
    s_add_u32 m0, s37, 20480
    s_nop 0
    buffer_load_dwordx4 v2, s[8:11], s44 offen sc1 lds
    buffer_load_dwordx4 v2, s[8:11], s44 offen offset:1024 sc1 lds
    s_add_u32 s44, s44, 2048
    s_cmp_eq_u32 s44, s47
    s_cselect_b32 s44, s41, s44
    v_mfma_f32_16x16x32_bf16 v[32:35], v[72:75], v[96:99], v[32:35]
    v_mfma_f32_16x16x32_bf16 v[36:39], v[72:75], v[100:103], v[36:39]
    ds_read_b64_tr_b16 v[72:73], v5 offset:41088
    ds_read_b64_tr_b16 v[74:75], v5 offset:42624
    v_mfma_f32_16x16x32_bf16 v[40:43], v[76:79], v[96:99], v[40:43]
    v_mfma_f32_16x16x32_bf16 v[44:47], v[76:79], v[100:103], v[44:47]
    ds_read_b64_tr_b16 v[76:77], v120 offset:41088
    ds_read_b64_tr_b16 v[78:79], v120 offset:42624
    v_mfma_f32_16x16x32_bf16 v[48:51], v[80:83], v[96:99], v[48:51]
    v_mfma_f32_16x16x32_bf16 v[52:55], v[80:83], v[100:103], v[52:55]
    ds_read_b64_tr_b16 v[80:81], v6 offset:41120
    ds_read_b64_tr_b16 v[82:83], v6 offset:42656
    v_mfma_f32_16x16x32_bf16 v[56:59], v[84:87], v[96:99], v[56:59]
    v_mfma_f32_16x16x32_bf16 v[60:63], v[84:87], v[100:103], v[60:63]
    ds_read_b64_tr_b16 v[84:85], v121 offset:41120
    ds_read_b64_tr_b16 v[86:87], v121 offset:42656
    s_waitcnt lgkmcnt(0)
    v_mfma_f32_16x16x32_bf16 v[16:19], v[64:67], v[88:91], v[16:19]
    v_mfma_f32_16x16x32_bf16 v[20:23], v[64:67], v[92:95], v[20:23]
    s_waitcnt vmcnt(4)
    s_barrier
    ds_read_b128 v[96:99], v4 offset:61440
    ds_read_b128 v[100:103], v4 offset:61696
    ds_read_b64_tr_b16 v[64:65], v6 offset:61536
    ds_read_b64_tr_b16 v[66:67], v6 offset:63072
    v_mfma_f32_16x16x32_bf16 v[24:27], v[68:71], v[88:91], v[24:27]
    v_mfma_f32_16x16x32_bf16 v[28:31], v[68:71], v[92:95], v[28:31]
    ds_read_b64_tr_b16 v[68:69], v121 offset:61536
    ds_read_b64_tr_b16 v[70:71], v121 offset:63072
    s_add_u32 m0, s37, 40960
    s_nop 0
    buffer_load_dwordx4 v2, s[8:11], s44 offen sc1 lds
    buffer_load_dwordx4 v2, s[8:11], s44 offen offset:1024 sc1 lds
    s_add_u32 s44, s44, 2048
    s_cmp_eq_u32 s44, s47
    s_cselect_b32 s44, s41, s44
    v_mfma_f32_16x16x32_bf16 v[32:35], v[72:75], v[88:91], v[32:35]
    v_mfma_f32_16x16x32_bf16 v[36:39], v[72:75], v[92:95], v[36:39]
    ds_read_b64_tr_b16 v[72:73], v5 offset:61568
    ds_read_b64_tr_b16 v[74:75], v5 offset:63104
    v_mfma_f32_16x16x32_bf16 v[40:43], v[76:79], v[88:91], v[40:43]
    v_mfma_f32_16x16x32_bf16 v[44:47], v[76:79], v[92:95], v[44:47]
    ds_read_b64_tr_b16 v[76:77], v120 offset:61568
    ds_read_b64_tr_b16 v[78:79], v120 offset:63104
    v_mfma_f32_16x16x32_bf16 v[48:51], v[80:83], v[88:91], v[48:51]
    v_mfma_f32_16x16x32_bf16 v[52:55], v[80:83], v[92:95], v[52:55]
    ds_read_b64_tr_b16 v[80:81], v6 offset:61600
    ds_read_b64_tr_b16 v[82:83], v6 offset:63136
    v_mfma_f32_16x16x32_bf16 v[56:59], v[84:87], v[88:91], v[56:59]
    v_mfma_f32_16x16x32_bf16 v[60:63], v[84:87], v[92:95], v[60:63]
    ds_read_b64_tr_b16 v[84:85], v121 offset:61600
    ds_read_b64_tr_b16 v[86:87], v121 offset:63136
    s_waitcnt lgkmcnt(0)
    v_mfma_f32_16x16x32_bf16 v[16:19], v[64:67], v[96:99], v[16:19]
    v_mfma_f32_16x16x32_bf16 v[20:23], v[64:67], v[100:103], v[20:23]
    s_waitcnt vmcnt(4)
    s_barrier
    ds_read_b128 v[88:91], v4 offset:0
    ds_read_b128 v[92:95], v4 offset:256
    ds_read_b64_tr_b16 v[64:65], v6 offset:96
    ds_read_b64_tr_b16 v[66:67], v6 offset:1632
    v_mfma_f32_16x16x32_bf16 v[24:27], v[68:71], v[96:99], v[24:27]
    v_mfma_f32_16x16x32_bf16 v[28:31], v[68:71], v[100:103], v[28:31]
    ds_read_b64_tr_b16 v[68:69], v121 offset:96
    ds_read_b64_tr_b16 v[70:71], v121 offset:1632
    s_add_u32 m0, s37, 61440
    s_nop 0
    buffer_load_dwordx4 v2, s[8:11], s44 offen sc1 lds
    buffer_load_dwordx4 v2, s[8:11], s44 offen offset:1024 sc1 lds
    s_add_u32 s44, s44, 2048
    s_cmp_eq_u32 s44, s47
    s_cselect_b32 s44, s41, s44
    v_mfma_f32_16x16x32_bf16 v[32:35], v[72:75], v[96:99], v[32:35]
    v_mfma_f32_16x16x32_bf16 v[36:39], v[72:75], v[100:103], v[36:39]
    ds_read_b64_tr_b16 v[72:73], v5 offset:128
    ds_read_b64_tr_b16 v[74:75], v5 offset:1664
    v_mfma_f32_16x16x32_bf16 v[40:43], v[76:79], v[96:99], v[40:43]
    v_mfma_f32_16x16x32_bf16 v[44:47], v[76:79], v[100:103], v[44:47]
    ds_read_b64_tr_b16 v[76:77], v120 offset:128
    ds_read_b64_tr_b16 v[78:79], v120 offset:1664
    v_mfma_f32_16x16x32_bf16 v[48:51], v[80:83], v[96:99], v[48:51]
    v_mfma_f32_16x16x32_bf16 v[52:55], v[80:83], v[100:103], v[52:55]
    ds_read_b64_tr_b16 v[80:81], v6 offset:160
    ds_read_b64_tr_b16 v[82:83], v6 offset:1696
    v_mfma_f32_16x16x32_bf16 v[56:59], v[84:87], v[96:99], v[56:59]
    v_mfma_f32_16x16x32_bf16 v[60:63], v[84:87], v[100:103], v[60:63]
    ds_read_b64_tr_b16 v[84:85], v121 offset:160
    ds_read_b64_tr_b16 v[86:87], v121 offset:1696
    buffer_load_dwordx4 v[104:107], v122, s[20:23], s72 offen
    s_mov_b64 exec, 0xffff
    buffer_load_dwordx4 v[116:119], v123, s[20:23], s72 offen
    s_mov_b64 exec, -1
    s_waitcnt lgkmcnt(0)
    v_mfma_f32_16x16x32_bf16 v[16:19], v[64:67], v[88:91], v[16:19]
    v_mfma_f32_16x16x32_bf16 v[20:23], v[64:67], v[92:95], v[20:23]
    s_waitcnt vmcnt(6)
    s_barrier
    ds_read_b128 v[96:99], v4 offset:20480
    ds_read_b128 v[100:103], v4 offset:20736
    ds_read_b64_tr_b16 v[64:65], v6 offset:20576
    ds_read_b64_tr_b16 v[66:67], v6 offset:22112
    v_mfma_f32_16x16x32_bf16 v[24:27], v[68:71], v[88:91], v[24:27]
    v_mfma_f32_16x16x32_bf16 v[28:31], v[68:71], v[92:95], v[28:31]
    ds_read_b64_tr_b16 v[68:69], v121 offset:20576
    ds_read_b64_tr_b16 v[70:71], v121 offset:22112
    s_add_u32 m0, s37, 0
    s_nop 0
    buffer_load_dwordx4 v2, s[8:11], s44 offen sc1 lds
    buffer_load_dwordx4 v2, s[8:11], s44 offen offset:1024 sc1 lds
    s_add_u32 s44, s44, 2048
    s_cmp_eq_u32 s44, s47
    s_cselect_b32 s44, s41, s44
    v_mfma_f32_16x16x32_bf16 v[32:35], v[72:75], v[88:91], v[32:35]
    v_mfma_f32_16x16x32_bf16 v[36:39], v[72:75], v[92:95], v[36:39]
    ds_read_b64_tr_b16 v[72:73], v5 offset:20608
    ds_read_b64_tr_b16 v[74:75], v5 offset:22144
    v_mfma_f32_16x16x32_bf16 v[40:43], v[76:79], v[88:91], v[40:43]
    v_mfma_f32_16x16x32_bf16 v[44:47], v[76:79], v[92:95], v[44:47]
    ds_read_b64_tr_b16 v[76:77], v120 offset:20608
    ds_read_b64_tr_b16 v[78:79], v120 offset:22144
    v_mfma_f32_16x16x32_bf16 v[48:51], v[80:83], v[88:91], v[48:51]
    v_mfma_f32_16x16x32_bf16 v[52:55], v[80:83], v[92:95], v[52:55]
    ds_read_b64_tr_b16 v[80:81], v6 offset:20640
    ds_read_b64_tr_b16 v[82:83], v6 offset:22176
    v_mfma_f32_16x16x32_bf16 v[56:59], v[84:87], v[88:91], v[56:59]
    v_mfma_f32_16x16x32_bf16 v[60:63], v[84:87], v[92:95], v[60:63]
    ds_read_b64_tr_b16 v[84:85], v121 offset:20640
    ds_read_b64_tr_b16 v[86:87], v121 offset:22176
    s_waitcnt lgkmcnt(0)
    v_mfma_f32_16x16x32_bf16 v[16:19], v[64:67], v[96:99], v[16:19]
    v_mfma_f32_16x16x32_bf16 v[20:23], v[64:67], v[100:103], v[20:23]
    s_waitcnt vmcnt(6)
    s_barrier
    ds_read_b128 v[88:91], v4 offset:40960
    ds_read_b128 v[92:95], v4 offset:41216
    ds_read_b64_tr_b16 v[64:65], v6 offset:41056
    ds_read_b64_tr_b16 v[66:67], v6 offset:42592
    v_mfma_f32_16x16x32_bf16 v[24:27], v[68:71], v[96:99], v[24:27]
    v_mfma_f32_16x16x32_bf16 v[28:31], v[68:71], v[100:103], v[28:31]
    ds_read_b64_tr_b16 v[68:69], v121 offset:41056
    ds_read_b64_tr_b16 v[70:71], v121 offset:42592
    s_add_u32 m0, s37, 20480
    s_nop 0
    buffer_load_dwordx4 v2, s[8:11], s44 offen sc1 lds
    buffer_load_dwordx4 v2, s[8:11], s44 offen offset:1024 sc1 lds
    s_add_u32 s44, s44, 2048
    s_cmp_eq_u32 s44, s47
    s_cselect_b32 s44, s41, s44
    v_mfma_f32_16x16x32_bf16 v[32:35], v[72:75], v[96:99], v[32:35]
    v_mfma_f32_16x16x32_bf16 v[36:39], v[72:75], v[100:103], v[36:39]
    ds_read_b64_tr_b16 v[72:73], v5 offset:41088
    ds_read_b64_tr_b16 v[74:75], v5 offset:42624
    v_mfma_f32_16x16x32_bf16 v[40:43], v[76:79], v[96:99], v[40:43]
    v_mfma_f32_16x16x32_bf16 v[44:47], v[76:79], v[100:103], v[44:47]
    ds_read_b64_tr_b16 v[76:77], v120 offset:41088
    ds_read_b64_tr_b16 v[78:79], v120 offset:42624
    v_mfma_f32_16x16x32_bf16 v[48:51], v[80:83], v[96:99], v[48:51]
    v_mfma_f32_16x16x32_bf16 v[52:55], v[80:83], v[100:103], v[52:55]
    ds_read_b64_tr_b16 v[80:81], v6 offset:41120
    ds_read_b64_tr_b16 v[82:83], v6 offset:42656
    v_mfma_f32_16x16x32_bf16 v[56:59], v[84:87], v[96:99], v[56:59]
    v_mfma_f32_16x16x32_bf16 v[60:63], v[84:87], v[100:103], v[60:63]
    ds_read_b64_tr_b16 v[84:85], v121 offset:41120
    ds_read_b64_tr_b16 v[86:87], v121 offset:42656
    s_waitcnt lgkmcnt(0)
    v_mfma_f32_16x16x32_bf16 v[16:19], v[64:67], v[88:91], v[16:19]
    v_mfma_f32_16x16x32_bf16 v[20:23], v[64:67], v[92:95], v[20:23]
    s_waitcnt vmcnt(6)
    s_barrier
    ds_read_b128 v[96:99], v4 offset:61440
    ds_read_b128 v[100:103], v4 offset:61696
    ds_read_b64_tr_b16 v[64:65], v6 offset:61536
    ds_read_b64_tr_b16 v[66:67], v6 offset:63072
    v_mfma_f32_16x16x32_bf16 v[24:27], v[68:71], v[88:91], v[24:27]
    v_mfma_f32_16x16x32_bf16 v[28:31], v[68:71], v[92:95], v[28:31]
    ds_read_b64_tr_b16 v[68:69], v121 offset:61536
    ds_read_b64_tr_b16 v[70:71], v121 offset:63072
    s_add_u32 m0, s37, 40960
    s_nop 0
    buffer_load_dwordx4 v2, s[8:11], s44 offen sc1 lds
    buffer_load_dwordx4 v2, s[8:11], s44 offen offset:1024 sc1 lds
    s_add_u32 s44, s44, 2048
    s_cmp_eq_u32 s44, s47
    s_cselect_b32 s44, s41, s44
    v_mfma_f32_16x16x32_bf16 v[32:35], v[72:75], v[88:91], v[32:35]
    v_mfma_f32_16x16x32_bf16 v[36:39], v[72:75], v[92:95], v[36:39]
    ds_read_b64_tr_b16 v[72:73], v5 offset:61568
    ds_read_b64_tr_b16 v[74:75], v5 offset:63104
    v_mfma_f32_16x16x32_bf16 v[40:43], v[76:79], v[88:91], v[40:43]
    v_mfma_f32_16x16x32_bf16 v[44:47], v[76:79], v[92:95], v[44:47]
    ds_read_b64_tr_b16 v[76:77], v120 offset:61568
    ds_read_b64_tr_b16 v[78:79], v120 offset:63104
    v_mfma_f32_16x16x32_bf16 v[48:51], v[80:83], v[88:91], v[48:51]
    v_mfma_f32_16x16x32_bf16 v[52:55], v[80:83], v[92:95], v[52:55]
    ds_read_b64_tr_b16 v[80:81], v6 offset:61600
    ds_read_b64_tr_b16 v[82:83], v6 offset:63136
    v_mfma_f32_16x16x32_bf16 v[56:59], v[84:87], v[88:91], v[56:59]
    v_mfma_f32_16x16x32_bf16 v[60:63], v[84:87], v[92:95], v[60:63]
    ds_read_b64_tr_b16 v[84:85], v121 offset:61600
    ds_read_b64_tr_b16 v[86:87], v121 offset:63136
    s_waitcnt vmcnt(6)
    buffer_store_dwordx4 v[104:107], v2, s[24:27], s73 offen sc1
    s_mov_b64 exec, 0xffff
    buffer_store_dwordx4 v[116:119], v2, s[24:27], s73 offen offset:1024 sc1
    s_mov_b64 exec, -1
    s_waitcnt lgkmcnt(0)
    v_mfma_f32_16x16x32_bf16 v[16:19], v[64:67], v[96:99], v[16:19]
    v_mfma_f32_16x16x32_bf16 v[20:23], v[64:67], v[100:103], v[20:23]
    s_waitcnt vmcnt(6)
    s_barrier
    ds_read_b128 v[88:91], v4 offset:0
    ds_read_b128 v[92:95], v4 offset:256
    ds_read_b64_tr_b16 v[64:65], v6 offset:96
    ds_read_b64_tr_b16 v[66:67], v6 offset:1632
    v_mfma_f32_16x16x32_bf16 v[24:27], v[68:71], v[96:99], v[24:27]
    v_mfma_f32_16x16x32_bf16 v[28:31], v[68:71], v[100:103], v[28:31]
    ds_read_b64_tr_b16 v[68:69], v121 offset:96
    ds_read_b64_tr_b16 v[70:71], v121 offset:1632
    s_add_u32 m0, s37, 61440
    s_nop 0
    buffer_load_dwordx4 v2, s[8:11], s44 offen sc1 lds
    buffer_load_dwordx4 v2, s[8:11], s44 offen offset:1024 sc1 lds
    s_add_u32 s44, s44, 2048
    s_cmp_eq_u32 s44, s47
    s_cselect_b32 s44, s41, s44
    v_mfma_f32_16x16x32_bf16 v[32:35], v[72:75], v[96:99], v[32:35]
    v_mfma_f32_16x16x32_bf16 v[36:39], v[72:75], v[100:103], v[36:39]
    ds_read_b64_tr_b16 v[72:73], v5 offset:128
    ds_read_b64_tr_b16 v[74:75], v5 offset:1664
    v_mfma_f32_16x16x32_bf16 v[40:43], v[76:79], v[96:99], v[40:43]
    v_mfma_f32_16x16x32_bf16 v[44:47], v[76:79], v[100:103], v[44:47]
    ds_read_b64_tr_b16 v[76:77], v120 offset:128
    ds_read_b64_tr_b16 v[78:79], v120 offset:1664
    v_mfma_f32_16x16x32_bf16 v[48:51], v[80:83], v[96:99], v[48:51]
    v_mfma_f32_16x16x32_bf16 v[52:55], v[80:83], v[100:103], v[52:55]
    ds_read_b64_tr_b16 v[80:81], v6 offset:160
    ds_read_b64_tr_b16 v[82:83], v6 offset:1696
    v_mfma_f32_16x16x32_bf16 v[56:59], v[84:87], v[96:99], v[56:59]
    v_mfma_f32_16x16x32_bf16 v[60:63], v[84:87], v[100:103], v[60:63]
    ds_read_b64_tr_b16 v[84:85], v121 offset:160
    ds_read_b64_tr_b16 v[86:87], v121 offset:1696
    s_waitcnt lgkmcnt(0)
    v_mfma_f32_16x16x32_bf16 v[16:19], v[64:67], v[88:91], v[16:19]
    v_mfma_f32_16x16x32_bf16 v[20:23], v[64:67], v[92:95], v[20:23]
    s_waitcnt vmcnt(6)
    s_barrier
    ds_read_b128 v[96:99], v4 offset:20480
    ds_read_b128 v[100:103], v4 offset:20736
    ds_read_b64_tr_b16 v[64:65], v6 offset:20576
    ds_read_b64_tr_b16 v[66:67], v6 offset:22112
    v_mfma_f32_16x16x32_bf16 v[24:27], v[68:71], v[88:91], v[24:27]
    v_mfma_f32_16x16x32_bf16 v[28:31], v[68:71], v[92:95], v[28:31]
    ds_read_b64_tr_b16 v[68:69], v121 offset:20576
    ds_read_b64_tr_b16 v[70:71], v121 offset:22112
    v_mfma_f32_16x16x32_bf16 v[32:35], v[72:75], v[88:91], v[32:35]
    v_mfma_f32_16x16x32_bf16 v[36:39], v[72:75], v[92:95], v[36:39]
    ds_read_b64_tr_b16 v[72:73], v5 offset:20608
    ds_read_b64_tr_b16 v[74:75], v5 offset:22144
    v_mfma_f32_16x16x32_bf16 v[40:43], v[76:79], v[88:91], v[40:43]
    v_mfma_f32_16x16x32_bf16 v[44:47], v[76:79], v[92:95], v[44:47]
    ds_read_b64_tr_b16 v[76:77], v120 offset:20608
    ds_read_b64_tr_b16 v[78:79], v120 offset:22144
    v_mfma_f32_16x16x32_bf16 v[48:51], v[80:83], v[88:91], v[48:51]
    v_mfma_f32_16x16x32_bf16 v[52:55], v[80:83], v[92:95], v[52:55]
    ds_read_b64_tr_b16 v[80:81], v6 offset:20640
    ds_read_b64_tr_b16 v[82:83], v6 offset:22176
    v_mfma_f32_16x16x32_bf16 v[56:59], v[84:87], v[88:91], v[56:59]
    v_mfma_f32_16x16x32_bf16 v[60:63], v[84:87], v[92:95], v[60:63]
    ds_read_b64_tr_b16 v[84:85], v121 offset:20640
    ds_read_b64_tr_b16 v[86:87], v121 offset:22176
    s_waitcnt lgkmcnt(0)
    v_mfma_f32_16x16x32_bf16 v[16:19], v[64:67], v[96:99], v[16:19]
    v_mfma_f32_16x16x32_bf16 v[20:23], v[64:67], v[100:103], v[20:23]
    s_waitcnt vmcnt(4)
    s_barrier
    ds_read_b128 v[88:91], v4 offset:40960
    ds_read_b128 v[92:95], v4 offset:41216
    ds_read_b64_tr_b16 v[64:65], v6 offset:41056
    ds_read_b64_tr_b16 v[66:67], v6 offset:42592
    v_mfma_f32_16x16x32_bf16 v[24:27], v[68:71], v[96:99], v[24:27]
    v_mfma_f32_16x16x32_bf16 v[28:31], v[68:71], v[100:103], v[28:31]
    ds_read_b64_tr_b16 v[68:69], v121 offset:41056
    ds_read_b64_tr_b16 v[70:71], v121 offset:42592
    v_mfma_f32_16x16x32_bf16 v[32:35], v[72:75], v[96:99], v[32:35]
    v_mfma_f32_16x16x32_bf16 v[36:39], v[72:75], v[100:103], v[36:39]
    ds_read_b64_tr_b16 v[72:73], v5 offset:41088
    ds_read_b64_tr_b16 v[74:75], v5 offset:42624
    v_mfma_f32_16x16x32_bf16 v[40:43], v[76:79], v[96:99], v[40:43]
    v_mfma_f32_16x16x32_bf16 v[44:47], v[76:79], v[100:103], v[44:47]
    ds_read_b64_tr_b16 v[76:77], v120 offset:41088
    ds_read_b64_tr_b16 v[78:79], v120 offset:42624
    v_mfma_f32_16x16x32_bf16 v[48:51], v[80:83], v[96:99], v[48:51]
    v_mfma_f32_16x16x32_bf16 v[52:55], v[80:83], v[100:103], v[52:55]
    ds_read_b64_tr_b16 v[80:81], v6 offset:41120
    ds_read_b64_tr_b16 v[82:83], v6 offset:42656
    v_mfma_f32_16x16x32_bf16 v[56:59], v[84:87], v[96:99], v[56:59]
    v_mfma_f32_16x16x32_bf16 v[60:63], v[84:87], v[100:103], v[60:63]
    ds_read_b64_tr_b16 v[84:85], v121 offset:41120
    ds_read_b64_tr_b16 v[86:87], v121 offset:42656
    s_waitcnt vmcnt(2)
    s_waitcnt lgkmcnt(0)
    v_mfma_f32_16x16x32_bf16 v[16:19], v[64:67], v[88:91], v[16:19]
    v_mfma_f32_16x16x32_bf16 v[20:23], v[64:67], v[92:95], v[20:23]
    s_waitcnt vmcnt(0)
    s_barrier
    ds_read_b128 v[96:99], v4 offset:61440
    ds_read_b128 v[100:103], v4 offset:61696
    ds_read_b64_tr_b16 v[64:65], v6 offset:61536
    ds_read_b64_tr_b16 v[66:67], v6 offset:63072
    v_mfma_f32_16x16x32_bf16 v[24:27], v[68:71], v[88:91], v[24:27]
    v_mfma_f32_16x16x32_bf16 v[28:31], v[68:71], v[92:95], v[28:31]
    ds_read_b64_tr_b16 v[68:69], v121 offset:61536
    ds_read_b64_tr_b16 v[70:71], v121 offset:63072
    v_mfma_f32_16x16x32_bf16 v[32:35], v[72:75], v[88:91], v[32:35]
    v_mfma_f32_16x16x32_bf16 v[36:39], v[72:75], v[92:95], v[36:39]
    ds_read_b64_tr_b16 v[72:73], v5 offset:61568
    ds_read_b64_tr_b16 v[74:75], v5 offset:63104
    v_mfma_f32_16x16x32_bf16 v[40:43], v[76:79], v[88:91], v[40:43]
    v_mfma_f32_16x16x32_bf16 v[44:47], v[76:79], v[92:95], v[44:47]
    ds_read_b64_tr_b16 v[76:77], v120 offset:61568
    ds_read_b64_tr_b16 v[78:79], v120 offset:63104
    v_mfma_f32_16x16x32_bf16 v[48:51], v[80:83], v[88:91], v[48:51]
    v_mfma_f32_16x16x32_bf16 v[52:55], v[80:83], v[92:95], v[52:55]
    ds_read_b64_tr_b16 v[80:81], v6 offset:61600
    ds_read_b64_tr_b16 v[82:83], v6 offset:63136
    v_mfma_f32_16x16x32_bf16 v[56:59], v[84:87], v[88:91], v[56:59]
    v_mfma_f32_16x16x32_bf16 v[60:63], v[84:87], v[92:95], v[60:63]
    ds_read_b64_tr_b16 v[84:85], v121 offset:61600
    ds_read_b64_tr_b16 v[86:87], v121 offset:63136
    s_waitcnt lgkmcnt(0)
    v_mfma_f32_16x16x32_bf16 v[16:19], v[64:67], v[96:99], v[16:19]
    v_mfma_f32_16x16x32_bf16 v[20:23], v[64:67], v[100:103], v[20:23]
    v_mfma_f32_16x16x32_bf16 v[24:27], v[68:71], v[96:99], v[24:27]
    v_mfma_f32_16x16x32_bf16 v[28:31], v[68:71], v[100:103], v[28:31]
    v_mfma_f32_16x16x32_bf16 v[32:35], v[72:75], v[96:99], v[32:35]
    v_mfma_f32_16x16x32_bf16 v[36:39], v[72:75], v[100:103], v[36:39]
    v_mfma_f32_16x16x32_bf16 v[40:43], v[76:79], v[96:99], v[40:43]
    v_mfma_f32_16x16x32_bf16 v[44:47], v[76:79], v[100:103], v[44:47]
    v_mfma_f32_16x16x32_bf16 v[48:51], v[80:83], v[96:99], v[48:51]
    v_mfma_f32_16x16x32_bf16 v[52:55], v[80:83], v[100:103], v[52:55]
    v_mfma_f32_16x16x32_bf16 v[56:59], v[84:87], v[96:99], v[56:59]
    v_mfma_f32_16x16x32_bf16 v[60:63], v[84:87], v[100:103], v[60:63]
    s_mov_b32 s37, 3
L_f1e_13_para:
    s_mul_i32 s70, s46, 96
    s_add_u32 s70, s70, s37
    s_mul_i32 s37, s33, 6
    s_add_u32 s70, s70, s37
    s_lshl_b32 s70, s70, 10
    s_lshl_b32 s71, s32, 4
    s_add_u32 s71, s71, s33
    s_mov_b32 s69, 0xbfb8aa3b
    s_setprio 2
    s_and_b32 s34, s5, 7
    s_lshr_b32 s35, s5, 3
    s_lshl_b32 s36, s34, 2
    s_and_b32 s37, s35, 3
    s_add_u32 s32, s36, s37
    s_lshr_b32 s33, s35, 2
    s_and_b32 s37, s4, 1
    s_lshr_b32 s38, s4, 1
    s_mul_i32 s39, s4, 160
    s_mul_i32 s43, s33, 160
    s_add_u32 s8, s66, 19955712
    s_addc_u32 s9, s67, 0
    s_mov_b32 s10, 2621440
    s_mov_b32 s11, 0x00020000
    v_mov_b32 v10, v110
    v_mov_b32 v11, v111
    v_mov_b32 v12, v112
    v_mov_b32 v3, v115
    v_mov_b32 v13, v113
    v_add_u32 v14, 61440, v113
    v_mov_b32 v15, v114
    s_and_b32 s40, s32, 3
    s_mul_i32 s40, s40, 3
    s_mul_i32 s44, s33, 5
    s_add_u32 s40, s40, s44
    s_cmp_ge_u32 s40, 24
    s_cselect_b32 s44, 24, 0
    s_sub_u32 s40, s40, s44
    s_cmp_ge_u32 s40, 12
    s_cselect_b32 s44, 12, 0
    s_sub_u32 s40, s40, s44
    s_lshl_b32 s46, s32, 1
    s_add_u32 s46, s46, s37
    s_mul_i32 s41, s46, 98304
    s_lshl_b32 s44, s38, 11
    s_add_u32 s41, s41, s44
    s_mul_i32 s47, s46, 40960
    s_add_u32 s47, s47, s44
    s_mul_i32 s42, s4, 2560
    s_mul_i32 s36, s33, 327680
    s_add_u32 s36, s36, s42
    s_add_u32 s39, s36, 245760
    s_mul_i32 s44, s40, 20480
    s_add_u32 s44, s44, s36
    s_lshl_b32 s45, s40, 13
    s_add_u32 s45, s45, s41
    s_add_u32 s68, s41, 98304
    v_lshlrev_b32 v104, 7, v1
    s_cmp_lg_u32 s4, 1
    s_cbranch_scc1 L_pkl_18_para
    s_mov_b32 s78, 65536
    buffer_load_dwordx2 v[96:97], v104, s[28:31], s78 offen sc1
    s_mov_b32 s78, 73728
    buffer_load_dwordx2 v[98:99], v104, s[28:31], s78 offen sc1
    s_mov_b32 s78, 81920
    buffer_load_dwordx2 v[100:101], v104, s[28:31], s78 offen sc1
    s_mov_b32 s78, 90112
    buffer_load_dwordx2 v[102:103], v104, s[28:31], s78 offen sc1
L_pkl_18_para:
    v_mul_f32 v80, s69, v16
    v_mul_f32 v81, s69, v17
    v_mul_f32 v82, s69, v18
    v_mul_f32 v83, s69, v19
    v_mul_f32 v84, s69, v20
    v_mul_f32 v85, s69, v21
    v_mul_f32 v86, s69, v22
    v_mul_f32 v87, s69, v23
    v_exp_f32 v80, v80
    v_exp_f32 v81, v81
    v_exp_f32 v82, v82
    v_exp_f32 v83, v83
    v_exp_f32 v84, v84
    v_exp_f32 v85, v85
    v_exp_f32 v86, v86
    v_exp_f32 v87, v87
    v_mul_f32 v16, v16, v24
    v_mul_f32 v17, v17, v25
    v_mul_f32 v18, v18, v26
    v_mul_f32 v19, v19, v27
    v_mul_f32 v20, v20, v28
    v_mul_f32 v21, v21, v29
    v_mul_f32 v22, v22, v30
    v_mul_f32 v23, v23, v31
    v_add_f32 v80, 1.0, v80
    v_add_f32 v81, 1.0, v81
    v_add_f32 v82, 1.0, v82
    v_add_f32 v83, 1.0, v83
    v_add_f32 v84, 1.0, v84
    v_add_f32 v85, 1.0, v85
    v_add_f32 v86, 1.0, v86
    v_add_f32 v87, 1.0, v87
    v_rcp_f32 v80, v80
    v_rcp_f32 v81, v81
    v_rcp_f32 v82, v82
    v_rcp_f32 v83, v83
    v_rcp_f32 v84, v84
    v_rcp_f32 v85, v85
    v_rcp_f32 v86, v86
    v_rcp_f32 v87, v87
    s_nop 0
    v_mul_f32 v16, v16, v80
    v_mul_f32 v17, v17, v81
    v_mul_f32 v18, v18, v82
    v_mul_f32 v19, v19, v83
    v_mul_f32 v20, v20, v84
    v_mul_f32 v21, v21, v85
    v_mul_f32 v22, v22, v86
    v_mul_f32 v23, v23, v87
    v_cvt_pk_bf16_f32 v64, v16, v17
    v_cvt_pk_bf16_f32 v65, v18, v19
    v_cvt_pk_bf16_f32 v66, v20, v21
    v_cvt_pk_bf16_f32 v67, v22, v23
    s_nop 1
    v_permlane16_swap_b32 v64, v66
    v_permlane16_swap_b32 v65, v67
    buffer_store_dwordx4 v[64:67], v2, s[16:19], s70 offen offset:0 sc1
    v_mul_f32 v88, s69, v32
    v_mul_f32 v89, s69, v33
    v_mul_f32 v90, s69, v34
    v_mul_f32 v91, s69, v35
    v_mul_f32 v92, s69, v36
    v_mul_f32 v93, s69, v37
    v_mul_f32 v94, s69, v38
    v_mul_f32 v95, s69, v39
    v_exp_f32 v88, v88
    v_exp_f32 v89, v89
    v_exp_f32 v90, v90
    v_exp_f32 v91, v91
    v_exp_f32 v92, v92
    v_exp_f32 v93, v93
    v_exp_f32 v94, v94
    v_exp_f32 v95, v95
    v_mul_f32 v32, v32, v40
    v_mul_f32 v33, v33, v41
    v_mul_f32 v34, v34, v42
    v_mul_f32 v35, v35, v43
    v_mul_f32 v36, v36, v44
    v_mul_f32 v37, v37, v45
    v_mul_f32 v38, v38, v46
    v_mul_f32 v39, v39, v47
    v_add_f32 v88, 1.0, v88
    v_add_f32 v89, 1.0, v89
    v_add_f32 v90, 1.0, v90
    v_add_f32 v91, 1.0, v91
    v_add_f32 v92, 1.0, v92
    v_add_f32 v93, 1.0, v93
    v_add_f32 v94, 1.0, v94
    v_add_f32 v95, 1.0, v95
    v_rcp_f32 v88, v88
    v_rcp_f32 v89, v89
    v_rcp_f32 v90, v90
    v_rcp_f32 v91, v91
    v_rcp_f32 v92, v92
    v_rcp_f32 v93, v93
    v_rcp_f32 v94, v94
    v_rcp_f32 v95, v95
    s_nop 0
    v_mul_f32 v32, v32, v88
    v_mul_f32 v33, v33, v89
    v_mul_f32 v34, v34, v90
    v_mul_f32 v35, v35, v91
    v_mul_f32 v36, v36, v92
    v_mul_f32 v37, v37, v93
    v_mul_f32 v38, v38, v94
    v_mul_f32 v39, v39, v95
    v_cvt_pk_bf16_f32 v68, v32, v33
    v_cvt_pk_bf16_f32 v69, v34, v35
    v_cvt_pk_bf16_f32 v70, v36, v37
    v_cvt_pk_bf16_f32 v71, v38, v39
    s_nop 1
    v_permlane16_swap_b32 v68, v70
    v_permlane16_swap_b32 v69, v71
    buffer_store_dwordx4 v[68:71], v2, s[16:19], s70 offen offset:1024 sc1
    v_mul_f32 v80, s69, v48
    v_mul_f32 v81, s69, v49
    v_mul_f32 v82, s69, v50
    v_mul_f32 v83, s69, v51
    v_mul_f32 v84, s69, v52
    v_mul_f32 v85, s69, v53
    v_mul_f32 v86, s69, v54
    v_mul_f32 v87, s69, v55
    v_exp_f32 v80, v80
    v_exp_f32 v81, v81
    v_exp_f32 v82, v82
    v_exp_f32 v83, v83
    v_exp_f32 v84, v84
    v_exp_f32 v85, v85
    v_exp_f32 v86, v86
    v_exp_f32 v87, v87
    v_mul_f32 v48, v48, v56
    v_mul_f32 v49, v49, v57
    v_mul_f32 v50, v50, v58
    v_mul_f32 v51, v51, v59
    v_mul_f32 v52, v52, v60
    v_mul_f32 v53, v53, v61
    v_mul_f32 v54, v54, v62
    v_mul_f32 v55, v55, v63
    v_add_f32 v80, 1.0, v80
    v_add_f32 v81, 1.0, v81
    v_add_f32 v82, 1.0, v82
    v_add_f32 v83, 1.0, v83
    v_add_f32 v84, 1.0, v84
    v_add_f32 v85, 1.0, v85
    v_add_f32 v86, 1.0, v86
    v_add_f32 v87, 1.0, v87
    v_rcp_f32 v80, v80
    v_rcp_f32 v81, v81
    v_rcp_f32 v82, v82
    v_rcp_f32 v83, v83
    v_rcp_f32 v84, v84
    v_rcp_f32 v85, v85
    v_rcp_f32 v86, v86
    v_rcp_f32 v87, v87
    s_nop 0
    v_mul_f32 v48, v48, v80
    v_mul_f32 v49, v49, v81
    v_mul_f32 v50, v50, v82
    v_mul_f32 v51, v51, v83
    v_mul_f32 v52, v52, v84
    v_mul_f32 v53, v53, v85
    v_mul_f32 v54, v54, v86
    v_mul_f32 v55, v55, v87
    v_cvt_pk_bf16_f32 v72, v48, v49
    v_cvt_pk_bf16_f32 v73, v50, v51
    v_cvt_pk_bf16_f32 v74, v52, v53
    v_cvt_pk_bf16_f32 v75, v54, v55
    s_nop 1
    v_permlane16_swap_b32 v72, v74
    v_permlane16_swap_b32 v73, v75
    buffer_store_dwordx4 v[72:75], v2, s[16:19], s70 offen offset:2048 sc1
    s_setprio 1
    s_waitcnt vmcnt(0)
    s_barrier
    s_cmp_lg_u32 s4, 0
    s_cbranch_scc1 L_f1f_19_para
    s_add_u32 s78, s71, 768
    s_lshl_b32 s78, s78, 7
    v_mov_b32 v80, s6
    v_mov_b32 v81, s7
    v_mov_b32 v82, 0
    s_mov_b64 exec, 1
    buffer_store_dwordx2 v[80:81], v82, s[28:31], s78 offen sc1
    s_mov_b64 exec, -1
L_f1f_19_para:
    s_cmp_lg_u32 s4, 1
    s_cbranch_scc1 L_pkc_20_para
    s_mov_b32 s79, 100000
L_pkt_21_para:
    v_cmp_ne_u64 s[74:75], s[6:7], v[96:97]
    v_cmp_ne_u64 vcc, s[6:7], v[98:99]
    s_nop 0
    s_or_b64 s[74:75], s[74:75], vcc
    v_cmp_ne_u64 vcc, s[6:7], v[100:101]
    s_nop 0
    s_or_b64 s[74:75], s[74:75], vcc
    v_cmp_ne_u64 vcc, s[6:7], v[102:103]
    s_nop 0
    s_or_b64 s[74:75], s[74:75], vcc
    s_cbranch_scc0 L_pkc_20_para
    s_sleep 8
    s_mov_b32 s78, 65536
    buffer_load_dwordx2 v[96:97], v104, s[28:31], s78 offen sc1
    s_mov_b32 s78, 73728
    buffer_load_dwordx2 v[98:99], v104, s[28:31], s78 offen sc1
    s_mov_b32 s78, 81920
    buffer_load_dwordx2 v[100:101], v104, s[28:31], s78 offen sc1
    s_mov_b32 s78, 90112
    buffer_load_dwordx2 v[102:103], v104, s[28:31], s78 offen sc1
    s_waitcnt vmcnt(0)
    s_sub_u32 s79, s79, 1
    s_cmp_lg_u32 s79, 0
    s_cbranch_scc1 L_pkt_21_para
L_pkc_20_para:
    s_barrier
    s_lshr_b32 s77, s32, 1
    s_lshl_b32 s77, s77, 4
    s_add_u32 s77, s77, 768
    s_lshl_b32 s77, s77, 7
    s_cmp_lg_u32 s4, 2
    s_cbranch_scc1 L_f2o_22_para
    s_mov_b64 exec, 0xffff
    buffer_load_dwordx2 v[76:77], v104, s[28:31], s77 offen sc1
    s_mov_b64 exec, -1
L_f2o_22_para:
    s_add_u32 m0, s42, 0
    s_nop 0
    buffer_load_dwordx4 v2, s[8:11], s44 offen sc1 lds
    buffer_load_dwordx4 v2, s[8:11], s44 offen offset:1024 sc1 lds
    s_mov_b32 exec_hi, 0
    buffer_load_dwordx4 v2, s[8:11], s44 offen offset:2048 sc1 lds
    s_mov_b32 exec_hi, -1
    s_add_u32 s44, s44, 20480
    s_cmp_eq_u32 s44, s39
    s_cselect_b32 s44, s36, s44
    s_add_u32 m0, s42, 20480
    s_nop 0
    buffer_load_dwordx4 v2, s[8:11], s44 offen sc1 lds
    buffer_load_dwordx4 v2, s[8:11], s44 offen offset:1024 sc1 lds
    s_mov_b32 exec_hi, 0
    buffer_load_dwordx4 v2, s[8:11], s44 offen offset:2048 sc1 lds
    s_mov_b32 exec_hi, -1
    s_add_u32 s44, s44, 20480
    s_cmp_eq_u32 s44, s39
    s_cselect_b32 s44, s36, s44
    s_mov_b32 s16, s52
    s_mov_b32 s17, s53
    s_mov_b32 s18, 819200
    s_mov_b32 s19, 0x00020000
    s_add_u32 s12, s66, 13107200
    s_addc_u32 s13, s67, 0
    s_mov_b32 s14, 6291456
    s_mov_b32 s15, 0x00020000
    s_add_u32 s24, s66, 10485760
    s_addc_u32 s25, s67, 0
    s_mov_b32 s26, 2621440
    s_mov_b32 s27, 0x00020000
    s_mov_b32 s20, s48
    s_mov_b32 s21, s49
    s_mov_b32 s22, 2621440
    s_mov_b32 s23, 0x00020000
    s_cmp_lg_u32 s4, 2
    s_cbranch_scc1 L_f2p_23_para
    s_waitcnt vmcnt(6)
    s_mov_b64 exec, 0xffff
    s_mov_b32 s79, 100000
    s_branch L_pmid_26_para
L_poll_24_para:
    buffer_load_dwordx2 v[76:77], v104, s[28:31], s77 offen sc1
    s_waitcnt vmcnt(0)
L_pmid_26_para:
    v_cmp_ne_u64 vcc, s[6:7], v[76:77]
    s_nop 1
    s_and_b64 exec, exec, vcc
    s_cbranch_scc0 L_polled_25_para
    s_sleep 4
    s_sub_u32 s79, s79, 1
    s_cmp_lg_u32 s79, 0
    s_cbranch_scc1 L_poll_24_para
L_polled_25_para:
    s_mov_b64 exec, -1
L_f2p_23_para:
    s_barrier
    buffer_load_dwordx4 v[76:79], v15, s[12:15], s45 offen offset:0 sc1
    buffer_load_dwordx4 v[80:83], v15, s[12:15], s45 offen offset:256 sc1
    s_add_u32 s45, s45, 8192
    s_cmp_eq_u32 s45, s68
    s_cselect_b32 s45, s41, s45
    buffer_load_dwordx4 v[84:87], v15, s[12:15], s45 offen offset:0 sc1
    buffer_load_dwordx4 v[88:91], v15, s[12:15], s45 offen offset:256 sc1
    s_add_u32 s45, s45, 8192
    s_cmp_eq_u32 s45, s68
    s_cselect_b32 s45, s41, s45
    s_add_u32 m0, s42, 40960
    s_nop 0
    buffer_load_dwordx4 v2, s[8:11], s44 offen sc1 lds
    buffer_load_dwordx4 v2, s[8:11], s44 offen offset:1024 sc1 lds
    s_mov_b32 exec_hi, 0
    buffer_load_dwordx4 v2, s[8:11], s44 offen offset:2048 sc1 lds
    s_mov_b32 exec_hi, -1
    s_add_u32 s44, s44, 20480
    s_cmp_eq_u32 s44, s39
    s_cselect_b32 s44, s36, s44
    buffer_load_dwordx4 v[92:95], v15, s[12:15], s45 offen offset:0 sc1
    buffer_load_dwordx4 v[96:99], v15, s[12:15], s45 offen offset:256 sc1
    s_add_u32 s45, s45, 8192
    s_cmp_eq_u32 s45, s68
    s_cselect_b32 s45, s41, s45
    s_add_u32 m0, s42, 61440
    s_nop 0
    buffer_load_dwordx4 v2, s[8:11], s44 offen sc1 lds
    buffer_load_dwordx4 v2, s[8:11], s44 offen offset:1024 sc1 lds
    s_mov_b32 exec_hi, 0
    buffer_load_dwordx4 v2, s[8:11], s44 offen offset:2048 sc1 lds
    s_mov_b32 exec_hi, -1
    s_add_u32 s44, s44, 20480
    s_cmp_eq_u32 s44, s39
    s_cselect_b32 s44, s36, s44
    buffer_load_dwordx4 v[100:103], v15, s[12:15], s45 offen offset:0 sc1
    buffer_load_dwordx4 v[104:107], v15, s[12:15], s45 offen offset:256 sc1
    s_add_u32 s45, s45, 8192
    s_cmp_eq_u32 s45, s68
    s_cselect_b32 s45, s41, s45
    buffer_load_dwordx4 v[108:111], v15, s[12:15], s45 offen offset:0 sc1
    buffer_load_dwordx4 v[112:115], v15, s[12:15], s45 offen offset:256 sc1
    s_add_u32 s45, s45, 8192
    s_cmp_eq_u32 s45, s68
    s_cselect_b32 s45, s41, s45
    buffer_load_dwordx4 v[116:119], v126, s[20:23], s43 offen
    buffer_load_dwordx4 v[120:123], v127, s[20:23], s43 offen
    s_waitcnt vmcnt(21)
    s_barrier
    ds_read_b64_tr_b16 v[56:57], v13 offset:0
    ds_read_b64_tr_b16 v[58:59], v13 offset:1280
    ds_read_b64_tr_b16 v[60:61], v13 offset:32
    ds_read_b64_tr_b16 v[62:63], v13 offset:1312
    ds_read_b64_tr_b16 v[64:65], v13 offset:64
    ds_read_b64_tr_b16 v[66:67], v13 offset:1344
    ds_read_b64_tr_b16 v[68:69], v13 offset:96
    ds_read_b64_tr_b16 v[70:71], v13 offset:1376
    ds_read_b64_tr_b16 v[72:73], v13 offset:128
    ds_read_b64_tr_b16 v[74:75], v13 offset:1408
    s_waitcnt vmcnt(18)
    s_waitcnt lgkmcnt(0)
    s_barrier
    s_waitcnt vmcnt(16)
    v_mfma_f32_16x16x32_bf16 v[16:19], v[56:59], v[76:79], 0
    v_mfma_f32_16x16x32_bf16 v[36:39], v[56:59], v[80:83], 0
    ds_read_b64_tr_b16 v[56:57], v13 offset:20480
    ds_read_b64_tr_b16 v[58:59], v13 offset:21760
    s_add_u32 m0, s42, 0
    s_nop 0
    buffer_load_dwordx4 v2, s[8:11], s44 offen sc1 lds
    v_mfma_f32_16x16x32_bf16 v[20:23], v[60:63], v[76:79], 0
    v_mfma_f32_16x16x32_bf16 v[40:43], v[60:63], v[80:83], 0
    ds_read_b64_tr_b16 v[60:61], v13 offset:20512
    ds_read_b64_tr_b16 v[62:63], v13 offset:21792
    buffer_load_dwordx4 v2, s[8:11], s44 offen offset:1024 sc1 lds
    v_mfma_f32_16x16x32_bf16 v[24:27], v[64:67], v[76:79], 0
    v_mfma_f32_16x16x32_bf16 v[44:47], v[64:67], v[80:83], 0
    ds_read_b64_tr_b16 v[64:65], v13 offset:20544
    ds_read_b64_tr_b16 v[66:67], v13 offset:21824
    s_mov_b32 exec_hi, 0
    buffer_load_dwordx4 v2, s[8:11], s44 offen offset:2048 sc1 lds
    s_mov_b32 exec_hi, -1
    s_add_u32 s44, s44, 20480
    s_cmp_eq_u32 s44, s39
    s_cselect_b32 s44, s36, s44
    v_mfma_f32_16x16x32_bf16 v[28:31], v[68:71], v[76:79], 0
    v_mfma_f32_16x16x32_bf16 v[48:51], v[68:71], v[80:83], 0
    ds_read_b64_tr_b16 v[68:69], v13 offset:20576
    ds_read_b64_tr_b16 v[70:71], v13 offset:21856
    v_mfma_f32_16x16x32_bf16 v[32:35], v[72:75], v[76:79], 0
    v_mfma_f32_16x16x32_bf16 v[52:55], v[72:75], v[80:83], 0
    ds_read_b64_tr_b16 v[72:73], v13 offset:20608
    ds_read_b64_tr_b16 v[74:75], v13 offset:21888
    buffer_load_dwordx4 v[76:79], v15, s[12:15], s45 offen offset:0 sc1
    buffer_load_dwordx4 v[80:83], v15, s[12:15], s45 offen offset:256 sc1
    s_add_u32 s45, s45, 8192
    s_cmp_eq_u32 s45, s68
    s_cselect_b32 s45, s41, s45
    s_waitcnt vmcnt(16)
    s_waitcnt lgkmcnt(0)
    s_barrier
    v_mfma_f32_16x16x32_bf16 v[16:19], v[56:59], v[84:87], v[16:19]
    v_mfma_f32_16x16x32_bf16 v[36:39], v[56:59], v[88:91], v[36:39]
    ds_read_b64_tr_b16 v[56:57], v13 offset:40960
    ds_read_b64_tr_b16 v[58:59], v13 offset:42240
    s_add_u32 m0, s42, 20480
    s_nop 0
    buffer_load_dwordx4 v2, s[8:11], s44 offen sc1 lds
    v_mfma_f32_16x16x32_bf16 v[20:23], v[60:63], v[84:87], v[20:23]
    v_mfma_f32_16x16x32_bf16 v[40:43], v[60:63], v[88:91], v[40:43]
    ds_read_b64_tr_b16 v[60:61], v13 offset:40992
    ds_read_b64_tr_b16 v[62:63], v13 offset:42272
    buffer_load_dwordx4 v2, s[8:11], s44 offen offset:1024 sc1 lds
    v_mfma_f32_16x16x32_bf16 v[24:27], v[64:67], v[84:87], v[24:27]
    v_mfma_f32_16x16x32_bf16 v[44:47], v[64:67], v[88:91], v[44:47]
    ds_read_b64_tr_b16 v[64:65], v13 offset:41024
    ds_read_b64_tr_b16 v[66:67], v13 offset:42304
    s_mov_b32 exec_hi, 0
    buffer_load_dwordx4 v2, s[8:11], s44 offen offset:2048 sc1 lds
    s_mov_b32 exec_hi, -1
    s_add_u32 s44, s44, 20480
    s_cmp_eq_u32 s44, s39
    s_cselect_b32 s44, s36, s44
    v_mfma_f32_16x16x32_bf16 v[28:31], v[68:71], v[84:87], v[28:31]
    v_mfma_f32_16x16x32_bf16 v[48:51], v[68:71], v[88:91], v[48:51]
    ds_read_b64_tr_b16 v[68:69], v13 offset:41056
    ds_read_b64_tr_b16 v[70:71], v13 offset:42336
    v_mfma_f32_16x16x32_bf16 v[32:35], v[72:75], v[84:87], v[32:35]
    v_mfma_f32_16x16x32_bf16 v[52:55], v[72:75], v[88:91], v[52:55]
    ds_read_b64_tr_b16 v[72:73], v13 offset:41088
    ds_read_b64_tr_b16 v[74:75], v13 offset:42368
    buffer_load_dwordx4 v[84:87], v15, s[12:15], s45 offen offset:0 sc1
    buffer_load_dwordx4 v[88:91], v15, s[12:15], s45 offen offset:256 sc1
    s_add_u32 s45, s45, 8192
    s_cmp_eq_u32 s45, s68
    s_cselect_b32 s45, s41, s45
    s_waitcnt vmcnt(16)
    s_waitcnt lgkmcnt(0)
    s_barrier
    v_mfma_f32_16x16x32_bf16 v[16:19], v[56:59], v[92:95], v[16:19]
    v_mfma_f32_16x16x32_bf16 v[36:39], v[56:59], v[96:99], v[36:39]
    ds_read_b64_tr_b16 v[56:57], v14 offset:0
    ds_read_b64_tr_b16 v[58:59], v14 offset:1280
    s_add_u32 m0, s42, 40960
    s_nop 0
    buffer_load_dwordx4 v2, s[8:11], s44 offen sc1 lds
    v_mfma_f32_16x16x32_bf16 v[20:23], v[60:63], v[92:95], v[20:23]
    v_mfma_f32_16x16x32_bf16 v[40:43], v[60:63], v[96:99], v[40:43]
    ds_read_b64_tr_b16 v[60:61], v14 offset:32
    ds_read_b64_tr_b16 v[62:63], v14 offset:1312
    buffer_load_dwordx4 v2, s[8:11], s44 offen offset:1024 sc1 lds
    v_mfma_f32_16x16x32_bf16 v[24:27], v[64:67], v[92:95], v[24:27]
    v_mfma_f32_16x16x32_bf16 v[44:47], v[64:67], v[96:99], v[44:47]
    ds_read_b64_tr_b16 v[64:65], v14 offset:64
    ds_read_b64_tr_b16 v[66:67], v14 offset:1344
    s_mov_b32 exec_hi, 0
    buffer_load_dwordx4 v2, s[8:11], s44 offen offset:2048 sc1 lds
    s_mov_b32 exec_hi, -1
    s_add_u32 s44, s44, 20480
    s_cmp_eq_u32 s44, s39
    s_cselect_b32 s44, s36, s44
    v_mfma_f32_16x16x32_bf16 v[28:31], v[68:71], v[92:95], v[28:31]
    v_mfma_f32_16x16x32_bf16 v[48:51], v[68:71], v[96:99], v[48:51]
    ds_read_b64_tr_b16 v[68:69], v14 offset:96
    ds_read_b64_tr_b16 v[70:71], v14 offset:1376
    v_mfma_f32_16x16x32_bf16 v[32:35], v[72:75], v[92:95], v[32:35]
    v_mfma_f32_16x16x32_bf16 v[52:55], v[72:75], v[96:99], v[52:55]
    ds_read_b64_tr_b16 v[72:73], v14 offset:128
    ds_read_b64_tr_b16 v[74:75], v14 offset:1408
    buffer_load_dwordx4 v[92:95], v15, s[12:15], s45 offen offset:0 sc1
    buffer_load_dwordx4 v[96:99], v15, s[12:15], s45 offen offset:256 sc1
    s_add_u32 s45, s45, 8192
    s_cmp_eq_u32 s45, s68
    s_cselect_b32 s45, s41, s45
    s_waitcnt vmcnt(12)
    s_waitcnt lgkmcnt(0)
    s_barrier
    v_mfma_f32_16x16x32_bf16 v[16:19], v[56:59], v[100:103], v[16:19]
    v_mfma_f32_16x16x32_bf16 v[36:39], v[56:59], v[104:107], v[36:39]
    ds_read_b64_tr_b16 v[56:57], v13 offset:0
    ds_read_b64_tr_b16 v[58:59], v13 offset:1280
    s_add_u32 m0, s42, 61440
    s_nop 0
    buffer_load_dwordx4 v2, s[8:11], s44 offen sc1 lds
    v_mfma_f32_16x16x32_bf16 v[20:23], v[60:63], v[100:103], v[20:23]
    v_mfma_f32_16x16x32_bf16 v[40:43], v[60:63], v[104:107], v[40:43]
    ds_read_b64_tr_b16 v[60:61], v13 offset:32
    ds_read_b64_tr_b16 v[62:63], v13 offset:1312
    buffer_load_dwordx4 v2, s[8:11], s44 offen offset:1024 sc1 lds
    v_mfma_f32_16x16x32_bf16 v[24:27], v[64:67], v[100:103], v[24:27]
    v_mfma_f32_16x16x32_bf16 v[44:47], v[64:67], v[104:107], v[44:47]
    ds_read_b64_tr_b16 v[64:65], v13 offset:64
    ds_read_b64_tr_b16 v[66:67], v13 offset:1344
    s_mov_b32 exec_hi, 0
    buffer_load_dwordx4 v2, s[8:11], s44 offen offset:2048 sc1 lds
    s_mov_b32 exec_hi, -1
    s_add_u32 s44, s44, 20480
    s_cmp_eq_u32 s44, s39
    s_cselect_b32 s44, s36, s44
    v_mfma_f32_16x16x32_bf16 v[28:31], v[68:71], v[100:103], v[28:31]
    v_mfma_f32_16x16x32_bf16 v[48:51], v[68:71], v[104:107], v[48:51]
    ds_read_b64_tr_b16 v[68:69], v13 offset:96
    ds_read_b64_tr_b16 v[70:71], v13 offset:1376
    v_mfma_f32_16x16x32_bf16 v[32:35], v[72:75], v[100:103], v[32:35]
    v_mfma_f32_16x16x32_bf16 v[52:55], v[72:75], v[104:107], v[52:55]
    ds_read_b64_tr_b16 v[72:73], v13 offset:128
    ds_read_b64_tr_b16 v[74:75], v13 offset:1408
    buffer_load_dwordx4 v[100:103], v15, s[12:15], s45 offen offset:0 sc1
    buffer_load_dwordx4 v[104:107], v15, s[12:15], s45 offen offset:256 sc1
    s_add_u32 s45, s45, 8192
    s_cmp_eq_u32 s45, s68
    s_cselect_b32 s45, s41, s45
    s_waitcnt vmcnt(12)
    s_waitcnt lgkmcnt(0)
    s_barrier
    v_mfma_f32_16x16x32_bf16 v[16:19], v[56:59], v[108:111], v[16:19]
    v_mfma_f32_16x16x32_bf16 v[36:39], v[56:59], v[112:115], v[36:39]
    ds_read_b64_tr_b16 v[56:57], v13 offset:20480
    ds_read_b64_tr_b16 v[58:59], v13 offset:21760
    s_add_u32 m0, s42, 0
    s_nop 0
    buffer_load_dwordx4 v2, s[8:11], s44 offen sc1 lds
    v_mfma_f32_16x16x32_bf16 v[20:23], v[60:63], v[108:111], v[20:23]
    v_mfma_f32_16x16x32_bf16 v[40:43], v[60:63], v[112:115], v[40:43]
    ds_read_b64_tr_b16 v[60:61], v13 offset:20512
    ds_read_b64_tr_b16 v[62:63], v13 offset:21792
    buffer_load_dwordx4 v2, s[8:11], s44 offen offset:1024 sc1 lds
    v_mfma_f32_16x16x32_bf16 v[24:27], v[64:67], v[108:111], v[24:27]
    v_mfma_f32_16x16x32_bf16 v[44:47], v[64:67], v[112:115], v[44:47]
    ds_read_b64_tr_b16 v[64:65], v13 offset:20544
    ds_read_b64_tr_b16 v[66:67], v13 offset:21824
    s_mov_b32 exec_hi, 0
    buffer_load_dwordx4 v2, s[8:11], s44 offen offset:2048 sc1 lds
    s_mov_b32 exec_hi, -1
    s_add_u32 s44, s44, 20480
    s_cmp_eq_u32 s44, s39
    s_cselect_b32 s44, s36, s44
    v_mfma_f32_16x16x32_bf16 v[28:31], v[68:71], v[108:111], v[28:31]
    v_mfma_f32_16x16x32_bf16 v[48:51], v[68:71], v[112:115], v[48:51]
    ds_read_b64_tr_b16 v[68:69], v13 offset:20576
    ds_read_b64_tr_b16 v[70:71], v13 offset:21856
    v_mfma_f32_16x16x32_bf16 v[32:35], v[72:75], v[108:111], v[32:35]
    v_mfma_f32_16x16x32_bf16 v[52:55], v[72:75], v[112:115], v[52:55]
    ds_read_b64_tr_b16 v[72:73], v13 offset:20608
    ds_read_b64_tr_b16 v[74:75], v13 offset:21888
    buffer_load_dwordx4 v[108:111], v15, s[12:15], s45 offen offset:0 sc1
    buffer_load_dwordx4 v[112:115], v15, s[12:15], s45 offen offset:256 sc1
    s_add_u32 s45, s45, 8192
    s_cmp_eq_u32 s45, s68
    s_cselect_b32 s45, s41, s45
    s_waitcnt vmcnt(12)
    s_waitcnt lgkmcnt(0)
    s_barrier
    v_mfma_f32_16x16x32_bf16 v[16:19], v[56:59], v[76:79], v[16:19]
    v_mfma_f32_16x16x32_bf16 v[36:39], v[56:59], v[80:83], v[36:39]
    ds_read_b64_tr_b16 v[56:57], v13 offset:40960
    ds_read_b64_tr_b16 v[58:59], v13 offset:42240
    s_add_u32 m0, s42, 20480
    s_nop 0
    buffer_load_dwordx4 v2, s[8:11], s44 offen sc1 lds
    v_mfma_f32_16x16x32_bf16 v[20:23], v[60:63], v[76:79], v[20:23]
    v_mfma_f32_16x16x32_bf16 v[40:43], v[60:63], v[80:83], v[40:43]
    ds_read_b64_tr_b16 v[60:61], v13 offset:40992
    ds_read_b64_tr_b16 v[62:63], v13 offset:42272
    buffer_load_dwordx4 v2, s[8:11], s44 offen offset:1024 sc1 lds
    v_mfma_f32_16x16x32_bf16 v[24:27], v[64:67], v[76:79], v[24:27]
    v_mfma_f32_16x16x32_bf16 v[44:47], v[64:67], v[80:83], v[44:47]
    ds_read_b64_tr_b16 v[64:65], v13 offset:41024
    ds_read_b64_tr_b16 v[66:67], v13 offset:42304
    s_mov_b32 exec_hi, 0
    buffer_load_dwordx4 v2, s[8:11], s44 offen offset:2048 sc1 lds
    s_mov_b32 exec_hi, -1
    s_add_u32 s44, s44, 20480
    s_cmp_eq_u32 s44, s39
    s_cselect_b32 s44, s36, s44
    v_mfma_f32_16x16x32_bf16 v[28:31], v[68:71], v[76:79], v[28:31]
    v_mfma_f32_16x16x32_bf16 v[48:51], v[68:71], v[80:83], v[48:51]
    ds_read_b64_tr_b16 v[68:69], v13 offset:41056
    ds_read_b64_tr_b16 v[70:71], v13 offset:42336
    v_mfma_f32_16x16x32_bf16 v[32:35], v[72:75], v[76:79], v[32:35]
    v_mfma_f32_16x16x32_bf16 v[52:55], v[72:75], v[80:83], v[52:55]
    ds_read_b64_tr_b16 v[72:73], v13 offset:41088
    ds_read_b64_tr_b16 v[74:75], v13 offset:42368
    buffer_load_dwordx4 v[76:79], v15, s[12:15], s45 offen offset:0 sc1
    buffer_load_dwordx4 v[80:83], v15, s[12:15], s45 offen offset:256 sc1
    s_add_u32 s45, s45, 8192
    s_cmp_eq_u32 s45, s68
    s_cselect_b32 s45, s41, s45
    s_waitcnt vmcnt(12)
    s_waitcnt lgkmcnt(0)
    s_barrier
    v_mfma_f32_16x16x32_bf16 v[16:19], v[56:59], v[84:87], v[16:19]
    v_mfma_f32_16x16x32_bf16 v[36:39], v[56:59], v[88:91], v[36:39]
    ds_read_b64_tr_b16 v[56:57], v14 offset:0
    ds_read_b64_tr_b16 v[58:59], v14 offset:1280
    s_add_u32 m0, s42, 40960
    s_nop 0
    buffer_load_dwordx4 v2, s[8:11], s44 offen sc1 lds
    v_mfma_f32_16x16x32_bf16 v[20:23], v[60:63], v[84:87], v[20:23]
    v_mfma_f32_16x16x32_bf16 v[40:43], v[60:63], v[88:91], v[40:43]
    ds_read_b64_tr_b16 v[60:61], v14 offset:32
    ds_read_b64_tr_b16 v[62:63], v14 offset:1312
    buffer_load_dwordx4 v2, s[8:11], s44 offen offset:1024 sc1 lds
    v_mfma_f32_16x16x32_bf16 v[24:27], v[64:67], v[84:87], v[24:27]
    v_mfma_f32_16x16x32_bf16 v[44:47], v[64:67], v[88:91], v[44:47]
    ds_read_b64_tr_b16 v[64:65], v14 offset:64
    ds_read_b64_tr_b16 v[66:67], v14 offset:1344
    s_mov_b32 exec_hi, 0
    buffer_load_dwordx4 v2, s[8:11], s44 offen offset:2048 sc1 lds
    s_mov_b32 exec_hi, -1
    s_add_u32 s44, s44, 20480
    s_cmp_eq_u32 s44, s39
    s_cselect_b32 s44, s36, s44
    v_mfma_f32_16x16x32_bf16 v[28:31], v[68:71], v[84:87], v[28:31]
    v_mfma_f32_16x16x32_bf16 v[48:51], v[68:71], v[88:91], v[48:51]
    ds_read_b64_tr_b16 v[68:69], v14 offset:96
    ds_read_b64_tr_b16 v[70:71], v14 offset:1376
    v_mfma_f32_16x16x32_bf16 v[32:35], v[72:75], v[84:87], v[32:35]
    v_mfma_f32_16x16x32_bf16 v[52:55], v[72:75], v[88:91], v[52:55]
    ds_read_b64_tr_b16 v[72:73], v14 offset:128
    ds_read_b64_tr_b16 v[74:75], v14 offset:1408
    buffer_load_dwordx4 v[84:87], v15, s[12:15], s45 offen offset:0 sc1
    buffer_load_dwordx4 v[88:91], v15, s[12:15], s45 offen offset:256 sc1
    s_add_u32 s45, s45, 8192
    s_cmp_eq_u32 s45, s68
    s_cselect_b32 s45, s41, s45
    s_waitcnt vmcnt(12)
    s_waitcnt lgkmcnt(0)
    s_barrier
    v_mfma_f32_16x16x32_bf16 v[16:19], v[56:59], v[92:95], v[16:19]
    v_mfma_f32_16x16x32_bf16 v[36:39], v[56:59], v[96:99], v[36:39]
    ds_read_b64_tr_b16 v[56:57], v13 offset:0
    ds_read_b64_tr_b16 v[58:59], v13 offset:1280
    s_add_u32 m0, s42, 61440
    s_nop 0
    buffer_load_dwordx4 v2, s[8:11], s44 offen sc1 lds
    v_mfma_f32_16x16x32_bf16 v[20:23], v[60:63], v[92:95], v[20:23]
    v_mfma_f32_16x16x32_bf16 v[40:43], v[60:63], v[96:99], v[40:43]
    ds_read_b64_tr_b16 v[60:61], v13 offset:32
    ds_read_b64_tr_b16 v[62:63], v13 offset:1312
    buffer_load_dwordx4 v2, s[8:11], s44 offen offset:1024 sc1 lds
    v_mfma_f32_16x16x32_bf16 v[24:27], v[64:67], v[92:95], v[24:27]
    v_mfma_f32_16x16x32_bf16 v[44:47], v[64:67], v[96:99], v[44:47]
    ds_read_b64_tr_b16 v[64:65], v13 offset:64
    ds_read_b64_tr_b16 v[66:67], v13 offset:1344
    s_mov_b32 exec_hi, 0
    buffer_load_dwordx4 v2, s[8:11], s44 offen offset:2048 sc1 lds
    s_mov_b32 exec_hi, -1
    v_mfma_f32_16x16x32_bf16 v[28:31], v[68:71], v[92:95], v[28:31]
    v_mfma_f32_16x16x32_bf16 v[48:51], v[68:71], v[96:99], v[48:51]
    ds_read_b64_tr_b16 v[68:69], v13 offset:96
    ds_read_b64_tr_b16 v[70:71], v13 offset:1376
    v_mfma_f32_16x16x32_bf16 v[32:35], v[72:75], v[92:95], v[32:35]
    v_mfma_f32_16x16x32_bf16 v[52:55], v[72:75], v[96:99], v[52:55]
    ds_read_b64_tr_b16 v[72:73], v13 offset:128
    ds_read_b64_tr_b16 v[74:75], v13 offset:1408
    s_waitcnt vmcnt(10)
    s_waitcnt lgkmcnt(0)
    s_barrier
    v_mfma_f32_16x16x32_bf16 v[16:19], v[56:59], v[100:103], v[16:19]
    v_mfma_f32_16x16x32_bf16 v[36:39], v[56:59], v[104:107], v[36:39]
    ds_read_b64_tr_b16 v[56:57], v13 offset:20480
    ds_read_b64_tr_b16 v[58:59], v13 offset:21760
    s_add_u32 s44, s39, 0
    s_add_u32 m0, s42, 0
    s_nop 0
    buffer_load_dwordx4 v2, s[8:11], s44 offen sc1 lds
    v_mfma_f32_16x16x32_bf16 v[20:23], v[60:63], v[100:103], v[20:23]
    v_mfma_f32_16x16x32_bf16 v[40:43], v[60:63], v[104:107], v[40:43]
    ds_read_b64_tr_b16 v[60:61], v13 offset:20512
    ds_read_b64_tr_b16 v[62:63], v13 offset:21792
    buffer_load_dwordx4 v2, s[8:11], s44 offen offset:1024 sc1 lds
    v_mfma_f32_16x16x32_bf16 v[24:27], v[64:67], v[100:103], v[24:27]
    v_mfma_f32_16x16x32_bf16 v[44:47], v[64:67], v[104:107], v[44:47]
    ds_read_b64_tr_b16 v[64:65], v13 offset:20544
    ds_read_b64_tr_b16 v[66:67], v13 offset:21824
    s_mov_b32 exec_hi, 0
    buffer_load_dwordx4 v2, s[8:11], s44 offen offset:2048 sc1 lds
    s_mov_b32 exec_hi, -1
    v_mfma_f32_16x16x32_bf16 v[28:31], v[68:71], v[100:103], v[28:31]
    v_mfma_f32_16x16x32_bf16 v[48:51], v[68:71], v[104:107], v[48:51]
    ds_read_b64_tr_b16 v[68:69], v13 offset:20576
    ds_read_b64_tr_b16 v[70:71], v13 offset:21856
    v_mfma_f32_16x16x32_bf16 v[32:35], v[72:75], v[100:103], v[32:35]
    v_mfma_f32_16x16x32_bf16 v[52:55], v[72:75], v[104:107], v[52:55]
    ds_read_b64_tr_b16 v[72:73], v13 offset:20608
    ds_read_b64_tr_b16 v[74:75], v13 offset:21888
    s_waitcnt vmcnt(8)
    s_waitcnt lgkmcnt(0)
    s_barrier
    v_mfma_f32_16x16x32_bf16 v[16:19], v[56:59], v[108:111], v[16:19]
    v_mfma_f32_16x16x32_bf16 v[36:39], v[56:59], v[112:115], v[36:39]
    ds_read_b64_tr_b16 v[56:57], v13 offset:40960
    ds_read_b64_tr_b16 v[58:59], v13 offset:42240
    s_add_u32 s44, s39, 20480
    s_add_u32 m0, s42, 20480
    s_nop 0
    buffer_load_dwordx4 v2, s[8:11], s44 offen sc1 lds
    v_mfma_f32_16x16x32_bf16 v[20:23], v[60:63], v[108:111], v[20:23]
    v_mfma_f32_16x16x32_bf16 v[40:43], v[60:63], v[112:115], v[40:43]
    ds_read_b64_tr_b16 v[60:61], v13 offset:40992
    ds_read_b64_tr_b16 v[62:63], v13 offset:42272
    buffer_load_dwordx4 v2, s[8:11], s44 offen offset:1024 sc1 lds
    v_mfma_f32_16x16x32_bf16 v[24:27], v[64:67], v[108:111], v[24:27]
    v_mfma_f32_16x16x32_bf16 v[44:47], v[64:67], v[112:115], v[44:47]
    ds_read_b64_tr_b16 v[64:65], v13 offset:41024
    ds_read_b64_tr_b16 v[66:67], v13 offset:42304
    s_mov_b32 exec_hi, 0
    buffer_load_dwordx4 v2, s[8:11], s44 offen offset:2048 sc1 lds
    s_mov_b32 exec_hi, -1
    v_mfma_f32_16x16x32_bf16 v[28:31], v[68:71], v[108:111], v[28:31]
    v_mfma_f32_16x16x32_bf16 v[48:51], v[68:71], v[112:115], v[48:51]
    ds_read_b64_tr_b16 v[68:69], v13 offset:41056
    ds_read_b64_tr_b16 v[70:71], v13 offset:42336
    v_mfma_f32_16x16x32_bf16 v[32:35], v[72:75], v[108:111], v[32:35]
    v_mfma_f32_16x16x32_bf16 v[52:55], v[72:75], v[112:115], v[52:55]
    ds_read_b64_tr_b16 v[72:73], v13 offset:41088
    ds_read_b64_tr_b16 v[74:75], v13 offset:42368
    s_waitcnt vmcnt(6)
    s_waitcnt lgkmcnt(0)
    s_barrier
    v_mfma_f32_16x16x32_bf16 v[16:19], v[56:59], v[76:79], v[16:19]
    v_mfma_f32_16x16x32_bf16 v[36:39], v[56:59], v[80:83], v[36:39]
    ds_read_b64_tr_b16 v[56:57], v14 offset:0
    ds_read_b64_tr_b16 v[58:59], v14 offset:1280
    s_add_u32 s44, s39, 40960
    s_add_u32 m0, s42, 40960
    s_nop 0
    buffer_load_dwordx4 v2, s[8:11], s44 offen sc1 lds
    v_mfma_f32_16x16x32_bf16 v[20:23], v[60:63], v[76:79], v[20:23]
    v_mfma_f32_16x16x32_bf16 v[40:43], v[60:63], v[80:83], v[40:43]
    ds_read_b64_tr_b16 v[60:61], v14 offset:32
    ds_read_b64_tr_b16 v[62:63], v14 offset:1312
    buffer_load_dwordx4 v2, s[8:11], s44 offen offset:1024 sc1 lds
    v_mfma_f32_16x16x32_bf16 v[24:27], v[64:67], v[76:79], v[24:27]
    v_mfma_f32_16x16x32_bf16 v[44:47], v[64:67], v[80:83], v[44:47]
    ds_read_b64_tr_b16 v[64:65], v14 offset:64
    ds_read_b64_tr_b16 v[66:67], v14 offset:1344
    s_mov_b32 exec_hi, 0
    buffer_load_dwordx4 v2, s[8:11], s44 offen offset:2048 sc1 lds
    s_mov_b32 exec_hi, -1
    v_mfma_f32_16x16x32_bf16 v[28:31], v[68:71], v[76:79], v[28:31]
    v_mfma_f32_16x16x32_bf16 v[48:51], v[68:71], v[80:83], v[48:51]
    ds_read_b64_tr_b16 v[68:69], v14 offset:96
    ds_read_b64_tr_b16 v[70:71], v14 offset:1376
    v_mfma_f32_16x16x32_bf16 v[32:35], v[72:75], v[76:79], v[32:35]
    v_mfma_f32_16x16x32_bf16 v[52:55], v[72:75], v[80:83], v[52:55]
    ds_read_b64_tr_b16 v[72:73], v14 offset:128
    ds_read_b64_tr_b16 v[74:75], v14 offset:1408
    s_waitcnt vmcnt(6)
    s_waitcnt lgkmcnt(0)
    s_barrier
    v_mfma_f32_16x16x32_bf16 v[16:19], v[56:59], v[84:87], v[16:19]
    v_mfma_f32_16x16x32_bf16 v[36:39], v[56:59], v[88:91], v[36:39]
    ds_read_b64_tr_b16 v[56:57], v13 offset:0
    ds_read_b64_tr_b16 v[58:59], v13 offset:1280
    s_add_u32 s44, s39, 61440
    s_add_u32 m0, s42, 61440
    s_nop 0
    buffer_load_dwordx4 v2, s[8:11], s44 offen sc1 lds
    v_mfma_f32_16x16x32_bf16 v[20:23], v[60:63], v[84:87], v[20:23]
    v_mfma_f32_16x16x32_bf16 v[40:43], v[60:63], v[88:91], v[40:43]
    ds_read_b64_tr_b16 v[60:61], v13 offset:32
    ds_read_b64_tr_b16 v[62:63], v13 offset:1312
    buffer_load_dwordx4 v2, s[8:11], s44 offen offset:1024 sc1 lds
    v_mfma_f32_16x16x32_bf16 v[24:27], v[64:67], v[84:87], v[24:27]
    v_mfma_f32_16x16x32_bf16 v[44:47], v[64:67], v[88:91], v[44:47]
    ds_read_b64_tr_b16 v[64:65], v13 offset:64
    ds_read_b64_tr_b16 v[66:67], v13 offset:1344
    s_mov_b32 exec_hi, 0
    buffer_load_dwordx4 v2, s[8:11], s44 offen offset:2048 sc1 lds
    s_mov_b32 exec_hi, -1
    v_mfma_f32_16x16x32_bf16 v[28:31], v[68:71], v[84:87], v[28:31]
    v_mfma_f32_16x16x32_bf16 v[48:51], v[68:71], v[88:91], v[48:51]
    ds_read_b64_tr_b16 v[68:69], v13 offset:96
    ds_read_b64_tr_b16 v[70:71], v13 offset:1376
    v_mfma_f32_16x16x32_bf16 v[32:35], v[72:75], v[84:87], v[32:35]
    v_mfma_f32_16x16x32_bf16 v[52:55], v[72:75], v[88:91], v[52:55]
    ds_read_b64_tr_b16 v[72:73], v13 offset:128
    ds_read_b64_tr_b16 v[74:75], v13 offset:1408
    s_waitcnt lgkmcnt(0)
    s_barrier
    s_add_u32 m0, s42, 0
    s_nop 0
    buffer_load_dwordx4 v10, s[16:19], 0 offen lds
    s_add_u32 m0, s42, 1024
    s_nop 0
    buffer_load_dwordx4 v11, s[16:19], 0 offen lds
    s_add_u32 m0, s42, 2048
    s_mov_b32 exec_hi, 0
    buffer_load_dwordx4 v12, s[16:19], 0 offen lds
    s_mov_b32 exec_hi, -1
    v_xor_b32 v4, 0, v3
    v_xor_b32 v5, 32, v3
    v_xor_b32 v6, 64, v3
    v_xor_b32 v7, 96, v3
    v_xor_b32 v8, 128, v3
    s_mov_b32 s8, s62
    s_mov_b32 s9, s63
    s_mov_b32 s10, 2621440
    s_mov_b32 s11, 0x00020000
    s_cmp_lg_u32 s4, 0
    s_cbranch_scc1 L_f2q_27_para
    s_lshr_b32 s78, s32, 2
    s_lshl_b32 s78, s78, 5
    s_add_u32 s78, s78, 1024
    s_lshl_b32 s78, s78, 7
    v_lshlrev_b32 v78, 7, v1
    s_mov_b32 exec_lo, 0xffffffff
    s_mov_b32 exec_hi, 0
    s_mov_b32 s79, 100000
L_poll_28_para:
    buffer_load_dwordx2 v[76:77], v78, s[28:31], s78 offen sc1
    s_waitcnt vmcnt(0)
L_pmid_30_para:
    v_cmp_ne_u64 vcc, s[6:7], v[76:77]
    s_nop 1
    s_and_b64 exec, exec, vcc
    s_cbranch_scc0 L_polled_29_para
    s_sleep 2
    s_sub_u32 s79, s79, 1
    s_cmp_lg_u32 s79, 0
    s_cbranch_scc1 L_poll_28_para
L_polled_29_para:
    s_mov_b64 exec, -1
L_f2q_27_para:
    s_waitcnt vmcnt(0)
    s_barrier
    s_setprio 3
    buffer_load_dwordx4 v[92:95], v15, s[24:27], s47 offen offset:0 sc1
    buffer_load_dwordx4 v[96:99], v15, s[24:27], s47 offen offset:256 sc1
    s_add_u32 s47, s47, 8192
    buffer_load_dwordx4 v[100:103], v15, s[24:27], s47 offen offset:0 sc1
    buffer_load_dwordx4 v[104:107], v15, s[24:27], s47 offen offset:256 sc1
    s_add_u32 s47, s47, 8192
    buffer_load_dwordx4 v[108:111], v15, s[24:27], s47 offen offset:0 sc1
    buffer_load_dwordx4 v[112:115], v15, s[24:27], s47 offen offset:256 sc1
    s_add_u32 s47, s47, 8192
    buffer_load_dwordx4 v[76:79], v15, s[24:27], s47 offen offset:0 sc1
    buffer_load_dwordx4 v[80:83], v15, s[24:27], s47 offen offset:256 sc1
    s_add_u32 s47, s47, 8192
    buffer_load_dwordx4 v[84:87], v15, s[24:27], s47 offen offset:0 sc1
    buffer_load_dwordx4 v[88:91], v15, s[24:27], s47 offen offset:256 sc1
    s_add_u32 s47, s47, 8192
    s_waitcnt vmcnt(8)
    s_waitcnt lgkmcnt(8)
    v_mfma_f32_16x16x32_bf16 v[16:19], v[56:59], v[92:95], v[16:19]
    v_mfma_f32_16x16x32_bf16 v[36:39], v[56:59], v[96:99], v[36:39]
    ds_read_b64_tr_b16 v[56:57], v13 offset:20480
    ds_read_b64_tr_b16 v[58:59], v13 offset:21760
    s_waitcnt lgkmcnt(8)
    v_mfma_f32_16x16x32_bf16 v[20:23], v[60:63], v[92:95], v[20:23]
    v_mfma_f32_16x16x32_bf16 v[40:43], v[60:63], v[96:99], v[40:43]
    ds_read_b64_tr_b16 v[60:61], v13 offset:20512
    ds_read_b64_tr_b16 v[62:63], v13 offset:21792
    s_waitcnt lgkmcnt(8)
    v_mfma_f32_16x16x32_bf16 v[24:27], v[64:67], v[92:95], v[24:27]
    v_mfma_f32_16x16x32_bf16 v[44:47], v[64:67], v[96:99], v[44:47]
    ds_read_b64_tr_b16 v[64:65], v13 offset:20544
    ds_read_b64_tr_b16 v[66:67], v13 offset:21824
    s_waitcnt lgkmcnt(8)
    v_mfma_f32_16x16x32_bf16 v[28:31], v[68:71], v[92:95], v[28:31]
    v_mfma_f32_16x16x32_bf16 v[48:51], v[68:71], v[96:99], v[48:51]
    ds_read_b64_tr_b16 v[68:69], v13 offset:20576
    ds_read_b64_tr_b16 v[70:71], v13 offset:21856
    s_waitcnt lgkmcnt(8)
    v_mfma_f32_16x16x32_bf16 v[32:35], v[72:75], v[92:95], v[32:35]
    v_mfma_f32_16x16x32_bf16 v[52:55], v[72:75], v[96:99], v[52:55]
    ds_read_b64_tr_b16 v[72:73], v13 offset:20608
    ds_read_b64_tr_b16 v[74:75], v13 offset:21888
    s_waitcnt vmcnt(6)
    s_waitcnt lgkmcnt(8)
    v_mfma_f32_16x16x32_bf16 v[16:19], v[56:59], v[100:103], v[16:19]
    v_mfma_f32_16x16x32_bf16 v[36:39], v[56:59], v[104:107], v[36:39]
    ds_read_b64_tr_b16 v[56:57], v13 offset:40960
    ds_read_b64_tr_b16 v[58:59], v13 offset:42240
    s_waitcnt lgkmcnt(8)
    v_mfma_f32_16x16x32_bf16 v[20:23], v[60:63], v[100:103], v[20:23]
    v_mfma_f32_16x16x32_bf16 v[40:43], v[60:63], v[104:107], v[40:43]
    ds_read_b64_tr_b16 v[60:61], v13 offset:40992
    ds_read_b64_tr_b16 v[62:63], v13 offset:42272
    s_waitcnt lgkmcnt(8)
    v_mfma_f32_16x16x32_bf16 v[24:27], v[64:67], v[100:103], v[24:27]
    v_mfma_f32_16x16x32_bf16 v[44:47], v[64:67], v[104:107], v[44:47]
    ds_read_b64_tr_b16 v[64:65], v13 offset:41024
    ds_read_b64_tr_b16 v[66:67], v13 offset:42304
    s_waitcnt lgkmcnt(8)
    v_mfma_f32_16x16x32_bf16 v[28:31], v[68:71], v[100:103], v[28:31]
    v_mfma_f32_16x16x32_bf16 v[48:51], v[68:71], v[104:107], v[48:51]
    ds_read_b64_tr_b16 v[68:69], v13 offset:41056
    ds_read_b64_tr_b16 v[70:71], v13 offset:42336
    s_waitcnt lgkmcnt(8)
    v_mfma_f32_16x16x32_bf16 v[32:35], v[72:75], v[100:103], v[32:35]
    v_mfma_f32_16x16x32_bf16 v[52:55], v[72:75], v[104:107], v[52:55]
    ds_read_b64_tr_b16 v[72:73], v13 offset:41088
    ds_read_b64_tr_b16 v[74:75], v13 offset:42368
    s_waitcnt vmcnt(4)
    s_waitcnt lgkmcnt(8)
    v_mfma_f32_16x16x32_bf16 v[16:19], v[56:59], v[108:111], v[16:19]
    v_mfma_f32_16x16x32_bf16 v[36:39], v[56:59], v[112:115], v[36:39]
    ds_read_b64_tr_b16 v[56:57], v14 offset:0
    ds_read_b64_tr_b16 v[58:59], v14 offset:1280
    s_waitcnt lgkmcnt(8)
    v_mfma_f32_16x16x32_bf16 v[20:23], v[60:63], v[108:111], v[20:23]
    v_mfma_f32_16x16x32_bf16 v[40:43], v[60:63], v[112:115], v[40:43]
    ds_read_b64_tr_b16 v[60:61], v14 offset:32
    ds_read_b64_tr_b16 v[62:63], v14 offset:1312
    s_waitcnt lgkmcnt(8)
    v_mfma_f32_16x16x32_bf16 v[24:27], v[64:67], v[108:111], v[24:27]
    v_mfma_f32_16x16x32_bf16 v[44:47], v[64:67], v[112:115], v[44:47]
    ds_read_b64_tr_b16 v[64:65], v14 offset:64
    ds_read_b64_tr_b16 v[66:67], v14 offset:1344
    s_waitcnt lgkmcnt(8)
    v_mfma_f32_16x16x32_bf16 v[28:31], v[68:71], v[108:111], v[28:31]
    v_mfma_f32_16x16x32_bf16 v[48:51], v[68:71], v[112:115], v[48:51]
    ds_read_b64_tr_b16 v[68:69], v14 offset:96
    ds_read_b64_tr_b16 v[70:71], v14 offset:1376
    s_waitcnt lgkmcnt(8)
    v_mfma_f32_16x16x32_bf16 v[32:35], v[72:75], v[108:111], v[32:35]
    v_mfma_f32_16x16x32_bf16 v[52:55], v[72:75], v[112:115], v[52:55]
    ds_read_b64_tr_b16 v[72:73], v14 offset:128
    ds_read_b64_tr_b16 v[74:75], v14 offset:1408
    s_waitcnt vmcnt(2)
    s_waitcnt lgkmcnt(8)
    v_mfma_f32_16x16x32_bf16 v[16:19], v[56:59], v[76:79], v[16:19]
    v_mfma_f32_16x16x32_bf16 v[36:39], v[56:59], v[80:83], v[36:39]
    ds_read_b64_tr_b16 v[56:57], v13 offset:0
    ds_read_b64_tr_b16 v[58:59], v13 offset:1280
    s_waitcnt lgkmcnt(8)
    v_mfma_f32_16x16x32_bf16 v[20:23], v[60:63], v[76:79], v[20:23]
    v_mfma_f32_16x16x32_bf16 v[40:43], v[60:63], v[80:83], v[40:43]
    ds_read_b64_tr_b16 v[60:61], v13 offset:32
    ds_read_b64_tr_b16 v[62:63], v13 offset:1312
    s_waitcnt lgkmcnt(8)
    v_mfma_f32_16x16x32_bf16 v[24:27], v[64:67], v[76:79], v[24:27]
    v_mfma_f32_16x16x32_bf16 v[44:47], v[64:67], v[80:83], v[44:47]
    ds_read_b64_tr_b16 v[64:65], v13 offset:64
    ds_read_b64_tr_b16 v[66:67], v13 offset:1344
    s_waitcnt lgkmcnt(8)
    v_mfma_f32_16x16x32_bf16 v[28:31], v[68:71], v[76:79], v[28:31]
    v_mfma_f32_16x16x32_bf16 v[48:51], v[68:71], v[80:83], v[48:51]
    ds_read_b64_tr_b16 v[68:69], v13 offset:96
    ds_read_b64_tr_b16 v[70:71], v13 offset:1376
    s_waitcnt lgkmcnt(8)
    v_mfma_f32_16x16x32_bf16 v[32:35], v[72:75], v[76:79], v[32:35]
    v_mfma_f32_16x16x32_bf16 v[52:55], v[72:75], v[80:83], v[52:55]
    ds_read_b64_tr_b16 v[72:73], v13 offset:128
    ds_read_b64_tr_b16 v[74:75], v13 offset:1408
    s_waitcnt vmcnt(0)
    s_waitcnt lgkmcnt(8)
    v_mfma_f32_16x16x32_bf16 v[16:19], v[56:59], v[84:87], v[16:19]
    v_mfma_f32_16x16x32_bf16 v[36:39], v[56:59], v[88:91], v[36:39]
    s_waitcnt lgkmcnt(6)
    v_mfma_f32_16x16x32_bf16 v[20:23], v[60:63], v[84:87], v[20:23]
    v_mfma_f32_16x16x32_bf16 v[40:43], v[60:63], v[88:91], v[40:43]
    s_waitcnt lgkmcnt(4)
    v_mfma_f32_16x16x32_bf16 v[24:27], v[64:67], v[84:87], v[24:27]
    v_mfma_f32_16x16x32_bf16 v[44:47], v[64:67], v[88:91], v[44:47]
    s_waitcnt lgkmcnt(2)
    v_mfma_f32_16x16x32_bf16 v[28:31], v[68:71], v[84:87], v[28:31]
    v_mfma_f32_16x16x32_bf16 v[48:51], v[68:71], v[88:91], v[48:51]
    s_waitcnt lgkmcnt(0)
    v_mfma_f32_16x16x32_bf16 v[32:35], v[72:75], v[84:87], v[32:35]
    v_mfma_f32_16x16x32_bf16 v[52:55], v[72:75], v[88:91], v[52:55]
    s_barrier
    s_nop 4
    ds_write_b128 v4, v[16:19] offset:0
    ds_write_b128 v4, v[36:39] offset:5120
    ds_write_b128 v5, v[20:23] offset:1024
    ds_write_b128 v5, v[40:43] offset:6144
    ds_write_b128 v6, v[24:27] offset:2048
    ds_write_b128 v6, v[44:47] offset:7168
    ds_write_b128 v7, v[28:31] offset:3072
    ds_write_b128 v7, v[48:51] offset:8192
    ds_write_b128 v8, v[32:35] offset:4096
    ds_write_b128 v8, v[52:55] offset:9216
    s_waitcnt lgkmcnt(0)
    s_barrier
    ds_read_b128 v[16:19], v124 offset:0
    ds_read_b128 v[20:23], v124 offset:256
    ds_read_b128 v[24:27], v124 offset:20480
    ds_read_b128 v[28:31], v124 offset:20736
    ds_read_b128 v[32:35], v124 offset:40960
    ds_read_b128 v[36:39], v124 offset:41216
    ds_read_b128 v[40:43], v124 offset:61440
    ds_read_b128 v[44:47], v124 offset:61696
    s_cmp_ge_u32 s4, 2
    s_cbranch_scc1 L_f2e_31_para
    ds_read_b128 v[48:51], v125 offset:0
    ds_read_b128 v[52:55], v125 offset:256
    ds_read_b128 v[56:59], v125 offset:20480
    ds_read_b128 v[60:63], v125 offset:20736
    ds_read_b128 v[64:67], v125 offset:40960
    ds_read_b128 v[68:71], v125 offset:41216
    s_waitcnt lgkmcnt(13)
    ds_read_b128 v[72:75], v125 offset:61440
    s_waitcnt lgkmcnt(13)
    ds_read_b128 v[76:79], v125 offset:61696
    v_lshlrev_b32 v88, 16, v120
    v_and_b32 v89, 0xffff0000, v120
    v_lshlrev_b32 v90, 16, v121
    v_and_b32 v91, 0xffff0000, v121
    v_lshlrev_b32 v92, 16, v122
    v_and_b32 v93, 0xffff0000, v122
    v_lshlrev_b32 v94, 16, v123
    v_and_b32 v95, 0xffff0000, v123
    s_waitcnt lgkmcnt(0)
    v_pk_add_f32 v[48:49], v[48:49], v[56:57]
    v_pk_add_f32 v[64:65], v[64:65], v[72:73]
    v_pk_add_f32 v[50:51], v[50:51], v[58:59]
    v_pk_add_f32 v[66:67], v[66:67], v[74:75]
    v_pk_add_f32 v[52:53], v[52:53], v[60:61]
    v_pk_add_f32 v[68:69], v[68:69], v[76:77]
    v_pk_add_f32 v[54:55], v[54:55], v[62:63]
    v_pk_add_f32 v[70:71], v[70:71], v[78:79]
    v_pk_add_f32 v[48:49], v[48:49], v[88:89]
    v_pk_add_f32 v[50:51], v[50:51], v[90:91]
    v_pk_add_f32 v[52:53], v[52:53], v[92:93]
    v_pk_add_f32 v[54:55], v[54:55], v[94:95]
    v_pk_add_f32 v[48:49], v[48:49], v[64:65]
    v_pk_add_f32 v[50:51], v[50:51], v[66:67]
    v_pk_add_f32 v[52:53], v[52:53], v[68:69]
    v_pk_add_f32 v[54:55], v[54:55], v[70:71]
    v_cvt_pk_bf16_f32 v56, v48, v49
    v_cvt_pk_bf16_f32 v57, v50, v51
    v_cvt_pk_bf16_f32 v58, v52, v53
    v_cvt_pk_bf16_f32 v59, v54, v55
    buffer_store_dwordx4 v[56:59], v127, s[8:11], s43 offen
L_f2e_31_para:
    v_lshlrev_b32 v80, 16, v116
    v_and_b32 v81, 0xffff0000, v116
    v_lshlrev_b32 v82, 16, v117
    v_and_b32 v83, 0xffff0000, v117
    v_lshlrev_b32 v84, 16, v118
    v_and_b32 v85, 0xffff0000, v118
    v_lshlrev_b32 v86, 16, v119
    v_and_b32 v87, 0xffff0000, v119
    s_waitcnt lgkmcnt(0)
    v_pk_add_f32 v[16:17], v[16:17], v[24:25]
    v_pk_add_f32 v[32:33], v[32:33], v[40:41]
    v_pk_add_f32 v[18:19], v[18:19], v[26:27]
    v_pk_add_f32 v[34:35], v[34:35], v[42:43]
    v_pk_add_f32 v[20:21], v[20:21], v[28:29]
    v_pk_add_f32 v[36:37], v[36:37], v[44:45]
    v_pk_add_f32 v[22:23], v[22:23], v[30:31]
    v_pk_add_f32 v[38:39], v[38:39], v[46:47]
    v_pk_add_f32 v[16:17], v[16:17], v[80:81]
    v_pk_add_f32 v[18:19], v[18:19], v[82:83]
    v_pk_add_f32 v[20:21], v[20:21], v[84:85]
    v_pk_add_f32 v[22:23], v[22:23], v[86:87]
    v_pk_add_f32 v[16:17], v[16:17], v[32:33]
    v_pk_add_f32 v[18:19], v[18:19], v[34:35]
    v_pk_add_f32 v[20:21], v[20:21], v[36:37]
    v_pk_add_f32 v[22:23], v[22:23], v[38:39]
    v_cvt_pk_bf16_f32 v24, v16, v17
    v_cvt_pk_bf16_f32 v25, v18, v19
    v_cvt_pk_bf16_f32 v26, v20, v21
    v_cvt_pk_bf16_f32 v27, v22, v23
    buffer_store_dwordx4 v[24:27], v126, s[8:11], s43 offen
L_end:
    s_endpgm
L_skipA1:
    s_waitcnt lgkmcnt(0)
    s_add_u32 s28, s66, 19693568
    s_addc_u32 s29, s67, 0
    s_mov_b32 s30, 196608
    s_mov_b32 s31, 0x00020000
    s_branch L_a2
L_a1c:
    s_and_b32 s36, s4, 1
    s_lshr_b32 s37, s4, 1
    v_and_b32 v3, 31, v1
    v_lshrrev_b32 v10, 5, v1
    s_lshl_b32 s38, s36, 6
    v_add_u32 v11, s38, v3
    v_lshlrev_b32 v11, 7, v11
    v_bfe_u32 v12, v1, 1, 3
    v_xor_b32 v12, v12, v10
    v_lshl_add_u32 v4, v12, 4, v11
    v_xor_b32 v5, 32, v4
    v_xor_b32 v6, 64, v4
    v_xor_b32 v7, 96, v4
    v_bfe_u32 v13, v1, 2, 2
    v_lshl_add_u32 v14, v10, 3, v13
    v_lshlrev_b32 v14, 8, v14
    v_bfe_u32 v15, v1, 4, 1
    v_lshl_add_u32 v14, v15, 5, v14
    v_and_b32 v15, 3, v1
    v_lshl_add_u32 v14, v15, 3, v14
    v_lshl_add_u32 v14, v13, 6, v14
    s_lshl_b32 s38, s37, 7
    v_xor_b32 v14, s38, v14
    v_add_u32 v8, 49152, v14
    v_xor_b32 v9, 64, v8
    s_waitcnt lgkmcnt(0)
    s_add_u32 s28, s66, 19693568
    s_addc_u32 s29, s67, 0
    s_mov_b32 s30, 196608
    s_mov_b32 s31, 0x00020000
    s_cmp_ge_u32 s33, 10
    s_cbranch_scc1 L_a1v_33_para
    s_add_u32 s16, s66, 2621440
    s_addc_u32 s17, s67, 0
    s_mov_b32 s18, 5242880
    s_mov_b32 s19, 0x00020000
    s_cmp_lt_u32 s33, 5
    s_cselect_b32 s47, 0x3ea52b5c, 1.0
    s_lshl_b32 s38, s36, 6
    v_lshl_add_u32 v11, v3, 1, s38
    v_lshlrev_b32 v12, 2, v11
    s_lshl_b32 s38, s37, 8
    v_lshl_add_u32 v13, v10, 4, s38
    v_lshlrev_b32 v11, 3, v11
    s_lshl_b32 s39, s32, 10
    v_add_u32 v11, s39, v11
    v_lshl_add_u32 v11, v10, 14, v11
    s_lshl_b32 s40, s33, 19
    s_lshl_b32 s41, s37, 18
    s_add_u32 s40, s40, s41
    s_barrier
    ds_read_b64_tr_b16 v[88:89], v8 offset:0
    ds_read_b64_tr_b16 v[90:91], v8 offset:1024
    ds_read_b128 v[80:83], v4 offset:0
    ds_read_b128 v[84:87], v4 offset:4096
    ds_read_b64_tr_b16 v[92:93], v9 offset:0
    ds_read_b64_tr_b16 v[94:95], v9 offset:1024
    ds_read_b64_tr_b16 v[104:105], v8 offset:4096
    ds_read_b64_tr_b16 v[106:107], v8 offset:5120
    ds_read_b128 v[96:99], v5 offset:0
    ds_read_b128 v[100:103], v5 offset:4096
    ds_read_b64_tr_b16 v[108:109], v9 offset:4096
    ds_read_b64_tr_b16 v[110:111], v9 offset:5120
    s_waitcnt lgkmcnt(6)
    v_mfma_f32_32x32x16_bf16 v[16:31], v[88:91], v[80:83], 0
    v_mfma_f32_32x32x16_bf16 v[32:47], v[88:91], v[84:87], 0
    v_mfma_f32_32x32x16_bf16 v[64:79], v[92:95], v[84:87], 0
    s_waitcnt lgkmcnt(0)
    s_barrier
    ds_read_b64_tr_b16 v[120:121], v8 offset:8192
    ds_read_b64_tr_b16 v[122:123], v8 offset:9216
    ds_read_b128 v[112:115], v6 offset:0
    v_mfma_f32_32x32x16_bf16 v[48:63], v[92:95], v[80:83], 0
    ds_read_b128 v[116:119], v6 offset:4096
    ds_read_b64_tr_b16 v[124:125], v9 offset:8192
    ds_read_b64_tr_b16 v[126:127], v9 offset:9216
    v_mfma_f32_32x32x16_bf16 v[16:31], v[104:107], v[96:99], v[16:31]
    ds_read_b64_tr_b16 v[88:89], v8 offset:12288
    ds_read_b64_tr_b16 v[90:91], v8 offset:13312
    ds_read_b128 v[80:83], v7 offset:0
    v_mfma_f32_32x32x16_bf16 v[32:47], v[104:107], v[100:103], v[32:47]
    ds_read_b128 v[84:87], v7 offset:4096
    ds_read_b64_tr_b16 v[92:93], v9 offset:12288
    ds_read_b64_tr_b16 v[94:95], v9 offset:13312
    v_mfma_f32_32x32x16_bf16 v[64:79], v[108:111], v[100:103], v[64:79]
    v_mfma_f32_32x32x16_bf16 v[48:63], v[108:111], v[96:99], v[48:63]
    s_waitcnt lgkmcnt(6)
    v_mfma_f32_32x32x16_bf16 v[16:31], v[120:123], v[112:115], v[16:31]
    v_mfma_f32_32x32x16_bf16 v[32:47], v[120:123], v[116:119], v[32:47]
    v_mfma_f32_32x32x16_bf16 v[64:79], v[124:127], v[116:119], v[64:79]
    s_waitcnt lgkmcnt(0)
    s_barrier
    ds_read_b64_tr_b16 v[104:105], v8 offset:16384
    ds_read_b64_tr_b16 v[106:107], v8 offset:17408
    ds_read_b128 v[96:99], v4 offset:16384
    v_mfma_f32_32x32x16_bf16 v[48:63], v[124:127], v[112:115], v[48:63]
    ds_read_b128 v[100:103], v4 offset:20480
    ds_read_b64_tr_b16 v[108:109], v9 offset:16384
    ds_read_b64_tr_b16 v[110:111], v9 offset:17408
    v_mfma_f32_32x32x16_bf16 v[16:31], v[88:91], v[80:83], v[16:31]
    ds_read_b64_tr_b16 v[120:121], v8 offset:20480
    ds_read_b64_tr_b16 v[122:123], v8 offset:21504
    ds_read_b128 v[112:115], v5 offset:16384
    v_mfma_f32_32x32x16_bf16 v[32:47], v[88:91], v[84:87], v[32:47]
    ds_read_b128 v[116:119], v5 offset:20480
    ds_read_b64_tr_b16 v[124:125], v9 offset:20480
    ds_read_b64_tr_b16 v[126:127], v9 offset:21504
    v_mfma_f32_32x32x16_bf16 v[64:79], v[92:95], v[84:87], v[64:79]
    v_mfma_f32_32x32x16_bf16 v[48:63], v[92:95], v[80:83], v[48:63]
    s_waitcnt lgkmcnt(6)
    v_mfma_f32_32x32x16_bf16 v[16:31], v[104:107], v[96:99], v[16:31]
    v_mfma_f32_32x32x16_bf16 v[32:47], v[104:107], v[100:103], v[32:47]
    v_mfma_f32_32x32x16_bf16 v[64:79], v[108:111], v[100:103], v[64:79]
    s_waitcnt lgkmcnt(0)
    s_barrier
    ds_read_b64_tr_b16 v[88:89], v8 offset:24576
    ds_read_b64_tr_b16 v[90:91], v8 offset:25600
    ds_read_b128 v[80:83], v6 offset:16384
    v_mfma_f32_32x32x16_bf16 v[48:63], v[108:111], v[96:99], v[48:63]
    ds_read_b128 v[84:87], v6 offset:20480
    ds_read_b64_tr_b16 v[92:93], v9 offset:24576
    ds_read_b64_tr_b16 v[94:95], v9 offset:25600
    v_mfma_f32_32x32x16_bf16 v[16:31], v[120:123], v[112:115], v[16:31]
    ds_read_b64_tr_b16 v[104:105], v8 offset:28672
    ds_read_b64_tr_b16 v[106:107], v8 offset:29696
    ds_read_b128 v[96:99], v7 offset:16384
    v_mfma_f32_32x32x16_bf16 v[32:47], v[120:123], v[116:119], v[32:47]
    ds_read_b128 v[100:103], v7 offset:20480
    ds_read_b64_tr_b16 v[108:109], v9 offset:28672
    ds_read_b64_tr_b16 v[110:111], v9 offset:29696
    v_mfma_f32_32x32x16_bf16 v[64:79], v[124:127], v[116:119], v[64:79]
    v_mfma_f32_32x32x16_bf16 v[48:63], v[124:127], v[112:115], v[48:63]
    s_waitcnt lgkmcnt(6)
    v_mfma_f32_32x32x16_bf16 v[16:31], v[88:91], v[80:83], v[16:31]
    v_mfma_f32_32x32x16_bf16 v[32:47], v[88:91], v[84:87], v[32:47]
    v_mfma_f32_32x32x16_bf16 v[64:79], v[92:95], v[84:87], v[64:79]
    s_waitcnt lgkmcnt(0)
    s_barrier
    ds_read_b64_tr_b16 v[120:121], v8 offset:0
    ds_read_b64_tr_b16 v[122:123], v8 offset:1024
    ds_read_b128 v[112:115], v4 offset:32768
    v_mfma_f32_32x32x16_bf16 v[48:63], v[92:95], v[80:83], v[48:63]
    ds_read_b128 v[116:119], v4 offset:36864
    ds_read_b64_tr_b16 v[124:125], v9 offset:0
    ds_read_b64_tr_b16 v[126:127], v9 offset:1024
    v_mfma_f32_32x32x16_bf16 v[16:31], v[104:107], v[96:99], v[16:31]
    ds_read_b64_tr_b16 v[88:89], v8 offset:4096
    ds_read_b64_tr_b16 v[90:91], v8 offset:5120
    ds_read_b128 v[80:83], v5 offset:32768
    v_mfma_f32_32x32x16_bf16 v[32:47], v[104:107], v[100:103], v[32:47]
    ds_read_b128 v[84:87], v5 offset:36864
    ds_read_b64_tr_b16 v[92:93], v9 offset:4096
    ds_read_b64_tr_b16 v[94:95], v9 offset:5120
    v_mfma_f32_32x32x16_bf16 v[64:79], v[108:111], v[100:103], v[64:79]
    v_mfma_f32_32x32x16_bf16 v[48:63], v[108:111], v[96:99], v[48:63]
    s_waitcnt lgkmcnt(6)
    v_mfma_f32_32x32x16_bf16 v[16:31], v[120:123], v[112:115], v[16:31]
    v_mfma_f32_32x32x16_bf16 v[32:47], v[120:123], v[116:119], v[32:47]
    v_mfma_f32_32x32x16_bf16 v[64:79], v[124:127], v[116:119], v[64:79]
    s_waitcnt lgkmcnt(0)
    s_barrier
    ds_read_b64_tr_b16 v[104:105], v8 offset:8192
    ds_read_b64_tr_b16 v[106:107], v8 offset:9216
    ds_read_b128 v[96:99], v6 offset:32768
    v_mfma_f32_32x32x16_bf16 v[48:63], v[124:127], v[112:115], v[48:63]
    ds_read_b128 v[100:103], v6 offset:36864
    ds_read_b64_tr_b16 v[108:109], v9 offset:8192
    ds_read_b64_tr_b16 v[110:111], v9 offset:9216
    v_mfma_f32_32x32x16_bf16 v[16:31], v[88:91], v[80:83], v[16:31]
    ds_read_b64_tr_b16 v[120:121], v8 offset:12288
    ds_read_b64_tr_b16 v[122:123], v8 offset:13312
    ds_read_b128 v[112:115], v7 offset:32768
    v_mfma_f32_32x32x16_bf16 v[32:47], v[88:91], v[84:87], v[32:47]
    ds_read_b128 v[116:119], v7 offset:36864
    ds_read_b64_tr_b16 v[124:125], v9 offset:12288
    ds_read_b64_tr_b16 v[126:127], v9 offset:13312
    v_mfma_f32_32x32x16_bf16 v[64:79], v[92:95], v[84:87], v[64:79]
    v_mfma_f32_32x32x16_bf16 v[48:63], v[92:95], v[80:83], v[48:63]
    s_waitcnt lgkmcnt(6)
    v_mfma_f32_32x32x16_bf16 v[16:31], v[104:107], v[96:99], v[16:31]
    v_mfma_f32_32x32x16_bf16 v[32:47], v[104:107], v[100:103], v[32:47]
    v_mfma_f32_32x32x16_bf16 v[64:79], v[108:111], v[100:103], v[64:79]
    s_waitcnt lgkmcnt(0)
    s_barrier
    ds_read_b64_tr_b16 v[88:89], v8 offset:16384
    ds_read_b64_tr_b16 v[90:91], v8 offset:17408
    ds_read_b128 v[80:83], v4 offset:0
    v_mfma_f32_32x32x16_bf16 v[48:63], v[108:111], v[96:99], v[48:63]
    ds_read_b128 v[84:87], v4 offset:4096
    ds_read_b64_tr_b16 v[92:93], v9 offset:16384
    ds_read_b64_tr_b16 v[94:95], v9 offset:17408
    v_mfma_f32_32x32x16_bf16 v[16:31], v[120:123], v[112:115], v[16:31]
    ds_read_b64_tr_b16 v[104:105], v8 offset:20480
    ds_read_b64_tr_b16 v[106:107], v8 offset:21504
    ds_read_b128 v[96:99], v5 offset:0
    v_mfma_f32_32x32x16_bf16 v[32:47], v[120:123], v[116:119], v[32:47]
    ds_read_b128 v[100:103], v5 offset:4096
    ds_read_b64_tr_b16 v[108:109], v9 offset:20480
    ds_read_b64_tr_b16 v[110:111], v9 offset:21504
    v_mfma_f32_32x32x16_bf16 v[64:79], v[124:127], v[116:119], v[64:79]
    v_mfma_f32_32x32x16_bf16 v[48:63], v[124:127], v[112:115], v[48:63]
    s_waitcnt lgkmcnt(6)
    v_mfma_f32_32x32x16_bf16 v[16:31], v[88:91], v[80:83], v[16:31]
    v_mfma_f32_32x32x16_bf16 v[32:47], v[88:91], v[84:87], v[32:47]
    v_mfma_f32_32x32x16_bf16 v[64:79], v[92:95], v[84:87], v[64:79]
    s_waitcnt lgkmcnt(0)
    s_barrier
    ds_read_b64_tr_b16 v[120:121], v8 offset:24576
    ds_read_b64_tr_b16 v[122:123], v8 offset:25600
    ds_read_b128 v[112:115], v6 offset:0
    v_mfma_f32_32x32x16_bf16 v[48:63], v[92:95], v[80:83], v[48:63]
    ds_read_b128 v[116:119], v6 offset:4096
    ds_read_b64_tr_b16 v[124:125], v9 offset:24576
    ds_read_b64_tr_b16 v[126:127], v9 offset:25600
    v_mfma_f32_32x32x16_bf16 v[16:31], v[104:107], v[96:99], v[16:31]
    ds_read_b64_tr_b16 v[88:89], v8 offset:28672
    ds_read_b64_tr_b16 v[90:91], v8 offset:29696
    ds_read_b128 v[80:83], v7 offset:0
    v_mfma_f32_32x32x16_bf16 v[32:47], v[104:107], v[100:103], v[32:47]
    ds_read_b128 v[84:87], v7 offset:4096
    ds_read_b64_tr_b16 v[92:93], v9 offset:28672
    ds_read_b64_tr_b16 v[94:95], v9 offset:29696
    v_mfma_f32_32x32x16_bf16 v[64:79], v[108:111], v[100:103], v[64:79]
    v_mfma_f32_32x32x16_bf16 v[48:63], v[108:111], v[96:99], v[48:63]
    s_waitcnt lgkmcnt(6)
    v_mfma_f32_32x32x16_bf16 v[16:31], v[120:123], v[112:115], v[16:31]
    v_mfma_f32_32x32x16_bf16 v[32:47], v[120:123], v[116:119], v[32:47]
    v_mfma_f32_32x32x16_bf16 v[64:79], v[124:127], v[116:119], v[64:79]
    s_waitcnt lgkmcnt(0)
    s_barrier
    ds_read_b64_tr_b16 v[104:105], v8 offset:0
    ds_read_b64_tr_b16 v[106:107], v8 offset:1024
    ds_read_b128 v[96:99], v4 offset:16384
    v_mfma_f32_32x32x16_bf16 v[48:63], v[124:127], v[112:115], v[48:63]
    ds_read_b128 v[100:103], v4 offset:20480
    ds_read_b64_tr_b16 v[108:109], v9 offset:0
    ds_read_b64_tr_b16 v[110:111], v9 offset:1024
    v_mfma_f32_32x32x16_bf16 v[16:31], v[88:91], v[80:83], v[16:31]
    ds_read_b64_tr_b16 v[120:121], v8 offset:4096
    ds_read_b64_tr_b16 v[122:123], v8 offset:5120
    ds_read_b128 v[112:115], v5 offset:16384
    v_mfma_f32_32x32x16_bf16 v[32:47], v[88:91], v[84:87], v[32:47]
    ds_read_b128 v[116:119], v5 offset:20480
    ds_read_b64_tr_b16 v[124:125], v9 offset:4096
    ds_read_b64_tr_b16 v[126:127], v9 offset:5120
    v_mfma_f32_32x32x16_bf16 v[64:79], v[92:95], v[84:87], v[64:79]
    v_mfma_f32_32x32x16_bf16 v[48:63], v[92:95], v[80:83], v[48:63]
    s_waitcnt lgkmcnt(6)
    v_mfma_f32_32x32x16_bf16 v[16:31], v[104:107], v[96:99], v[16:31]
    v_mfma_f32_32x32x16_bf16 v[32:47], v[104:107], v[100:103], v[32:47]
    v_mfma_f32_32x32x16_bf16 v[64:79], v[108:111], v[100:103], v[64:79]
    s_waitcnt lgkmcnt(0)
    s_barrier
    ds_read_b64_tr_b16 v[88:89], v8 offset:8192
    ds_read_b64_tr_b16 v[90:91], v8 offset:9216
    ds_read_b128 v[80:83], v6 offset:16384
    v_mfma_f32_32x32x16_bf16 v[48:63], v[108:111], v[96:99], v[48:63]
    ds_read_b128 v[84:87], v6 offset:20480
    ds_read_b64_tr_b16 v[92:93], v9 offset:8192
    ds_read_b64_tr_b16 v[94:95], v9 offset:9216
    v_mfma_f32_32x32x16_bf16 v[16:31], v[120:123], v[112:115], v[16:31]
    ds_read_b64_tr_b16 v[104:105], v8 offset:12288
    ds_read_b64_tr_b16 v[106:107], v8 offset:13312
    ds_read_b128 v[96:99], v7 offset:16384
    v_mfma_f32_32x32x16_bf16 v[32:47], v[120:123], v[116:119], v[32:47]
    ds_read_b128 v[100:103], v7 offset:20480
    ds_read_b64_tr_b16 v[108:109], v9 offset:12288
    ds_read_b64_tr_b16 v[110:111], v9 offset:13312
    v_mfma_f32_32x32x16_bf16 v[64:79], v[124:127], v[116:119], v[64:79]
    v_mfma_f32_32x32x16_bf16 v[48:63], v[124:127], v[112:115], v[48:63]
    s_waitcnt lgkmcnt(6)
    v_mfma_f32_32x32x16_bf16 v[16:31], v[88:91], v[80:83], v[16:31]
    v_mfma_f32_32x32x16_bf16 v[32:47], v[88:91], v[84:87], v[32:47]
    v_mfma_f32_32x32x16_bf16 v[64:79], v[92:95], v[84:87], v[64:79]
    s_waitcnt lgkmcnt(0)
    s_barrier
    ds_read_b64_tr_b16 v[120:121], v8 offset:16384
    ds_read_b64_tr_b16 v[122:123], v8 offset:17408
    ds_read_b128 v[112:115], v4 offset:32768
    v_mfma_f32_32x32x16_bf16 v[48:63], v[92:95], v[80:83], v[48:63]
    ds_read_b128 v[116:119], v4 offset:36864
    ds_read_b64_tr_b16 v[124:125], v9 offset:16384
    ds_read_b64_tr_b16 v[126:127], v9 offset:17408
    v_mfma_f32_32x32x16_bf16 v[16:31], v[104:107], v[96:99], v[16:31]
    ds_read_b64_tr_b16 v[88:89], v8 offset:20480
    ds_read_b64_tr_b16 v[90:91], v8 offset:21504
    ds_read_b128 v[80:83], v5 offset:32768
    v_mfma_f32_32x32x16_bf16 v[32:47], v[104:107], v[100:103], v[32:47]
    ds_read_b128 v[84:87], v5 offset:36864
    ds_read_b64_tr_b16 v[92:93], v9 offset:20480
    ds_read_b64_tr_b16 v[94:95], v9 offset:21504
    v_mfma_f32_32x32x16_bf16 v[64:79], v[108:111], v[100:103], v[64:79]
    v_mfma_f32_32x32x16_bf16 v[48:63], v[108:111], v[96:99], v[48:63]
    s_waitcnt lgkmcnt(6)
    v_mfma_f32_32x32x16_bf16 v[16:31], v[120:123], v[112:115], v[16:31]
    v_mfma_f32_32x32x16_bf16 v[32:47], v[120:123], v[116:119], v[32:47]
    v_mfma_f32_32x32x16_bf16 v[64:79], v[124:127], v[116:119], v[64:79]
    s_waitcnt lgkmcnt(0)
    s_barrier
    ds_read_b64_tr_b16 v[104:105], v8 offset:24576
    ds_read_b64_tr_b16 v[106:107], v8 offset:25600
    ds_read_b128 v[96:99], v6 offset:32768
    v_mfma_f32_32x32x16_bf16 v[48:63], v[124:127], v[112:115], v[48:63]
    ds_read_b128 v[100:103], v6 offset:36864
    ds_read_b64_tr_b16 v[108:109], v9 offset:24576
    ds_read_b64_tr_b16 v[110:111], v9 offset:25600
    v_mfma_f32_32x32x16_bf16 v[16:31], v[88:91], v[80:83], v[16:31]
    ds_read_b64_tr_b16 v[120:121], v8 offset:28672
    ds_read_b64_tr_b16 v[122:123], v8 offset:29696
    ds_read_b128 v[112:115], v7 offset:32768
    v_mfma_f32_32x32x16_bf16 v[32:47], v[88:91], v[84:87], v[32:47]
    ds_read_b128 v[116:119], v7 offset:36864
    ds_read_b64_tr_b16 v[124:125], v9 offset:28672
    ds_read_b64_tr_b16 v[126:127], v9 offset:29696
    v_mfma_f32_32x32x16_bf16 v[64:79], v[92:95], v[84:87], v[64:79]
    v_mfma_f32_32x32x16_bf16 v[48:63], v[92:95], v[80:83], v[48:63]
    s_waitcnt lgkmcnt(6)
    v_mfma_f32_32x32x16_bf16 v[16:31], v[104:107], v[96:99], v[16:31]
    v_mfma_f32_32x32x16_bf16 v[32:47], v[104:107], v[100:103], v[32:47]
    v_mfma_f32_32x32x16_bf16 v[64:79], v[108:111], v[100:103], v[64:79]
    s_waitcnt lgkmcnt(0)
    s_barrier
    ds_read_b64_tr_b16 v[88:89], v8 offset:0
    ds_read_b64_tr_b16 v[90:91], v8 offset:1024
    ds_read_b128 v[80:83], v4 offset:0
    v_mfma_f32_32x32x16_bf16 v[48:63], v[108:111], v[96:99], v[48:63]
    ds_read_b128 v[84:87], v4 offset:4096
    ds_read_b64_tr_b16 v[92:93], v9 offset:0
    ds_read_b64_tr_b16 v[94:95], v9 offset:1024
    v_mfma_f32_32x32x16_bf16 v[16:31], v[120:123], v[112:115], v[16:31]
    ds_read_b64_tr_b16 v[104:105], v8 offset:4096
    ds_read_b64_tr_b16 v[106:107], v8 offset:5120
    ds_read_b128 v[96:99], v5 offset:0
    v_mfma_f32_32x32x16_bf16 v[32:47], v[120:123], v[116:119], v[32:47]
    ds_read_b128 v[100:103], v5 offset:4096
    ds_read_b64_tr_b16 v[108:109], v9 offset:4096
    ds_read_b64_tr_b16 v[110:111], v9 offset:5120
    v_mfma_f32_32x32x16_bf16 v[64:79], v[124:127], v[116:119], v[64:79]
    v_mfma_f32_32x32x16_bf16 v[48:63], v[124:127], v[112:115], v[48:63]
    s_waitcnt lgkmcnt(6)
    v_mfma_f32_32x32x16_bf16 v[16:31], v[88:91], v[80:83], v[16:31]
    v_mfma_f32_32x32x16_bf16 v[32:47], v[88:91], v[84:87], v[32:47]
    v_mfma_f32_32x32x16_bf16 v[64:79], v[92:95], v[84:87], v[64:79]
    s_waitcnt lgkmcnt(0)
    s_barrier
    ds_read_b64_tr_b16 v[120:121], v8 offset:8192
    ds_read_b64_tr_b16 v[122:123], v8 offset:9216
    ds_read_b128 v[112:115], v6 offset:0
    v_mfma_f32_32x32x16_bf16 v[48:63], v[92:95], v[80:83], v[48:63]
    ds_read_b128 v[116:119], v6 offset:4096
    ds_read_b64_tr_b16 v[124:125], v9 offset:8192
    ds_read_b64_tr_b16 v[126:127], v9 offset:9216
    v_mfma_f32_32x32x16_bf16 v[16:31], v[104:107], v[96:99], v[16:31]
    ds_read_b64_tr_b16 v[88:89], v8 offset:12288
    ds_read_b64_tr_b16 v[90:91], v8 offset:13312
    ds_read_b128 v[80:83], v7 offset:0
    v_mfma_f32_32x32x16_bf16 v[32:47], v[104:107], v[100:103], v[32:47]
    ds_read_b128 v[84:87], v7 offset:4096
    ds_read_b64_tr_b16 v[92:93], v9 offset:12288
    ds_read_b64_tr_b16 v[94:95], v9 offset:13312
    v_mfma_f32_32x32x16_bf16 v[64:79], v[108:111], v[100:103], v[64:79]
    v_mfma_f32_32x32x16_bf16 v[48:63], v[108:111], v[96:99], v[48:63]
    s_waitcnt lgkmcnt(6)
    v_mfma_f32_32x32x16_bf16 v[16:31], v[120:123], v[112:115], v[16:31]
    v_mfma_f32_32x32x16_bf16 v[32:47], v[120:123], v[116:119], v[32:47]
    v_mfma_f32_32x32x16_bf16 v[64:79], v[124:127], v[116:119], v[64:79]
    s_waitcnt lgkmcnt(0)
    s_barrier
    ds_read_b64_tr_b16 v[104:105], v8 offset:16384
    ds_read_b64_tr_b16 v[106:107], v8 offset:17408
    ds_read_b128 v[96:99], v4 offset:16384
    v_mfma_f32_32x32x16_bf16 v[48:63], v[124:127], v[112:115], v[48:63]
    ds_read_b128 v[100:103], v4 offset:20480
    ds_read_b64_tr_b16 v[108:109], v9 offset:16384
    ds_read_b64_tr_b16 v[110:111], v9 offset:17408
    v_mfma_f32_32x32x16_bf16 v[16:31], v[88:91], v[80:83], v[16:31]
    ds_read_b64_tr_b16 v[120:121], v8 offset:20480
    ds_read_b64_tr_b16 v[122:123], v8 offset:21504
    ds_read_b128 v[112:115], v5 offset:16384
    v_mfma_f32_32x32x16_bf16 v[32:47], v[88:91], v[84:87], v[32:47]
    ds_read_b128 v[116:119], v5 offset:20480
    ds_read_b64_tr_b16 v[124:125], v9 offset:20480
    ds_read_b64_tr_b16 v[126:127], v9 offset:21504
    v_mfma_f32_32x32x16_bf16 v[64:79], v[92:95], v[84:87], v[64:79]
    v_mfma_f32_32x32x16_bf16 v[48:63], v[92:95], v[80:83], v[48:63]
    s_waitcnt lgkmcnt(6)
    v_mfma_f32_32x32x16_bf16 v[16:31], v[104:107], v[96:99], v[16:31]
    v_mfma_f32_32x32x16_bf16 v[32:47], v[104:107], v[100:103], v[32:47]
    v_mfma_f32_32x32x16_bf16 v[64:79], v[108:111], v[100:103], v[64:79]
    s_waitcnt lgkmcnt(0)
    s_barrier
    ds_read_b64_tr_b16 v[88:89], v8 offset:24576
    ds_read_b64_tr_b16 v[90:91], v8 offset:25600
    ds_read_b128 v[80:83], v6 offset:16384
    v_mfma_f32_32x32x16_bf16 v[48:63], v[108:111], v[96:99], v[48:63]
    ds_read_b128 v[84:87], v6 offset:20480
    ds_read_b64_tr_b16 v[92:93], v9 offset:24576
    ds_read_b64_tr_b16 v[94:95], v9 offset:25600
    v_mfma_f32_32x32x16_bf16 v[16:31], v[120:123], v[112:115], v[16:31]
    ds_read_b64_tr_b16 v[104:105], v8 offset:28672
    ds_read_b64_tr_b16 v[106:107], v8 offset:29696
    ds_read_b128 v[96:99], v7 offset:16384
    v_mfma_f32_32x32x16_bf16 v[32:47], v[120:123], v[116:119], v[32:47]
    ds_read_b128 v[100:103], v7 offset:20480
    ds_read_b64_tr_b16 v[108:109], v9 offset:28672
    ds_read_b64_tr_b16 v[110:111], v9 offset:29696
    v_mfma_f32_32x32x16_bf16 v[64:79], v[124:127], v[116:119], v[64:79]
    v_mfma_f32_32x32x16_bf16 v[48:63], v[124:127], v[112:115], v[48:63]
    s_waitcnt lgkmcnt(6)
    v_mfma_f32_32x32x16_bf16 v[16:31], v[88:91], v[80:83], v[16:31]
    v_mfma_f32_32x32x16_bf16 v[32:47], v[88:91], v[84:87], v[32:47]
    v_mfma_f32_32x32x16_bf16 v[64:79], v[92:95], v[84:87], v[64:79]
    s_waitcnt lgkmcnt(0)
    s_barrier
    ds_read_b64_tr_b16 v[120:121], v8 offset:0
    ds_read_b64_tr_b16 v[122:123], v8 offset:1024
    ds_read_b128 v[112:115], v4 offset:32768
    v_mfma_f32_32x32x16_bf16 v[48:63], v[92:95], v[80:83], v[48:63]
    ds_read_b128 v[116:119], v4 offset:36864
    ds_read_b64_tr_b16 v[124:125], v9 offset:0
    ds_read_b64_tr_b16 v[126:127], v9 offset:1024
    v_mfma_f32_32x32x16_bf16 v[16:31], v[104:107], v[96:99], v[16:31]
    ds_read_b64_tr_b16 v[88:89], v8 offset:4096
    ds_read_b64_tr_b16 v[90:91], v8 offset:5120
    ds_read_b128 v[80:83], v5 offset:32768
    v_mfma_f32_32x32x16_bf16 v[32:47], v[104:107], v[100:103], v[32:47]
    ds_read_b128 v[84:87], v5 offset:36864
    ds_read_b64_tr_b16 v[92:93], v9 offset:4096
    ds_read_b64_tr_b16 v[94:95], v9 offset:5120
    v_mfma_f32_32x32x16_bf16 v[64:79], v[108:111], v[100:103], v[64:79]
    v_mfma_f32_32x32x16_bf16 v[48:63], v[108:111], v[96:99], v[48:63]
    s_waitcnt lgkmcnt(6)
    v_mfma_f32_32x32x16_bf16 v[16:31], v[120:123], v[112:115], v[16:31]
    v_mfma_f32_32x32x16_bf16 v[32:47], v[120:123], v[116:119], v[32:47]
    v_mfma_f32_32x32x16_bf16 v[64:79], v[124:127], v[116:119], v[64:79]
    s_waitcnt lgkmcnt(0)
    s_barrier
    ds_read_b64_tr_b16 v[104:105], v8 offset:8192
    ds_read_b64_tr_b16 v[106:107], v8 offset:9216
    ds_read_b128 v[96:99], v6 offset:32768
    v_mfma_f32_32x32x16_bf16 v[48:63], v[124:127], v[112:115], v[48:63]
    ds_read_b128 v[100:103], v6 offset:36864
    ds_read_b64_tr_b16 v[108:109], v9 offset:8192
    ds_read_b64_tr_b16 v[110:111], v9 offset:9216
    v_mfma_f32_32x32x16_bf16 v[16:31], v[88:91], v[80:83], v[16:31]
    ds_read_b64_tr_b16 v[120:121], v8 offset:12288
    ds_read_b64_tr_b16 v[122:123], v8 offset:13312
    ds_read_b128 v[112:115], v7 offset:32768
    v_mfma_f32_32x32x16_bf16 v[32:47], v[88:91], v[84:87], v[32:47]
    ds_read_b128 v[116:119], v7 offset:36864
    ds_read_b64_tr_b16 v[124:125], v9 offset:12288
    ds_read_b64_tr_b16 v[126:127], v9 offset:13312
    v_mfma_f32_32x32x16_bf16 v[64:79], v[92:95], v[84:87], v[64:79]
    v_mfma_f32_32x32x16_bf16 v[48:63], v[92:95], v[80:83], v[48:63]
    s_waitcnt lgkmcnt(6)
    v_mfma_f32_32x32x16_bf16 v[16:31], v[104:107], v[96:99], v[16:31]
    v_mfma_f32_32x32x16_bf16 v[32:47], v[104:107], v[100:103], v[32:47]
    v_mfma_f32_32x32x16_bf16 v[64:79], v[108:111], v[100:103], v[64:79]
    s_waitcnt lgkmcnt(0)
    s_barrier
    ds_read_b64_tr_b16 v[88:89], v8 offset:16384
    ds_read_b64_tr_b16 v[90:91], v8 offset:17408
    ds_read_b128 v[80:83], v4 offset:0
    v_mfma_f32_32x32x16_bf16 v[48:63], v[108:111], v[96:99], v[48:63]
    ds_read_b128 v[84:87], v4 offset:4096
    ds_read_b64_tr_b16 v[92:93], v9 offset:16384
    ds_read_b64_tr_b16 v[94:95], v9 offset:17408
    v_mfma_f32_32x32x16_bf16 v[16:31], v[120:123], v[112:115], v[16:31]
    ds_read_b64_tr_b16 v[104:105], v8 offset:20480
    ds_read_b64_tr_b16 v[106:107], v8 offset:21504
    ds_read_b128 v[96:99], v5 offset:0
    v_mfma_f32_32x32x16_bf16 v[32:47], v[120:123], v[116:119], v[32:47]
    ds_read_b128 v[100:103], v5 offset:4096
    ds_read_b64_tr_b16 v[108:109], v9 offset:20480
    ds_read_b64_tr_b16 v[110:111], v9 offset:21504
    v_mfma_f32_32x32x16_bf16 v[64:79], v[124:127], v[116:119], v[64:79]
    v_mfma_f32_32x32x16_bf16 v[48:63], v[124:127], v[112:115], v[48:63]
    s_waitcnt lgkmcnt(6)
    v_mfma_f32_32x32x16_bf16 v[16:31], v[88:91], v[80:83], v[16:31]
    v_mfma_f32_32x32x16_bf16 v[32:47], v[88:91], v[84:87], v[32:47]
    v_mfma_f32_32x32x16_bf16 v[64:79], v[92:95], v[84:87], v[64:79]
    s_waitcnt lgkmcnt(0)
    s_barrier
    ds_read_b64_tr_b16 v[120:121], v8 offset:24576
    ds_read_b64_tr_b16 v[122:123], v8 offset:25600
    ds_read_b128 v[112:115], v6 offset:0
    v_mfma_f32_32x32x16_bf16 v[48:63], v[92:95], v[80:83], v[48:63]
    ds_read_b128 v[116:119], v6 offset:4096
    ds_read_b64_tr_b16 v[124:125], v9 offset:24576
    ds_read_b64_tr_b16 v[126:127], v9 offset:25600
    v_mfma_f32_32x32x16_bf16 v[16:31], v[104:107], v[96:99], v[16:31]
    ds_read_b64_tr_b16 v[88:89], v8 offset:28672
    ds_read_b64_tr_b16 v[90:91], v8 offset:29696
    ds_read_b128 v[80:83], v7 offset:0
    v_mfma_f32_32x32x16_bf16 v[32:47], v[104:107], v[100:103], v[32:47]
    ds_read_b128 v[84:87], v7 offset:4096
    ds_read_b64_tr_b16 v[92:93], v9 offset:28672
    ds_read_b64_tr_b16 v[94:95], v9 offset:29696
    v_mfma_f32_32x32x16_bf16 v[64:79], v[108:111], v[100:103], v[64:79]
    v_mfma_f32_32x32x16_bf16 v[48:63], v[108:111], v[96:99], v[48:63]
    s_waitcnt lgkmcnt(6)
    v_mfma_f32_32x32x16_bf16 v[16:31], v[120:123], v[112:115], v[16:31]
    v_mfma_f32_32x32x16_bf16 v[32:47], v[120:123], v[116:119], v[32:47]
    v_mfma_f32_32x32x16_bf16 v[64:79], v[124:127], v[116:119], v[64:79]
    s_waitcnt lgkmcnt(0)
    v_mfma_f32_32x32x16_bf16 v[48:63], v[124:127], v[112:115], v[48:63]
    v_mfma_f32_32x32x16_bf16 v[16:31], v[88:91], v[80:83], v[16:31]
    v_mfma_f32_32x32x16_bf16 v[32:47], v[88:91], v[84:87], v[32:47]
    v_mfma_f32_32x32x16_bf16 v[64:79], v[92:95], v[84:87], v[64:79]
    v_mfma_f32_32x32x16_bf16 v[48:63], v[92:95], v[80:83], v[48:63]
    ds_read_b64 v[4:5], v12 offset:17408
    ds_read_b64 v[6:7], v12 offset:17920
    ds_read_b128 v[80:83], v13 offset:16384
    ds_read_b128 v[84:87], v13 offset:16416
    ds_read_b128 v[88:91], v13 offset:16448
    ds_read_b128 v[92:95], v13 offset:16480
    ds_read_b128 v[96:99], v13 offset:16512
    ds_read_b128 v[100:103], v13 offset:16544
    ds_read_b128 v[104:107], v13 offset:16576
    ds_read_b128 v[108:111], v13 offset:16608
    s_waitcnt lgkmcnt(8)
    v_mul_f32 v6, s47, v6
    v_mul_f32 v7, s47, v7
    s_waitcnt lgkmcnt(7)
    v_fma_f32 v16, -v4, v80, v16
    v_fma_f32 v17, -v4, v81, v17
    v_fma_f32 v18, -v4, v82, v18
    v_fma_f32 v19, -v4, v83, v19
    v_fma_f32 v32, -v5, v80, v32
    v_fma_f32 v33, -v5, v81, v33
    v_fma_f32 v34, -v5, v82, v34
    v_fma_f32 v35, -v5, v83, v35
    v_mul_f32 v16, v16, v6
    v_mul_f32 v17, v17, v6
    v_mul_f32 v18, v18, v6
    v_mul_f32 v19, v19, v6
    v_mul_f32 v32, v32, v7
    v_mul_f32 v33, v33, v7
    v_mul_f32 v34, v34, v7
    v_mul_f32 v35, v35, v7
    v_cvt_pk_bf16_f32 v112, v16, v17
    v_cvt_pk_bf16_f32 v113, v18, v19
    v_cvt_pk_bf16_f32 v114, v32, v33
    v_cvt_pk_bf16_f32 v115, v34, v35
    s_add_u32 s41, s40, 0
    buffer_store_dwordx4 v[112:115], v11, s[16:19], s41 offen sc1
    s_waitcnt lgkmcnt(6)
    v_fma_f32 v20, -v4, v84, v20
    v_fma_f32 v21, -v4, v85, v21
    v_fma_f32 v22, -v4, v86, v22
    v_fma_f32 v23, -v4, v87, v23
    v_fma_f32 v36, -v5, v84, v36
    v_fma_f32 v37, -v5, v85, v37
    v_fma_f32 v38, -v5, v86, v38
    v_fma_f32 v39, -v5, v87, v39
    v_mul_f32 v20, v20, v6
    v_mul_f32 v21, v21, v6
    v_mul_f32 v22, v22, v6
    v_mul_f32 v23, v23, v6
    v_mul_f32 v36, v36, v7
    v_mul_f32 v37, v37, v7
    v_mul_f32 v38, v38, v7
    v_mul_f32 v39, v39, v7
    v_cvt_pk_bf16_f32 v116, v20, v21
    v_cvt_pk_bf16_f32 v117, v22, v23
    v_cvt_pk_bf16_f32 v118, v36, v37
    v_cvt_pk_bf16_f32 v119, v38, v39
    s_add_u32 s41, s40, 32768
    buffer_store_dwordx4 v[116:119], v11, s[16:19], s41 offen sc1
    s_waitcnt lgkmcnt(5)
    v_fma_f32 v24, -v4, v88, v24
    v_fma_f32 v25, -v4, v89, v25
    v_fma_f32 v26, -v4, v90, v26
    v_fma_f32 v27, -v4, v91, v27
    v_fma_f32 v40, -v5, v88, v40
    v_fma_f32 v41, -v5, v89, v41
    v_fma_f32 v42, -v5, v90, v42
    v_fma_f32 v43, -v5, v91, v43
    v_mul_f32 v24, v24, v6
    v_mul_f32 v25, v25, v6
    v_mul_f32 v26, v26, v6
    v_mul_f32 v27, v27, v6
    v_mul_f32 v40, v40, v7
    v_mul_f32 v41, v41, v7
    v_mul_f32 v42, v42, v7
    v_mul_f32 v43, v43, v7
    v_cvt_pk_bf16_f32 v120, v24, v25
    v_cvt_pk_bf16_f32 v121, v26, v27
    v_cvt_pk_bf16_f32 v122, v40, v41
    v_cvt_pk_bf16_f32 v123, v42, v43
    s_add_u32 s41, s40, 65536
    buffer_store_dwordx4 v[120:123], v11, s[16:19], s41 offen sc1
    s_waitcnt lgkmcnt(4)
    v_fma_f32 v28, -v4, v92, v28
    v_fma_f32 v29, -v4, v93, v29
    v_fma_f32 v30, -v4, v94, v30
    v_fma_f32 v31, -v4, v95, v31
    v_fma_f32 v44, -v5, v92, v44
    v_fma_f32 v45, -v5, v93, v45
    v_fma_f32 v46, -v5, v94, v46
    v_fma_f32 v47, -v5, v95, v47
    v_mul_f32 v28, v28, v6
    v_mul_f32 v29, v29, v6
    v_mul_f32 v30, v30, v6
    v_mul_f32 v31, v31, v6
    v_mul_f32 v44, v44, v7
    v_mul_f32 v45, v45, v7
    v_mul_f32 v46, v46, v7
    v_mul_f32 v47, v47, v7
    v_cvt_pk_bf16_f32 v124, v28, v29
    v_cvt_pk_bf16_f32 v125, v30, v31
    v_cvt_pk_bf16_f32 v126, v44, v45
    v_cvt_pk_bf16_f32 v127, v46, v47
    s_add_u32 s41, s40, 98304
    buffer_store_dwordx4 v[124:127], v11, s[16:19], s41 offen sc1
    s_waitcnt lgkmcnt(3)
    v_fma_f32 v48, -v4, v96, v48
    v_fma_f32 v49, -v4, v97, v49
    v_fma_f32 v50, -v4, v98, v50
    v_fma_f32 v51, -v4, v99, v51
    v_fma_f32 v64, -v5, v96, v64
    v_fma_f32 v65, -v5, v97, v65
    v_fma_f32 v66, -v5, v98, v66
    v_fma_f32 v67, -v5, v99, v67
    v_mul_f32 v48, v48, v6
    v_mul_f32 v49, v49, v6
    v_mul_f32 v50, v50, v6
    v_mul_f32 v51, v51, v6
    v_mul_f32 v64, v64, v7
    v_mul_f32 v65, v65, v7
    v_mul_f32 v66, v66, v7
    v_mul_f32 v67, v67, v7
    v_cvt_pk_bf16_f32 v112, v48, v49
    v_cvt_pk_bf16_f32 v113, v50, v51
    v_cvt_pk_bf16_f32 v114, v64, v65
    v_cvt_pk_bf16_f32 v115, v66, v67
    s_add_u32 s41, s40, 131072
    buffer_store_dwordx4 v[112:115], v11, s[16:19], s41 offen sc1
    s_waitcnt lgkmcnt(2)
    v_fma_f32 v52, -v4, v100, v52
    v_fma_f32 v53, -v4, v101, v53
    v_fma_f32 v54, -v4, v102, v54
    v_fma_f32 v55, -v4, v103, v55
    v_fma_f32 v68, -v5, v100, v68
    v_fma_f32 v69, -v5, v101, v69
    v_fma_f32 v70, -v5, v102, v70
    v_fma_f32 v71, -v5, v103, v71
    v_mul_f32 v52, v52, v6
    v_mul_f32 v53, v53, v6
    v_mul_f32 v54, v54, v6
    v_mul_f32 v55, v55, v6
    v_mul_f32 v68, v68, v7
    v_mul_f32 v69, v69, v7
    v_mul_f32 v70, v70, v7
    v_mul_f32 v71, v71, v7
    v_cvt_pk_bf16_f32 v116, v52, v53
    v_cvt_pk_bf16_f32 v117, v54, v55
    v_cvt_pk_bf16_f32 v118, v68, v69
    v_cvt_pk_bf16_f32 v119, v70, v71
    s_add_u32 s41, s40, 163840
    buffer_store_dwordx4 v[116:119], v11, s[16:19], s41 offen sc1
    s_waitcnt lgkmcnt(1)
    v_fma_f32 v56, -v4, v104, v56
    v_fma_f32 v57, -v4, v105, v57
    v_fma_f32 v58, -v4, v106, v58
    v_fma_f32 v59, -v4, v107, v59
    v_fma_f32 v72, -v5, v104, v72
    v_fma_f32 v73, -v5, v105, v73
    v_fma_f32 v74, -v5, v106, v74
    v_fma_f32 v75, -v5, v107, v75
    v_mul_f32 v56, v56, v6
    v_mul_f32 v57, v57, v6
    v_mul_f32 v58, v58, v6
    v_mul_f32 v59, v59, v6
    v_mul_f32 v72, v72, v7
    v_mul_f32 v73, v73, v7
    v_mul_f32 v74, v74, v7
    v_mul_f32 v75, v75, v7
    v_cvt_pk_bf16_f32 v120, v56, v57
    v_cvt_pk_bf16_f32 v121, v58, v59
    v_cvt_pk_bf16_f32 v122, v72, v73
    v_cvt_pk_bf16_f32 v123, v74, v75
    s_add_u32 s41, s40, 196608
    buffer_store_dwordx4 v[120:123], v11, s[16:19], s41 offen sc1
    s_waitcnt lgkmcnt(0)
    v_fma_f32 v60, -v4, v108, v60
    v_fma_f32 v61, -v4, v109, v61
    v_fma_f32 v62, -v4, v110, v62
    v_fma_f32 v63, -v4, v111, v63
    v_fma_f32 v76, -v5, v108, v76
    v_fma_f32 v77, -v5, v109, v77
    v_fma_f32 v78, -v5, v110, v78
    v_fma_f32 v79, -v5, v111, v79
    v_mul_f32 v60, v60, v6
    v_mul_f32 v61, v61, v6
    v_mul_f32 v62, v62, v6
    v_mul_f32 v63, v63, v6
    v_mul_f32 v76, v76, v7
    v_mul_f32 v77, v77, v7
    v_mul_f32 v78, v78, v7
    v_mul_f32 v79, v79, v7
    v_cvt_pk_bf16_f32 v124, v60, v61
    v_cvt_pk_bf16_f32 v125, v62, v63
    v_cvt_pk_bf16_f32 v126, v76, v77
    v_cvt_pk_bf16_f32 v127, v78, v79
    s_add_u32 s41, s40, 229376
    buffer_store_dwordx4 v[124:127], v11, s[16:19], s41 offen sc1
    s_waitcnt vmcnt(0)
    s_barrier
    s_branch L_a2
L_a1v_33_para:
    s_add_u32 s16, s66, 7864320
    s_addc_u32 s17, s67, 0
    s_mov_b32 s18, 2621440
    s_mov_b32 s19, 0x00020000
    s_lshl_b32 s39, s37, 6
    v_add_u32 v12, s39, v3
    v_lshlrev_b32 v12, 2, v12
    s_lshl_b32 s40, s36, 8
    v_lshl_add_u32 v11, v10, 4, s40
    s_sub_u32 s38, s33, 10
    s_lshl_b32 s38, s38, 7
    s_add_u32 s38, s38, s39
    s_mov_b32 s41, 81600
    v_add_u32 v112, s38, v3
    v_add_u32 v112, 0, v112
    v_mul_u32_u24 v15, 3277, v112
    v_lshrrev_b32 v15, 16, v15
    v_mul_lo_u32 v15, v15, s41
    v_lshl_add_u32 v15, v112, 4, v15
    v_mul_u32_u24 v112, 320, v10
    v_add_u32 v13, v15, v112
    v_add_u32 v112, s38, v3
    v_add_u32 v112, 32, v112
    v_mul_u32_u24 v15, 3277, v112
    v_lshrrev_b32 v15, 16, v15
    v_mul_lo_u32 v15, v15, s41
    v_lshl_add_u32 v15, v112, 4, v15
    v_mul_u32_u24 v112, 320, v10
    v_add_u32 v14, v15, v112
    s_lshl_b32 s40, s32, 1
    s_add_u32 s40, s40, s36
    s_mul_i32 s40, s40, 2560
    s_barrier
    ds_read_b64_tr_b16 v[88:89], v8 offset:0
    ds_read_b64_tr_b16 v[90:91], v8 offset:1024
    ds_read_b128 v[80:83], v4 offset:0
    ds_read_b128 v[84:87], v4 offset:4096
    ds_read_b64_tr_b16 v[92:93], v9 offset:0
    ds_read_b64_tr_b16 v[94:95], v9 offset:1024
    ds_read_b64_tr_b16 v[104:105], v8 offset:4096
    ds_read_b64_tr_b16 v[106:107], v8 offset:5120
    ds_read_b128 v[96:99], v5 offset:0
    ds_read_b128 v[100:103], v5 offset:4096
    ds_read_b64_tr_b16 v[108:109], v9 offset:4096
    ds_read_b64_tr_b16 v[110:111], v9 offset:5120
    s_waitcnt lgkmcnt(6)
    v_mfma_f32_32x32x16_bf16 v[16:31], v[80:83], v[88:91], 0
    v_mfma_f32_32x32x16_bf16 v[32:47], v[84:87], v[88:91], 0
    v_mfma_f32_32x32x16_bf16 v[64:79], v[84:87], v[92:95], 0
    s_waitcnt lgkmcnt(0)
    s_barrier
    ds_read_b64_tr_b16 v[120:121], v8 offset:8192
    ds_read_b64_tr_b16 v[122:123], v8 offset:9216
    ds_read_b128 v[112:115], v6 offset:0
    v_mfma_f32_32x32x16_bf16 v[48:63], v[80:83], v[92:95], 0
    ds_read_b128 v[116:119], v6 offset:4096
    ds_read_b64_tr_b16 v[124:125], v9 offset:8192
    ds_read_b64_tr_b16 v[126:127], v9 offset:9216
    v_mfma_f32_32x32x16_bf16 v[16:31], v[96:99], v[104:107], v[16:31]
    ds_read_b64_tr_b16 v[88:89], v8 offset:12288
    ds_read_b64_tr_b16 v[90:91], v8 offset:13312
    ds_read_b128 v[80:83], v7 offset:0
    v_mfma_f32_32x32x16_bf16 v[32:47], v[100:103], v[104:107], v[32:47]
    ds_read_b128 v[84:87], v7 offset:4096
    ds_read_b64_tr_b16 v[92:93], v9 offset:12288
    ds_read_b64_tr_b16 v[94:95], v9 offset:13312
    v_mfma_f32_32x32x16_bf16 v[64:79], v[100:103], v[108:111], v[64:79]
    v_mfma_f32_32x32x16_bf16 v[48:63], v[96:99], v[108:111], v[48:63]
    s_waitcnt lgkmcnt(6)
    v_mfma_f32_32x32x16_bf16 v[16:31], v[112:115], v[120:123], v[16:31]
    v_mfma_f32_32x32x16_bf16 v[32:47], v[116:119], v[120:123], v[32:47]
    v_mfma_f32_32x32x16_bf16 v[64:79], v[116:119], v[124:127], v[64:79]
    s_waitcnt lgkmcnt(0)
    s_barrier
    ds_read_b64_tr_b16 v[104:105], v8 offset:16384
    ds_read_b64_tr_b16 v[106:107], v8 offset:17408
    ds_read_b128 v[96:99], v4 offset:16384
    v_mfma_f32_32x32x16_bf16 v[48:63], v[112:115], v[124:127], v[48:63]
    ds_read_b128 v[100:103], v4 offset:20480
    ds_read_b64_tr_b16 v[108:109], v9 offset:16384
    ds_read_b64_tr_b16 v[110:111], v9 offset:17408
    v_mfma_f32_32x32x16_bf16 v[16:31], v[80:83], v[88:91], v[16:31]
    ds_read_b64_tr_b16 v[120:121], v8 offset:20480
    ds_read_b64_tr_b16 v[122:123], v8 offset:21504
    ds_read_b128 v[112:115], v5 offset:16384
    v_mfma_f32_32x32x16_bf16 v[32:47], v[84:87], v[88:91], v[32:47]
    ds_read_b128 v[116:119], v5 offset:20480
    ds_read_b64_tr_b16 v[124:125], v9 offset:20480
    ds_read_b64_tr_b16 v[126:127], v9 offset:21504
    v_mfma_f32_32x32x16_bf16 v[64:79], v[84:87], v[92:95], v[64:79]
    v_mfma_f32_32x32x16_bf16 v[48:63], v[80:83], v[92:95], v[48:63]
    s_waitcnt lgkmcnt(6)
    v_mfma_f32_32x32x16_bf16 v[16:31], v[96:99], v[104:107], v[16:31]
    v_mfma_f32_32x32x16_bf16 v[32:47], v[100:103], v[104:107], v[32:47]
    v_mfma_f32_32x32x16_bf16 v[64:79], v[100:103], v[108:111], v[64:79]
    s_waitcnt lgkmcnt(0)
    s_barrier
    ds_read_b64_tr_b16 v[88:89], v8 offset:24576
    ds_read_b64_tr_b16 v[90:91], v8 offset:25600
    ds_read_b128 v[80:83], v6 offset:16384
    v_mfma_f32_32x32x16_bf16 v[48:63], v[96:99], v[108:111], v[48:63]
    ds_read_b128 v[84:87], v6 offset:20480
    ds_read_b64_tr_b16 v[92:93], v9 offset:24576
    ds_read_b64_tr_b16 v[94:95], v9 offset:25600
    v_mfma_f32_32x32x16_bf16 v[16:31], v[112:115], v[120:123], v[16:31]
    ds_read_b64_tr_b16 v[104:105], v8 offset:28672
    ds_read_b64_tr_b16 v[106:107], v8 offset:29696
    ds_read_b128 v[96:99], v7 offset:16384
    v_mfma_f32_32x32x16_bf16 v[32:47], v[116:119], v[120:123], v[32:47]
    ds_read_b128 v[100:103], v7 offset:20480
    ds_read_b64_tr_b16 v[108:109], v9 offset:28672
    ds_read_b64_tr_b16 v[110:111], v9 offset:29696
    v_mfma_f32_32x32x16_bf16 v[64:79], v[116:119], v[124:127], v[64:79]
    v_mfma_f32_32x32x16_bf16 v[48:63], v[112:115], v[124:127], v[48:63]
    s_waitcnt lgkmcnt(6)
    v_mfma_f32_32x32x16_bf16 v[16:31], v[80:83], v[88:91], v[16:31]
    v_mfma_f32_32x32x16_bf16 v[32:47], v[84:87], v[88:91], v[32:47]
    v_mfma_f32_32x32x16_bf16 v[64:79], v[84:87], v[92:95], v[64:79]
    s_waitcnt lgkmcnt(0)
    s_barrier
    ds_read_b64_tr_b16 v[120:121], v8 offset:0
    ds_read_b64_tr_b16 v[122:123], v8 offset:1024
    ds_read_b128 v[112:115], v4 offset:32768
    v_mfma_f32_32x32x16_bf16 v[48:63], v[80:83], v[92:95], v[48:63]
    ds_read_b128 v[116:119], v4 offset:36864
    ds_read_b64_tr_b16 v[124:125], v9 offset:0
    ds_read_b64_tr_b16 v[126:127], v9 offset:1024
    v_mfma_f32_32x32x16_bf16 v[16:31], v[96:99], v[104:107], v[16:31]
    ds_read_b64_tr_b16 v[88:89], v8 offset:4096
    ds_read_b64_tr_b16 v[90:91], v8 offset:5120
    ds_read_b128 v[80:83], v5 offset:32768
    v_mfma_f32_32x32x16_bf16 v[32:47], v[100:103], v[104:107], v[32:47]
    ds_read_b128 v[84:87], v5 offset:36864
    ds_read_b64_tr_b16 v[92:93], v9 offset:4096
    ds_read_b64_tr_b16 v[94:95], v9 offset:5120
    v_mfma_f32_32x32x16_bf16 v[64:79], v[100:103], v[108:111], v[64:79]
    v_mfma_f32_32x32x16_bf16 v[48:63], v[96:99], v[108:111], v[48:63]
    s_waitcnt lgkmcnt(6)
    v_mfma_f32_32x32x16_bf16 v[16:31], v[112:115], v[120:123], v[16:31]
    v_mfma_f32_32x32x16_bf16 v[32:47], v[116:119], v[120:123], v[32:47]
    v_mfma_f32_32x32x16_bf16 v[64:79], v[116:119], v[124:127], v[64:79]
    s_waitcnt lgkmcnt(0)
    s_barrier
    ds_read_b64_tr_b16 v[104:105], v8 offset:8192
    ds_read_b64_tr_b16 v[106:107], v8 offset:9216
    ds_read_b128 v[96:99], v6 offset:32768
    v_mfma_f32_32x32x16_bf16 v[48:63], v[112:115], v[124:127], v[48:63]
    ds_read_b128 v[100:103], v6 offset:36864
    ds_read_b64_tr_b16 v[108:109], v9 offset:8192
    ds_read_b64_tr_b16 v[110:111], v9 offset:9216
    v_mfma_f32_32x32x16_bf16 v[16:31], v[80:83], v[88:91], v[16:31]
    ds_read_b64_tr_b16 v[120:121], v8 offset:12288
    ds_read_b64_tr_b16 v[122:123], v8 offset:13312
    ds_read_b128 v[112:115], v7 offset:32768
    v_mfma_f32_32x32x16_bf16 v[32:47], v[84:87], v[88:91], v[32:47]
    ds_read_b128 v[116:119], v7 offset:36864
    ds_read_b64_tr_b16 v[124:125], v9 offset:12288
    ds_read_b64_tr_b16 v[126:127], v9 offset:13312
    v_mfma_f32_32x32x16_bf16 v[64:79], v[84:87], v[92:95], v[64:79]
    v_mfma_f32_32x32x16_bf16 v[48:63], v[80:83], v[92:95], v[48:63]
    s_waitcnt lgkmcnt(6)
    v_mfma_f32_32x32x16_bf16 v[16:31], v[96:99], v[104:107], v[16:31]
    v_mfma_f32_32x32x16_bf16 v[32:47], v[100:103], v[104:107], v[32:47]
    v_mfma_f32_32x32x16_bf16 v[64:79], v[100:103], v[108:111], v[64:79]
    s_waitcnt lgkmcnt(0)
    s_barrier
    ds_read_b64_tr_b16 v[88:89], v8 offset:16384
    ds_read_b64_tr_b16 v[90:91], v8 offset:17408
    ds_read_b128 v[80:83], v4 offset:0
    v_mfma_f32_32x32x16_bf16 v[48:63], v[96:99], v[108:111], v[48:63]
    ds_read_b128 v[84:87], v4 offset:4096
    ds_read_b64_tr_b16 v[92:93], v9 offset:16384
    ds_read_b64_tr_b16 v[94:95], v9 offset:17408
    v_mfma_f32_32x32x16_bf16 v[16:31], v[112:115], v[120:123], v[16:31]
    ds_read_b64_tr_b16 v[104:105], v8 offset:20480
    ds_read_b64_tr_b16 v[106:107], v8 offset:21504
    ds_read_b128 v[96:99], v5 offset:0
    v_mfma_f32_32x32x16_bf16 v[32:47], v[116:119], v[120:123], v[32:47]
    ds_read_b128 v[100:103], v5 offset:4096
    ds_read_b64_tr_b16 v[108:109], v9 offset:20480
    ds_read_b64_tr_b16 v[110:111], v9 offset:21504
    v_mfma_f32_32x32x16_bf16 v[64:79], v[116:119], v[124:127], v[64:79]
    v_mfma_f32_32x32x16_bf16 v[48:63], v[112:115], v[124:127], v[48:63]
    s_waitcnt lgkmcnt(6)
    v_mfma_f32_32x32x16_bf16 v[16:31], v[80:83], v[88:91], v[16:31]
    v_mfma_f32_32x32x16_bf16 v[32:47], v[84:87], v[88:91], v[32:47]
    v_mfma_f32_32x32x16_bf16 v[64:79], v[84:87], v[92:95], v[64:79]
    s_waitcnt lgkmcnt(0)
    s_barrier
    ds_read_b64_tr_b16 v[120:121], v8 offset:24576
    ds_read_b64_tr_b16 v[122:123], v8 offset:25600
    ds_read_b128 v[112:115], v6 offset:0
    v_mfma_f32_32x32x16_bf16 v[48:63], v[80:83], v[92:95], v[48:63]
    ds_read_b128 v[116:119], v6 offset:4096
    ds_read_b64_tr_b16 v[124:125], v9 offset:24576
    ds_read_b64_tr_b16 v[126:127], v9 offset:25600
    v_mfma_f32_32x32x16_bf16 v[16:31], v[96:99], v[104:107], v[16:31]
    ds_read_b64_tr_b16 v[88:89], v8 offset:28672
    ds_read_b64_tr_b16 v[90:91], v8 offset:29696
    ds_read_b128 v[80:83], v7 offset:0
    v_mfma_f32_32x32x16_bf16 v[32:47], v[100:103], v[104:107], v[32:47]
    ds_read_b128 v[84:87], v7 offset:4096
    ds_read_b64_tr_b16 v[92:93], v9 offset:28672
    ds_read_b64_tr_b16 v[94:95], v9 offset:29696
    v_mfma_f32_32x32x16_bf16 v[64:79], v[100:103], v[108:111], v[64:79]
    v_mfma_f32_32x32x16_bf16 v[48:63], v[96:99], v[108:111], v[48:63]
    s_waitcnt lgkmcnt(6)
    v_mfma_f32_32x32x16_bf16 v[16:31], v[112:115], v[120:123], v[16:31]
    v_mfma_f32_32x32x16_bf16 v[32:47], v[116:119], v[120:123], v[32:47]
    v_mfma_f32_32x32x16_bf16 v[64:79], v[116:119], v[124:127], v[64:79]
    s_waitcnt lgkmcnt(0)
    s_barrier
    ds_read_b64_tr_b16 v[104:105], v8 offset:0
    ds_read_b64_tr_b16 v[106:107], v8 offset:1024
    ds_read_b128 v[96:99], v4 offset:16384
    v_mfma_f32_32x32x16_bf16 v[48:63], v[112:115], v[124:127], v[48:63]
    ds_read_b128 v[100:103], v4 offset:20480
    ds_read_b64_tr_b16 v[108:109], v9 offset:0
    ds_read_b64_tr_b16 v[110:111], v9 offset:1024
    v_mfma_f32_32x32x16_bf16 v[16:31], v[80:83], v[88:91], v[16:31]
    ds_read_b64_tr_b16 v[120:121], v8 offset:4096
    ds_read_b64_tr_b16 v[122:123], v8 offset:5120
    ds_read_b128 v[112:115], v5 offset:16384
    v_mfma_f32_32x32x16_bf16 v[32:47], v[84:87], v[88:91], v[32:47]
    ds_read_b128 v[116:119], v5 offset:20480
    ds_read_b64_tr_b16 v[124:125], v9 offset:4096
    ds_read_b64_tr_b16 v[126:127], v9 offset:5120
    v_mfma_f32_32x32x16_bf16 v[64:79], v[84:87], v[92:95], v[64:79]
    v_mfma_f32_32x32x16_bf16 v[48:63], v[80:83], v[92:95], v[48:63]
    s_waitcnt lgkmcnt(6)
    v_mfma_f32_32x32x16_bf16 v[16:31], v[96:99], v[104:107], v[16:31]
    v_mfma_f32_32x32x16_bf16 v[32:47], v[100:103], v[104:107], v[32:47]
    v_mfma_f32_32x32x16_bf16 v[64:79], v[100:103], v[108:111], v[64:79]
    s_waitcnt lgkmcnt(0)
    s_barrier
    ds_read_b64_tr_b16 v[88:89], v8 offset:8192
    ds_read_b64_tr_b16 v[90:91], v8 offset:9216
    ds_read_b128 v[80:83], v6 offset:16384
    v_mfma_f32_32x32x16_bf16 v[48:63], v[96:99], v[108:111], v[48:63]
    ds_read_b128 v[84:87], v6 offset:20480
    ds_read_b64_tr_b16 v[92:93], v9 offset:8192
    ds_read_b64_tr_b16 v[94:95], v9 offset:9216
    v_mfma_f32_32x32x16_bf16 v[16:31], v[112:115], v[120:123], v[16:31]
    ds_read_b64_tr_b16 v[104:105], v8 offset:12288
    ds_read_b64_tr_b16 v[106:107], v8 offset:13312
    ds_read_b128 v[96:99], v7 offset:16384
    v_mfma_f32_32x32x16_bf16 v[32:47], v[116:119], v[120:123], v[32:47]
    ds_read_b128 v[100:103], v7 offset:20480
    ds_read_b64_tr_b16 v[108:109], v9 offset:12288
    ds_read_b64_tr_b16 v[110:111], v9 offset:13312
    v_mfma_f32_32x32x16_bf16 v[64:79], v[116:119], v[124:127], v[64:79]
    v_mfma_f32_32x32x16_bf16 v[48:63], v[112:115], v[124:127], v[48:63]
    s_waitcnt lgkmcnt(6)
    v_mfma_f32_32x32x16_bf16 v[16:31], v[80:83], v[88:91], v[16:31]
    v_mfma_f32_32x32x16_bf16 v[32:47], v[84:87], v[88:91], v[32:47]
    v_mfma_f32_32x32x16_bf16 v[64:79], v[84:87], v[92:95], v[64:79]
    s_waitcnt lgkmcnt(0)
    s_barrier
    ds_read_b64_tr_b16 v[120:121], v8 offset:16384
    ds_read_b64_tr_b16 v[122:123], v8 offset:17408
    ds_read_b128 v[112:115], v4 offset:32768
    v_mfma_f32_32x32x16_bf16 v[48:63], v[80:83], v[92:95], v[48:63]
    ds_read_b128 v[116:119], v4 offset:36864
    ds_read_b64_tr_b16 v[124:125], v9 offset:16384
    ds_read_b64_tr_b16 v[126:127], v9 offset:17408
    v_mfma_f32_32x32x16_bf16 v[16:31], v[96:99], v[104:107], v[16:31]
    ds_read_b64_tr_b16 v[88:89], v8 offset:20480
    ds_read_b64_tr_b16 v[90:91], v8 offset:21504
    ds_read_b128 v[80:83], v5 offset:32768
    v_mfma_f32_32x32x16_bf16 v[32:47], v[100:103], v[104:107], v[32:47]
    ds_read_b128 v[84:87], v5 offset:36864
    ds_read_b64_tr_b16 v[92:93], v9 offset:20480
    ds_read_b64_tr_b16 v[94:95], v9 offset:21504
    v_mfma_f32_32x32x16_bf16 v[64:79], v[100:103], v[108:111], v[64:79]
    v_mfma_f32_32x32x16_bf16 v[48:63], v[96:99], v[108:111], v[48:63]
    s_waitcnt lgkmcnt(6)
    v_mfma_f32_32x32x16_bf16 v[16:31], v[112:115], v[120:123], v[16:31]
    v_mfma_f32_32x32x16_bf16 v[32:47], v[116:119], v[120:123], v[32:47]
    v_mfma_f32_32x32x16_bf16 v[64:79], v[116:119], v[124:127], v[64:79]
    s_waitcnt lgkmcnt(0)
    s_barrier
    ds_read_b64_tr_b16 v[104:105], v8 offset:24576
    ds_read_b64_tr_b16 v[106:107], v8 offset:25600
    ds_read_b128 v[96:99], v6 offset:32768
    v_mfma_f32_32x32x16_bf16 v[48:63], v[112:115], v[124:127], v[48:63]
    ds_read_b128 v[100:103], v6 offset:36864
    ds_read_b64_tr_b16 v[108:109], v9 offset:24576
    ds_read_b64_tr_b16 v[110:111], v9 offset:25600
    v_mfma_f32_32x32x16_bf16 v[16:31], v[80:83], v[88:91], v[16:31]
    ds_read_b64_tr_b16 v[120:121], v8 offset:28672
    ds_read_b64_tr_b16 v[122:123], v8 offset:29696
    ds_read_b128 v[112:115], v7 offset:32768
    v_mfma_f32_32x32x16_bf16 v[32:47], v[84:87], v[88:91], v[32:47]
    ds_read_b128 v[116:119], v7 offset:36864
    ds_read_b64_tr_b16 v[124:125], v9 offset:28672
    ds_read_b64_tr_b16 v[126:127], v9 offset:29696
    v_mfma_f32_32x32x16_bf16 v[64:79], v[84:87], v[92:95], v[64:79]
    v_mfma_f32_32x32x16_bf16 v[48:63], v[80:83], v[92:95], v[48:63]
    s_waitcnt lgkmcnt(6)
    v_mfma_f32_32x32x16_bf16 v[16:31], v[96:99], v[104:107], v[16:31]
    v_mfma_f32_32x32x16_bf16 v[32:47], v[100:103], v[104:107], v[32:47]
    v_mfma_f32_32x32x16_bf16 v[64:79], v[100:103], v[108:111], v[64:79]
    s_waitcnt lgkmcnt(0)
    s_barrier
    ds_read_b64_tr_b16 v[88:89], v8 offset:0
    ds_read_b64_tr_b16 v[90:91], v8 offset:1024
    ds_read_b128 v[80:83], v4 offset:0
    v_mfma_f32_32x32x16_bf16 v[48:63], v[96:99], v[108:111], v[48:63]
    ds_read_b128 v[84:87], v4 offset:4096
    ds_read_b64_tr_b16 v[92:93], v9 offset:0
    ds_read_b64_tr_b16 v[94:95], v9 offset:1024
    v_mfma_f32_32x32x16_bf16 v[16:31], v[112:115], v[120:123], v[16:31]
    ds_read_b64_tr_b16 v[104:105], v8 offset:4096
    ds_read_b64_tr_b16 v[106:107], v8 offset:5120
    ds_read_b128 v[96:99], v5 offset:0
    v_mfma_f32_32x32x16_bf16 v[32:47], v[116:119], v[120:123], v[32:47]
    ds_read_b128 v[100:103], v5 offset:4096
    ds_read_b64_tr_b16 v[108:109], v9 offset:4096
    ds_read_b64_tr_b16 v[110:111], v9 offset:5120
    v_mfma_f32_32x32x16_bf16 v[64:79], v[116:119], v[124:127], v[64:79]
    v_mfma_f32_32x32x16_bf16 v[48:63], v[112:115], v[124:127], v[48:63]
    s_waitcnt lgkmcnt(6)
    v_mfma_f32_32x32x16_bf16 v[16:31], v[80:83], v[88:91], v[16:31]
    v_mfma_f32_32x32x16_bf16 v[32:47], v[84:87], v[88:91], v[32:47]
    v_mfma_f32_32x32x16_bf16 v[64:79], v[84:87], v[92:95], v[64:79]
    s_waitcnt lgkmcnt(0)
    s_barrier
    ds_read_b64_tr_b16 v[120:121], v8 offset:8192
    ds_read_b64_tr_b16 v[122:123], v8 offset:9216
    ds_read_b128 v[112:115], v6 offset:0
    v_mfma_f32_32x32x16_bf16 v[48:63], v[80:83], v[92:95], v[48:63]
    ds_read_b128 v[116:119], v6 offset:4096
    ds_read_b64_tr_b16 v[124:125], v9 offset:8192
    ds_read_b64_tr_b16 v[126:127], v9 offset:9216
    v_mfma_f32_32x32x16_bf16 v[16:31], v[96:99], v[104:107], v[16:31]
    ds_read_b64_tr_b16 v[88:89], v8 offset:12288
    ds_read_b64_tr_b16 v[90:91], v8 offset:13312
    ds_read_b128 v[80:83], v7 offset:0
    v_mfma_f32_32x32x16_bf16 v[32:47], v[100:103], v[104:107], v[32:47]
    ds_read_b128 v[84:87], v7 offset:4096
    ds_read_b64_tr_b16 v[92:93], v9 offset:12288
    ds_read_b64_tr_b16 v[94:95], v9 offset:13312
    v_mfma_f32_32x32x16_bf16 v[64:79], v[100:103], v[108:111], v[64:79]
    v_mfma_f32_32x32x16_bf16 v[48:63], v[96:99], v[108:111], v[48:63]
    s_waitcnt lgkmcnt(6)
    v_mfma_f32_32x32x16_bf16 v[16:31], v[112:115], v[120:123], v[16:31]
    v_mfma_f32_32x32x16_bf16 v[32:47], v[116:119], v[120:123], v[32:47]
    v_mfma_f32_32x32x16_bf16 v[64:79], v[116:119], v[124:127], v[64:79]
    s_waitcnt lgkmcnt(0)
    s_barrier
    ds_read_b64_tr_b16 v[104:105], v8 offset:16384
    ds_read_b64_tr_b16 v[106:107], v8 offset:17408
    ds_read_b128 v[96:99], v4 offset:16384
    v_mfma_f32_32x32x16_bf16 v[48:63], v[112:115], v[124:127], v[48:63]
    ds_read_b128 v[100:103], v4 offset:20480
    ds_read_b64_tr_b16 v[108:109], v9 offset:16384
    ds_read_b64_tr_b16 v[110:111], v9 offset:17408
    v_mfma_f32_32x32x16_bf16 v[16:31], v[80:83], v[88:91], v[16:31]
    ds_read_b64_tr_b16 v[120:121], v8 offset:20480
    ds_read_b64_tr_b16 v[122:123], v8 offset:21504
    ds_read_b128 v[112:115], v5 offset:16384
    v_mfma_f32_32x32x16_bf16 v[32:47], v[84:87], v[88:91], v[32:47]
    ds_read_b128 v[116:119], v5 offset:20480
    ds_read_b64_tr_b16 v[124:125], v9 offset:20480
    ds_read_b64_tr_b16 v[126:127], v9 offset:21504
    v_mfma_f32_32x32x16_bf16 v[64:79], v[84:87], v[92:95], v[64:79]
    v_mfma_f32_32x32x16_bf16 v[48:63], v[80:83], v[92:95], v[48:63]
    s_waitcnt lgkmcnt(6)
    v_mfma_f32_32x32x16_bf16 v[16:31], v[96:99], v[104:107], v[16:31]
    v_mfma_f32_32x32x16_bf16 v[32:47], v[100:103], v[104:107], v[32:47]
    v_mfma_f32_32x32x16_bf16 v[64:79], v[100:103], v[108:111], v[64:79]
    s_waitcnt lgkmcnt(0)
    s_barrier
    ds_read_b64_tr_b16 v[88:89], v8 offset:24576
    ds_read_b64_tr_b16 v[90:91], v8 offset:25600
    ds_read_b128 v[80:83], v6 offset:16384
    v_mfma_f32_32x32x16_bf16 v[48:63], v[96:99], v[108:111], v[48:63]
    ds_read_b128 v[84:87], v6 offset:20480
    ds_read_b64_tr_b16 v[92:93], v9 offset:24576
    ds_read_b64_tr_b16 v[94:95], v9 offset:25600
    v_mfma_f32_32x32x16_bf16 v[16:31], v[112:115], v[120:123], v[16:31]
    ds_read_b64_tr_b16 v[104:105], v8 offset:28672
    ds_read_b64_tr_b16 v[106:107], v8 offset:29696
    ds_read_b128 v[96:99], v7 offset:16384
    v_mfma_f32_32x32x16_bf16 v[32:47], v[116:119], v[120:123], v[32:47]
    ds_read_b128 v[100:103], v7 offset:20480
    ds_read_b64_tr_b16 v[108:109], v9 offset:28672
    ds_read_b64_tr_b16 v[110:111], v9 offset:29696
    v_mfma_f32_32x32x16_bf16 v[64:79], v[116:119], v[124:127], v[64:79]
    v_mfma_f32_32x32x16_bf16 v[48:63], v[112:115], v[124:127], v[48:63]
    s_waitcnt lgkmcnt(6)
    v_mfma_f32_32x32x16_bf16 v[16:31], v[80:83], v[88:91], v[16:31]
    v_mfma_f32_32x32x16_bf16 v[32:47], v[84:87], v[88:91], v[32:47]
    v_mfma_f32_32x32x16_bf16 v[64:79], v[84:87], v[92:95], v[64:79]
    s_waitcnt lgkmcnt(0)
    s_barrier
    ds_read_b64_tr_b16 v[120:121], v8 offset:0
    ds_read_b64_tr_b16 v[122:123], v8 offset:1024
    ds_read_b128 v[112:115], v4 offset:32768
    v_mfma_f32_32x32x16_bf16 v[48:63], v[80:83], v[92:95], v[48:63]
    ds_read_b128 v[116:119], v4 offset:36864
    ds_read_b64_tr_b16 v[124:125], v9 offset:0
    ds_read_b64_tr_b16 v[126:127], v9 offset:1024
    v_mfma_f32_32x32x16_bf16 v[16:31], v[96:99], v[104:107], v[16:31]
    ds_read_b64_tr_b16 v[88:89], v8 offset:4096
    ds_read_b64_tr_b16 v[90:91], v8 offset:5120
    ds_read_b128 v[80:83], v5 offset:32768
    v_mfma_f32_32x32x16_bf16 v[32:47], v[100:103], v[104:107], v[32:47]
    ds_read_b128 v[84:87], v5 offset:36864
    ds_read_b64_tr_b16 v[92:93], v9 offset:4096
    ds_read_b64_tr_b16 v[94:95], v9 offset:5120
    v_mfma_f32_32x32x16_bf16 v[64:79], v[100:103], v[108:111], v[64:79]
    v_mfma_f32_32x32x16_bf16 v[48:63], v[96:99], v[108:111], v[48:63]
    s_waitcnt lgkmcnt(6)
    v_mfma_f32_32x32x16_bf16 v[16:31], v[112:115], v[120:123], v[16:31]
    v_mfma_f32_32x32x16_bf16 v[32:47], v[116:119], v[120:123], v[32:47]
    v_mfma_f32_32x32x16_bf16 v[64:79], v[116:119], v[124:127], v[64:79]
    s_waitcnt lgkmcnt(0)
    s_barrier
    ds_read_b64_tr_b16 v[104:105], v8 offset:8192
    ds_read_b64_tr_b16 v[106:107], v8 offset:9216
    ds_read_b128 v[96:99], v6 offset:32768
    v_mfma_f32_32x32x16_bf16 v[48:63], v[112:115], v[124:127], v[48:63]
    ds_read_b128 v[100:103], v6 offset:36864
    ds_read_b64_tr_b16 v[108:109], v9 offset:8192
    ds_read_b64_tr_b16 v[110:111], v9 offset:9216
    v_mfma_f32_32x32x16_bf16 v[16:31], v[80:83], v[88:91], v[16:31]
    ds_read_b64_tr_b16 v[120:121], v8 offset:12288
    ds_read_b64_tr_b16 v[122:123], v8 offset:13312
    ds_read_b128 v[112:115], v7 offset:32768
    v_mfma_f32_32x32x16_bf16 v[32:47], v[84:87], v[88:91], v[32:47]
    ds_read_b128 v[116:119], v7 offset:36864
    ds_read_b64_tr_b16 v[124:125], v9 offset:12288
    ds_read_b64_tr_b16 v[126:127], v9 offset:13312
    v_mfma_f32_32x32x16_bf16 v[64:79], v[84:87], v[92:95], v[64:79]
    v_mfma_f32_32x32x16_bf16 v[48:63], v[80:83], v[92:95], v[48:63]
    s_waitcnt lgkmcnt(6)
    v_mfma_f32_32x32x16_bf16 v[16:31], v[96:99], v[104:107], v[16:31]
    v_mfma_f32_32x32x16_bf16 v[32:47], v[100:103], v[104:107], v[32:47]
    v_mfma_f32_32x32x16_bf16 v[64:79], v[100:103], v[108:111], v[64:79]
    s_waitcnt lgkmcnt(0)
    s_barrier
    ds_read_b64_tr_b16 v[88:89], v8 offset:16384
    ds_read_b64_tr_b16 v[90:91], v8 offset:17408
    ds_read_b128 v[80:83], v4 offset:0
    v_mfma_f32_32x32x16_bf16 v[48:63], v[96:99], v[108:111], v[48:63]
    ds_read_b128 v[84:87], v4 offset:4096
    ds_read_b64_tr_b16 v[92:93], v9 offset:16384
    ds_read_b64_tr_b16 v[94:95], v9 offset:17408
    v_mfma_f32_32x32x16_bf16 v[16:31], v[112:115], v[120:123], v[16:31]
    ds_read_b64_tr_b16 v[104:105], v8 offset:20480
    ds_read_b64_tr_b16 v[106:107], v8 offset:21504
    ds_read_b128 v[96:99], v5 offset:0
    v_mfma_f32_32x32x16_bf16 v[32:47], v[116:119], v[120:123], v[32:47]
    ds_read_b128 v[100:103], v5 offset:4096
    ds_read_b64_tr_b16 v[108:109], v9 offset:20480
    ds_read_b64_tr_b16 v[110:111], v9 offset:21504
    v_mfma_f32_32x32x16_bf16 v[64:79], v[116:119], v[124:127], v[64:79]
    v_mfma_f32_32x32x16_bf16 v[48:63], v[112:115], v[124:127], v[48:63]
    s_waitcnt lgkmcnt(6)
    v_mfma_f32_32x32x16_bf16 v[16:31], v[80:83], v[88:91], v[16:31]
    v_mfma_f32_32x32x16_bf16 v[32:47], v[84:87], v[88:91], v[32:47]
    v_mfma_f32_32x32x16_bf16 v[64:79], v[84:87], v[92:95], v[64:79]
    s_waitcnt lgkmcnt(0)
    s_barrier
    ds_read_b64_tr_b16 v[120:121], v8 offset:24576
    ds_read_b64_tr_b16 v[122:123], v8 offset:25600
    ds_read_b128 v[112:115], v6 offset:0
    v_mfma_f32_32x32x16_bf16 v[48:63], v[80:83], v[92:95], v[48:63]
    ds_read_b128 v[116:119], v6 offset:4096
    ds_read_b64_tr_b16 v[124:125], v9 offset:24576
    ds_read_b64_tr_b16 v[126:127], v9 offset:25600
    v_mfma_f32_32x32x16_bf16 v[16:31], v[96:99], v[104:107], v[16:31]
    ds_read_b64_tr_b16 v[88:89], v8 offset:28672
    ds_read_b64_tr_b16 v[90:91], v8 offset:29696
    ds_read_b128 v[80:83], v7 offset:0
    v_mfma_f32_32x32x16_bf16 v[32:47], v[100:103], v[104:107], v[32:47]
    ds_read_b128 v[84:87], v7 offset:4096
    ds_read_b64_tr_b16 v[92:93], v9 offset:28672
    ds_read_b64_tr_b16 v[94:95], v9 offset:29696
    v_mfma_f32_32x32x16_bf16 v[64:79], v[100:103], v[108:111], v[64:79]
    v_mfma_f32_32x32x16_bf16 v[48:63], v[96:99], v[108:111], v[48:63]
    s_waitcnt lgkmcnt(6)
    v_mfma_f32_32x32x16_bf16 v[16:31], v[112:115], v[120:123], v[16:31]
    v_mfma_f32_32x32x16_bf16 v[32:47], v[116:119], v[120:123], v[32:47]
    v_mfma_f32_32x32x16_bf16 v[64:79], v[116:119], v[124:127], v[64:79]
    s_waitcnt lgkmcnt(0)
    v_mfma_f32_32x32x16_bf16 v[48:63], v[112:115], v[124:127], v[48:63]
    v_mfma_f32_32x32x16_bf16 v[16:31], v[80:83], v[88:91], v[16:31]
    v_mfma_f32_32x32x16_bf16 v[32:47], v[84:87], v[88:91], v[32:47]
    v_mfma_f32_32x32x16_bf16 v[64:79], v[84:87], v[92:95], v[64:79]
    v_mfma_f32_32x32x16_bf16 v[48:63], v[80:83], v[92:95], v[48:63]
    ds_read_b32 v6, v12 offset:16384
    ds_read_b32 v7, v12 offset:16512
    ds_read_b128 v[80:83], v11 offset:17408
    ds_read_b128 v[96:99], v11 offset:17920
    ds_read_b128 v[84:87], v11 offset:17440
    ds_read_b128 v[100:103], v11 offset:17952
    ds_read_b128 v[88:91], v11 offset:17472
    ds_read_b128 v[104:107], v11 offset:17984
    ds_read_b128 v[92:95], v11 offset:17504
    ds_read_b128 v[108:111], v11 offset:18016
    s_waitcnt lgkmcnt(0)
    s_nop 1
    v_fma_f32 v16, -v80, v6, v16
    v_fma_f32 v17, -v81, v6, v17
    v_fma_f32 v18, -v82, v6, v18
    v_fma_f32 v19, -v83, v6, v19
    v_fma_f32 v20, -v84, v6, v20
    v_fma_f32 v21, -v85, v6, v21
    v_fma_f32 v22, -v86, v6, v22
    v_fma_f32 v23, -v87, v6, v23
    v_mul_f32 v16, v16, v96
    v_mul_f32 v17, v17, v97
    v_mul_f32 v18, v18, v98
    v_mul_f32 v19, v19, v99
    v_mul_f32 v20, v20, v100
    v_mul_f32 v21, v21, v101
    v_mul_f32 v22, v22, v102
    v_mul_f32 v23, v23, v103
    v_cvt_pk_bf16_f32 v112, v16, v17
    v_cvt_pk_bf16_f32 v113, v18, v19
    v_cvt_pk_bf16_f32 v114, v20, v21
    v_cvt_pk_bf16_f32 v115, v22, v23
    buffer_store_dwordx4 v[112:115], v13, s[16:19], s40 offen offset:0 sc1
    v_fma_f32 v24, -v88, v6, v24
    v_fma_f32 v25, -v89, v6, v25
    v_fma_f32 v26, -v90, v6, v26
    v_fma_f32 v27, -v91, v6, v27
    v_fma_f32 v28, -v92, v6, v28
    v_fma_f32 v29, -v93, v6, v29
    v_fma_f32 v30, -v94, v6, v30
    v_fma_f32 v31, -v95, v6, v31
    v_mul_f32 v24, v24, v104
    v_mul_f32 v25, v25, v105
    v_mul_f32 v26, v26, v106
    v_mul_f32 v27, v27, v107
    v_mul_f32 v28, v28, v108
    v_mul_f32 v29, v29, v109
    v_mul_f32 v30, v30, v110
    v_mul_f32 v31, v31, v111
    v_cvt_pk_bf16_f32 v116, v24, v25
    v_cvt_pk_bf16_f32 v117, v26, v27
    v_cvt_pk_bf16_f32 v118, v28, v29
    v_cvt_pk_bf16_f32 v119, v30, v31
    buffer_store_dwordx4 v[116:119], v13, s[16:19], s40 offen offset:640 sc1
    v_fma_f32 v48, -v80, v7, v48
    v_fma_f32 v49, -v81, v7, v49
    v_fma_f32 v50, -v82, v7, v50
    v_fma_f32 v51, -v83, v7, v51
    v_fma_f32 v52, -v84, v7, v52
    v_fma_f32 v53, -v85, v7, v53
    v_fma_f32 v54, -v86, v7, v54
    v_fma_f32 v55, -v87, v7, v55
    v_mul_f32 v48, v48, v96
    v_mul_f32 v49, v49, v97
    v_mul_f32 v50, v50, v98
    v_mul_f32 v51, v51, v99
    v_mul_f32 v52, v52, v100
    v_mul_f32 v53, v53, v101
    v_mul_f32 v54, v54, v102
    v_mul_f32 v55, v55, v103
    v_cvt_pk_bf16_f32 v120, v48, v49
    v_cvt_pk_bf16_f32 v121, v50, v51
    v_cvt_pk_bf16_f32 v122, v52, v53
    v_cvt_pk_bf16_f32 v123, v54, v55
    buffer_store_dwordx4 v[120:123], v14, s[16:19], s40 offen offset:0 sc1
    v_fma_f32 v56, -v88, v7, v56
    v_fma_f32 v57, -v89, v7, v57
    v_fma_f32 v58, -v90, v7, v58
    v_fma_f32 v59, -v91, v7, v59
    v_fma_f32 v60, -v92, v7, v60
    v_fma_f32 v61, -v93, v7, v61
    v_fma_f32 v62, -v94, v7, v62
    v_fma_f32 v63, -v95, v7, v63
    v_mul_f32 v56, v56, v104
    v_mul_f32 v57, v57, v105
    v_mul_f32 v58, v58, v106
    v_mul_f32 v59, v59, v107
    v_mul_f32 v60, v60, v108
    v_mul_f32 v61, v61, v109
    v_mul_f32 v62, v62, v110
    v_mul_f32 v63, v63, v111
    v_cvt_pk_bf16_f32 v124, v56, v57
    v_cvt_pk_bf16_f32 v125, v58, v59
    v_cvt_pk_bf16_f32 v126, v60, v61
    v_cvt_pk_bf16_f32 v127, v62, v63
    buffer_store_dwordx4 v[124:127], v14, s[16:19], s40 offen offset:640 sc1
    ds_read_b128 v[80:83], v11 offset:17536
    ds_read_b128 v[96:99], v11 offset:18048
    ds_read_b128 v[84:87], v11 offset:17568
    ds_read_b128 v[100:103], v11 offset:18080
    ds_read_b128 v[88:91], v11 offset:17600
    ds_read_b128 v[104:107], v11 offset:18112
    ds_read_b128 v[92:95], v11 offset:17632
    ds_read_b128 v[108:111], v11 offset:18144
    s_waitcnt lgkmcnt(0)
    v_fma_f32 v32, -v80, v6, v32
    v_fma_f32 v33, -v81, v6, v33
    v_fma_f32 v34, -v82, v6, v34
    v_fma_f32 v35, -v83, v6, v35
    v_fma_f32 v36, -v84, v6, v36
    v_fma_f32 v37, -v85, v6, v37
    v_fma_f32 v38, -v86, v6, v38
    v_fma_f32 v39, -v87, v6, v39
    v_mul_f32 v32, v32, v96
    v_mul_f32 v33, v33, v97
    v_mul_f32 v34, v34, v98
    v_mul_f32 v35, v35, v99
    v_mul_f32 v36, v36, v100
    v_mul_f32 v37, v37, v101
    v_mul_f32 v38, v38, v102
    v_mul_f32 v39, v39, v103
    v_cvt_pk_bf16_f32 v112, v32, v33
    v_cvt_pk_bf16_f32 v113, v34, v35
    v_cvt_pk_bf16_f32 v114, v36, v37
    v_cvt_pk_bf16_f32 v115, v38, v39
    buffer_store_dwordx4 v[112:115], v13, s[16:19], s40 offen offset:1280 sc1
    v_fma_f32 v40, -v88, v6, v40
    v_fma_f32 v41, -v89, v6, v41
    v_fma_f32 v42, -v90, v6, v42
    v_fma_f32 v43, -v91, v6, v43
    v_fma_f32 v44, -v92, v6, v44
    v_fma_f32 v45, -v93, v6, v45
    v_fma_f32 v46, -v94, v6, v46
    v_fma_f32 v47, -v95, v6, v47
    v_mul_f32 v40, v40, v104
    v_mul_f32 v41, v41, v105
    v_mul_f32 v42, v42, v106
    v_mul_f32 v43, v43, v107
    v_mul_f32 v44, v44, v108
    v_mul_f32 v45, v45, v109
    v_mul_f32 v46, v46, v110
    v_mul_f32 v47, v47, v111
    v_cvt_pk_bf16_f32 v116, v40, v41
    v_cvt_pk_bf16_f32 v117, v42, v43
    v_cvt_pk_bf16_f32 v118, v44, v45
    v_cvt_pk_bf16_f32 v119, v46, v47
    buffer_store_dwordx4 v[116:119], v13, s[16:19], s40 offen offset:1920 sc1
    v_fma_f32 v64, -v80, v7, v64
    v_fma_f32 v65, -v81, v7, v65
    v_fma_f32 v66, -v82, v7, v66
    v_fma_f32 v67, -v83, v7, v67
    v_fma_f32 v68, -v84, v7, v68
    v_fma_f32 v69, -v85, v7, v69
    v_fma_f32 v70, -v86, v7, v70
    v_fma_f32 v71, -v87, v7, v71
    v_mul_f32 v64, v64, v96
    v_mul_f32 v65, v65, v97
    v_mul_f32 v66, v66, v98
    v_mul_f32 v67, v67, v99
    v_mul_f32 v68, v68, v100
    v_mul_f32 v69, v69, v101
    v_mul_f32 v70, v70, v102
    v_mul_f32 v71, v71, v103
    v_cvt_pk_bf16_f32 v120, v64, v65
    v_cvt_pk_bf16_f32 v121, v66, v67
    v_cvt_pk_bf16_f32 v122, v68, v69
    v_cvt_pk_bf16_f32 v123, v70, v71
    buffer_store_dwordx4 v[120:123], v14, s[16:19], s40 offen offset:1280 sc1
    v_fma_f32 v72, -v88, v7, v72
    v_fma_f32 v73, -v89, v7, v73
    v_fma_f32 v74, -v90, v7, v74
    v_fma_f32 v75, -v91, v7, v75
    v_fma_f32 v76, -v92, v7, v76
    v_fma_f32 v77, -v93, v7, v77
    v_fma_f32 v78, -v94, v7, v78
    v_fma_f32 v79, -v95, v7, v79
    v_mul_f32 v72, v72, v104
    v_mul_f32 v73, v73, v105
    v_mul_f32 v74, v74, v106
    v_mul_f32 v75, v75, v107
    v_mul_f32 v76, v76, v108
    v_mul_f32 v77, v77, v109
    v_mul_f32 v78, v78, v110
    v_mul_f32 v79, v79, v111
    v_cvt_pk_bf16_f32 v124, v72, v73
    v_cvt_pk_bf16_f32 v125, v74, v75
    v_cvt_pk_bf16_f32 v126, v76, v77
    v_cvt_pk_bf16_f32 v127, v78, v79
    buffer_store_dwordx4 v[124:127], v14, s[16:19], s40 offen offset:1920 sc1
    s_waitcnt vmcnt(0)
    s_barrier
L_a2:
    s_and_b32 s34, s5, 7
    s_lshr_b32 s35, s5, 3
    s_lshl_b32 s32, s34, 2
    s_lshr_b32 s34, s35, 3
    s_add_u32 s32, s32, s34
    s_and_b32 s33, s35, 7
    v_and_b32 v3, 31, v1
    v_lshrrev_b32 v4, 5, v1
    v_mov_b32 v15, 0
    v_mov_b32 v100, 0
    s_mov_b32 s3, 0
    s_cmp_lg_u32 s4, 4
    s_cbranch_scc1 L_a2p_41_para
    s_cmp_lg_u32 s6, 0
    s_cbranch_scc1 L_gt_43_para
    s_mov_b32 s72, s64
    s_mov_b32 s73, s65
    s_mov_b32 s74, 256
    s_mov_b32 s75, 0x00020000
    v_mov_b32 v98, 0
    s_mov_b32 s79, 100000
L_tg_44_para:
    buffer_load_dwordx2 v[96:97], v98, s[72:75], 0 offen sc1
    s_waitcnt vmcnt(0)
L_tgm_45_para:
    v_readfirstlane_b32 s6, v96
    v_readfirstlane_b32 s7, v97
    s_nop 1
    s_cmp_lg_u32 s6, 0
    s_cbranch_scc1 L_tgd_46_para
    s_sleep 2
    s_sub_u32 s79, s79, 1
    s_cmp_lg_u32 s79, 0
    s_cbranch_scc1 L_tg_44_para
L_tgd_46_para:
L_gt_43_para:
    s_mov_b32 s3, 1
    s_mul_i32 s76, s32, 20
    s_add_u32 s77, s76, 19
    s_lshr_b32 s76, s76, 7
    s_lshr_b32 s77, s77, 7
    s_sub_u32 s77, s77, s76
    s_lshl_b32 s78, s33, 1
    v_bfe_u32 v100, v1, 4, 1
    v_mul_u32_u24 v100, s77, v100
    v_add_u32 v100, s76, v100
    v_lshlrev_b32 v100, 4, v100
    v_add_u32 v96, s78, v1
    v_and_b32 v97, 15, v96
    v_mul_u32_u24 v15, 80, v4
    v_add3_u32 v15, v15, v100, v97
    v_add_u32 v15, 336, v15
    v_lshlrev_b32 v15, 7, v15
    v_add_u32 v96, 12, v96
    v_and_b32 v96, 15, v96
    v_add_u32 v96, v96, v100
    v_add_u32 v96, 256, v96
    v_mov_b32 v100, v15
    s_mov_b64 exec, 0x00300030
    v_lshlrev_b32 v100, 7, v96
    s_mov_b64 exec, -1
L_a2p_41_para:
    v_mul_u32_u24 v5, 320, v4
    v_lshl_add_u32 v5, v3, 4, v5
    v_lshlrev_b32 v6, 12, v4
    v_lshl_add_u32 v6, v3, 3, v6
    v_add_u32 v7, 256, v6
    v_add_u32 v10, 10240, v2
    s_lshl_b32 s37, s33, 3
    s_add_u32 s37, s37, s4
    s_lshl_b32 s38, s37, 5
    v_add_u32 v11, s38, v3
    v_lshlrev_b32 v11, 3, v11
    v_mov_b32 v12, v11
    v_lshl_add_u32 v11, v4, 15, v11
    s_mul_i32 s39, s32, 81920
    s_mov_b32 s68, 0x000fffff
    s_mov_b32 s69, 0x000fffff
    s_mov_b32 s70, -1
    s_mov_b32 s71, 0
    s_add_u32 s8, s66, 2621440
    s_addc_u32 s9, s67, 0
    s_mov_b32 s10, 2621440
    s_mov_b32 s11, 0x00020000
    s_add_u32 s12, s66, 5242880
    s_addc_u32 s13, s67, 0
    s_mov_b32 s14, 2621440
    s_mov_b32 s15, 0x00020000
    s_add_u32 s16, s66, 7864320
    s_addc_u32 s17, s67, 0
    s_mov_b32 s18, 2621440
    s_mov_b32 s19, 0x00020000
    s_add_u32 s20, s66, 10485760
    s_addc_u32 s21, s67, 0
    s_mov_b32 s22, 2621440
    s_mov_b32 s23, 0x00020000
    s_lshr_b32 s40, s4, 1
    s_lshl_b32 s40, s40, 14
    s_and_b32 s44, s4, 1
    s_lshl_b32 s44, s44, 10
    s_add_u32 s40, s40, s44
    s_add_u32 s40, s40, s39
    s_lshl_b32 s45, s4, 8
    s_add_u32 s41, s45, s39
    s_add_u32 s41, s41, 65536
    s_add_u32 s45, s45, 8192
    s_mul_i32 s42, s4, 1280
    s_add_u32 s42, s42, s39
    s_lshl_b32 s44, s4, 10
    s_lshl_b32 s46, s4, 11
    s_add_u32 s46, s46, 10240
    s_mov_b32 s24, s33
    s_mov_b32 s43, 0
    s_lshl_b32 s26, s24, 11
    s_add_u32 s25, s26, s40
    s_add_u32 s26, s26, s41
    s_mul_i32 s27, s24, 10240
    s_add_u32 s27, s27, s42
    s_add_u32 s24, s24, 1
    s_and_b32 s24, s24, 7
    v_cmp_eq_u32 vcc, 20, v3
    v_cmp_eq_u32 s[34:35], 24, v3
    v_mov_b32 v13, 0x3f803f80
    s_or_b64 vcc, vcc, s[34:35]
    s_nop 1
    v_cndmask_b32 v44, 0, v13, vcc
    v_mov_b32 v45, v44
    v_mov_b32 v46, v44
    v_mov_b32 v47, v44
    v_add_u32 v13, s46, v2
    s_not_b64 exec, s[68:69]
    ds_write_b128 v13, v[44:47] offset:0
    ds_write_b128 v13, v[44:47] offset:1024
    ds_write_b128 v13, v[44:47] offset:26624
    ds_write_b128 v13, v[44:47] offset:27648
    ds_write_b128 v13, v[44:47] offset:53248
    ds_write_b128 v13, v[44:47] offset:54272
    s_mov_b64 exec, -1
    v_mov_b32 v64, 0
    v_mov_b32 v65, 0
    v_mov_b32 v66, 0
    v_mov_b32 v67, 0
    v_mov_b32 v68, 0
    v_mov_b32 v69, 0
    v_mov_b32 v70, 0
    v_mov_b32 v71, 0
    v_mov_b32 v72, 0
    v_mov_b32 v73, 0
    v_mov_b32 v74, 0
    v_mov_b32 v75, 0
    v_mov_b32 v76, 0
    v_mov_b32 v77, 0
    v_mov_b32 v78, 0
    v_mov_b32 v79, 0
    v_mov_b32 v20, 0
    v_mov_b32 v21, 0
    s_add_u32 s34, s39, 16384
    s_add_u32 s35, s39, 65536
    s_cmp_lg_u32 s4, 4
    s_cbranch_scc1 L_a2q_42_para
    s_mov_b32 exec_lo, 0x003f003f
    s_mov_b32 exec_hi, 0x000f000f
    s_mov_b32 s79, 100000
L_poll_47_para:
    buffer_load_dwordx2 v[96:97], v100, s[28:31], 0 offen sc1
    s_waitcnt vmcnt(0)
L_pmid_49_para:
    v_cmp_ne_u64 vcc, s[6:7], v[96:97]
    s_nop 1
    s_and_b64 exec, exec, vcc
    s_cbranch_scc0 L_polled_48_para
    s_sleep 1
    s_sub_u32 s79, s79, 1
    s_cmp_lg_u32 s79, 0
    s_cbranch_scc1 L_poll_47_para
L_polled_48_para:
    s_mov_b64 exec, -1
L_a2q_42_para:
    s_barrier
    buffer_load_dwordx2 v[16:17], v11, s[8:11], s39 offen sc1
    buffer_load_dwordx2 v[18:19], v11, s[8:11], s34 offen sc1
    s_mov_b64 exec, s[70:71]
    buffer_load_dwordx2 v[20:21], v12, s[8:11], s35 offen sc1
    s_mov_b64 exec, -1
    s_add_u32 m0, s43, s44
    s_nop 0
    buffer_load_dwordx4 v2, s[12:15], s25 offen sc1 lds
    s_add_u32 m0, s43, s45
    s_mov_b64 exec, 0xffff
    buffer_load_dwordx4 v2, s[12:15], s26 offen sc1 lds
    s_mov_b64 exec, -1
    s_add_u32 m0, s43, s46
    s_mov_b64 exec, s[68:69]
    buffer_load_dwordx4 v5, s[16:19], s27 offen sc1 lds
    s_mov_b64 exec, -1
    s_add_u32 m0, m0, 384
    s_mov_b64 exec, s[68:69]
    buffer_load_dwordx4 v5, s[16:19], s27 offen offset:640 sc1 lds
    s_mov_b64 exec, -1
    s_lshl_b32 s26, s24, 11
    s_add_u32 s25, s26, s40
    s_add_u32 s26, s26, s41
    s_mul_i32 s27, s24, 10240
    s_add_u32 s27, s27, s42
    s_add_u32 s24, s24, 1
    s_and_b32 s24, s24, 7
    s_add_u32 s43, s43, 26624
    s_cmp_eq_u32 s43, 79872
    s_cselect_b32 s43, 0, s43
    s_add_u32 m0, s43, s44
    s_nop 0
    buffer_load_dwordx4 v2, s[12:15], s25 offen sc1 lds
    s_add_u32 m0, s43, s45
    s_mov_b64 exec, 0xffff
    buffer_load_dwordx4 v2, s[12:15], s26 offen sc1 lds
    s_mov_b64 exec, -1
    s_add_u32 m0, s43, s46
    s_mov_b64 exec, s[68:69]
    buffer_load_dwordx4 v5, s[16:19], s27 offen sc1 lds
    s_mov_b64 exec, -1
    s_add_u32 m0, m0, 384
    s_mov_b64 exec, s[68:69]
    buffer_load_dwordx4 v5, s[16:19], s27 offen offset:640 sc1 lds
    s_mov_b64 exec, -1
    s_waitcnt vmcnt(4) lgkmcnt(0)
    s_barrier
    ds_read2st64_b64 v[24:27], v6 offset0:0 offset1:4
    ds_read_b64 v[22:23], v6 offset:8192
    s_waitcnt lgkmcnt(0)
    v_mfma_f32_32x32x16_bf16 v[80:95], v[24:27], v[16:19], 0
    v_mfma_f32_32x32x8_bf16 v[80:95], v[22:23], v[20:21], v[80:95]
    ds_read2st64_b64 v[24:27], v7 offset0:0 offset1:4
    ds_read_b64 v[22:23], v7 offset:8192
    ds_read_b128 v[28:31], v10 offset:0
    ds_read_b128 v[32:35], v10 offset:1024
    s_mov_b32 s47, 0
    s_mov_b32 s76, 26624
    s_mov_b32 s77, 4294914048
    s_nop 7
    v_max3_f32 v44, v80, v81, v82
    v_max3_f32 v45, v83, v84, v85
    v_max3_f32 v44, v44, v86, v87
    v_max3_f32 v45, v45, v88, v89
    v_max3_f32 v44, v44, v90, v91
    v_max3_f32 v45, v45, v92, v93
    v_max3_f32 v44, v44, v94, v95
    v_max_f32 v44, v44, v45
    v_mov_b32 v45, v44
    s_nop 1
    v_permlane32_swap_b32 v44, v45
    s_nop 1
    v_max_f32 v44, v44, v45
    v_sub_f32 v48, 0, v44
    v_sub_f32 v49, 0, v44
    v_sub_f32 v50, 0, v44
    v_sub_f32 v51, 0, v44
    v_sub_f32 v52, 0, v44
    v_sub_f32 v53, 0, v44
    v_sub_f32 v54, 0, v44
    v_sub_f32 v55, 0, v44
    v_sub_f32 v56, 0, v44
    v_sub_f32 v57, 0, v44
    v_sub_f32 v58, 0, v44
    v_sub_f32 v59, 0, v44
    v_sub_f32 v60, 0, v44
    v_sub_f32 v61, 0, v44
    v_sub_f32 v62, 0, v44
    v_sub_f32 v63, 0, v44
    v_sub_f32 v80, v80, v44
    v_sub_f32 v81, v81, v44
    v_sub_f32 v82, v82, v44
    v_sub_f32 v83, v83, v44
    v_sub_f32 v84, v84, v44
    v_sub_f32 v85, v85, v44
    v_sub_f32 v86, v86, v44
    v_sub_f32 v87, v87, v44
    v_sub_f32 v88, v88, v44
    v_sub_f32 v89, v89, v44
    v_sub_f32 v90, v90, v44
    v_sub_f32 v91, v91, v44
    v_sub_f32 v92, v92, v44
    v_sub_f32 v93, v93, v44
    v_sub_f32 v94, v94, v44
    v_sub_f32 v95, v95, v44
    s_cmp_lg_u32 s4, 4
    s_cbranch_scc1 L_a2r_50_para
    buffer_load_dwordx2 v[96:97], v15, s[28:31], 0 offen sc1
L_a2r_50_para:
    s_setprio 0
    s_cmp_ge_u32 s4, 4
    s_cbranch_scc1 L_atY_51_para
    .p2align 6
L_atl_36_para:
    v_exp_f32 v80, v80
    s_setprio 1
    v_exp_f32 v81, v81
    v_exp_f32 v82, v82
    v_exp_f32 v83, v83
    v_cvt_pk_bf16_f32 v36, v80, v81
    v_cvt_pk_bf16_f32 v37, v82, v83
    v_exp_f32 v84, v84
    v_exp_f32 v85, v85
    v_exp_f32 v86, v86
    v_exp_f32 v87, v87
    v_cvt_pk_bf16_f32 v38, v84, v85
    v_cvt_pk_bf16_f32 v39, v86, v87
    v_exp_f32 v88, v88
    v_exp_f32 v89, v89
    v_exp_f32 v90, v90
    v_exp_f32 v91, v91
    v_cvt_pk_bf16_f32 v40, v88, v89
    v_cvt_pk_bf16_f32 v41, v90, v91
    v_exp_f32 v92, v92
    v_exp_f32 v93, v93
    v_exp_f32 v94, v94
    v_exp_f32 v95, v95
    v_cvt_pk_bf16_f32 v42, v92, v93
    v_cvt_pk_bf16_f32 v43, v94, v95
    s_setprio 2
    s_waitcnt lgkmcnt(0)
    v_mfma_f32_32x32x16_bf16 v[80:95], v[24:27], v[16:19], v[48:63]
    ds_read2st64_b64 v[24:27], v6 offset0:1 offset1:5
    s_lshl_b32 s26, s24, 11
    s_add_u32 s25, s26, s40
    s_add_u32 s26, s26, s41
    s_mul_i32 s27, s24, 10240
    v_mfma_f32_32x32x8_bf16 v[80:95], v[22:23], v[20:21], v[80:95]
    ds_read_b64 v[22:23], v6 offset:8704
    v_mfma_f32_32x32x16_bf16 v[64:79], v[28:31], v[36:39], v[64:79]
    ds_read_b128 v[28:31], v10 offset:2048
    s_add_u32 s27, s27, s42
    s_add_u32 s24, s24, 1
    s_and_b32 s24, s24, 7
    v_mfma_f32_32x32x16_bf16 v[64:79], v[32:35], v[40:43], v[64:79]
    ds_read_b128 v[32:35], v10 offset:3072
    s_nop 2
    s_setprio 0
    v_exp_f32 v80, v80
    s_setprio 1
    v_exp_f32 v81, v81
    v_exp_f32 v82, v82
    v_exp_f32 v83, v83
    v_cvt_pk_bf16_f32 v36, v80, v81
    v_cvt_pk_bf16_f32 v37, v82, v83
    v_exp_f32 v84, v84
    v_exp_f32 v85, v85
    v_exp_f32 v86, v86
    v_exp_f32 v87, v87
    v_cvt_pk_bf16_f32 v38, v84, v85
    v_cvt_pk_bf16_f32 v39, v86, v87
    v_exp_f32 v88, v88
    v_exp_f32 v89, v89
    v_exp_f32 v90, v90
    v_exp_f32 v91, v91
    v_cvt_pk_bf16_f32 v40, v88, v89
    v_cvt_pk_bf16_f32 v41, v90, v91
    v_exp_f32 v92, v92
    v_exp_f32 v93, v93
    v_exp_f32 v94, v94
    v_exp_f32 v95, v95
    v_cvt_pk_bf16_f32 v42, v92, v93
    v_cvt_pk_bf16_f32 v43, v94, v95
    s_setprio 2
    s_waitcnt lgkmcnt(0)
    v_mfma_f32_32x32x16_bf16 v[80:95], v[24:27], v[16:19], v[48:63]
    ds_read2st64_b64 v[24:27], v7 offset0:1 offset1:5
    s_add_u32 s43, s43, 26624
    s_cmp_eq_u32 s43, 79872
    s_cselect_b32 s43, 0, s43
    v_mfma_f32_32x32x8_bf16 v[80:95], v[22:23], v[20:21], v[80:95]
    ds_read_b64 v[22:23], v7 offset:8704
    v_mfma_f32_32x32x16_bf16 v[64:79], v[28:31], v[36:39], v[64:79]
    ds_read_b128 v[28:31], v10 offset:4096
    s_cmp_eq_u32 s47, 2
    s_cselect_b32 s36, s77, s76
    s_cmp_eq_u32 s47, 5
    s_cselect_b32 s36, s77, s36
    v_mfma_f32_32x32x16_bf16 v[64:79], v[32:35], v[40:43], v[64:79]
    ds_read_b128 v[32:35], v10 offset:5120
    s_nop 1
    s_setprio 0
    v_exp_f32 v80, v80
    s_setprio 1
    v_exp_f32 v81, v81
    v_exp_f32 v82, v82
    v_exp_f32 v83, v83
    v_cvt_pk_bf16_f32 v36, v80, v81
    v_cvt_pk_bf16_f32 v37, v82, v83
    v_exp_f32 v84, v84
    v_exp_f32 v85, v85
    v_exp_f32 v86, v86
    v_exp_f32 v87, v87
    v_cvt_pk_bf16_f32 v38, v84, v85
    v_cvt_pk_bf16_f32 v39, v86, v87
    v_exp_f32 v88, v88
    v_exp_f32 v89, v89
    v_exp_f32 v90, v90
    v_exp_f32 v91, v91
    v_cvt_pk_bf16_f32 v40, v88, v89
    v_cvt_pk_bf16_f32 v41, v90, v91
    v_exp_f32 v92, v92
    v_exp_f32 v93, v93
    v_exp_f32 v94, v94
    v_exp_f32 v95, v95
    v_cvt_pk_bf16_f32 v42, v92, v93
    v_cvt_pk_bf16_f32 v43, v94, v95
    s_setprio 2
    s_waitcnt lgkmcnt(0)
    v_mfma_f32_32x32x16_bf16 v[80:95], v[24:27], v[16:19], v[48:63]
    ds_read2st64_b64 v[24:27], v6 offset0:2 offset1:6
    v_mfma_f32_32x32x8_bf16 v[80:95], v[22:23], v[20:21], v[80:95]
    ds_read_b64 v[22:23], v6 offset:9216
    v_mfma_f32_32x32x16_bf16 v[64:79], v[28:31], v[36:39], v[64:79]
    ds_read_b128 v[28:31], v10 offset:6144
    s_cmp_ge_u32 s47, 6
    s_cselect_b32 s25, 2621440, s25
    s_cselect_b32 s26, 2621440, s26
    s_cselect_b32 s27, 2621440, s27
    v_mfma_f32_32x32x16_bf16 v[64:79], v[32:35], v[40:43], v[64:79]
    ds_read_b128 v[32:35], v10 offset:7168
    s_nop 1
    s_setprio 0
    v_exp_f32 v80, v80
    s_setprio 1
    v_exp_f32 v81, v81
    v_exp_f32 v82, v82
    v_exp_f32 v83, v83
    v_cvt_pk_bf16_f32 v36, v80, v81
    v_cvt_pk_bf16_f32 v37, v82, v83
    v_exp_f32 v84, v84
    v_exp_f32 v85, v85
    v_exp_f32 v86, v86
    v_exp_f32 v87, v87
    v_cvt_pk_bf16_f32 v38, v84, v85
    v_cvt_pk_bf16_f32 v39, v86, v87
    v_exp_f32 v88, v88
    v_exp_f32 v89, v89
    v_exp_f32 v90, v90
    v_exp_f32 v91, v91
    v_cvt_pk_bf16_f32 v40, v88, v89
    v_cvt_pk_bf16_f32 v41, v90, v91
    v_exp_f32 v92, v92
    v_exp_f32 v93, v93
    v_exp_f32 v94, v94
    v_exp_f32 v95, v95
    v_cvt_pk_bf16_f32 v42, v92, v93
    v_cvt_pk_bf16_f32 v43, v94, v95
    s_setprio 2
    s_waitcnt lgkmcnt(0)
    v_mfma_f32_32x32x16_bf16 v[80:95], v[24:27], v[16:19], v[48:63]
    ds_read2st64_b64 v[24:27], v7 offset0:2 offset1:6
    v_mfma_f32_32x32x8_bf16 v[80:95], v[22:23], v[20:21], v[80:95]
    ds_read_b64 v[22:23], v7 offset:9216
    v_mfma_f32_32x32x16_bf16 v[64:79], v[28:31], v[36:39], v[64:79]
    ds_read_b128 v[28:31], v10 offset:8192
    v_mfma_f32_32x32x16_bf16 v[64:79], v[32:35], v[40:43], v[64:79]
    ds_read_b128 v[32:35], v10 offset:9216
    s_nop 5
    s_setprio 0
    v_exp_f32 v80, v80
    s_setprio 1
    v_exp_f32 v81, v81
    v_exp_f32 v82, v82
    v_exp_f32 v83, v83
    v_cvt_pk_bf16_f32 v36, v80, v81
    v_cvt_pk_bf16_f32 v37, v82, v83
    v_exp_f32 v84, v84
    v_exp_f32 v85, v85
    v_exp_f32 v86, v86
    v_exp_f32 v87, v87
    v_cvt_pk_bf16_f32 v38, v84, v85
    v_cvt_pk_bf16_f32 v39, v86, v87
    v_exp_f32 v88, v88
    v_exp_f32 v89, v89
    v_exp_f32 v90, v90
    v_exp_f32 v91, v91
    v_cvt_pk_bf16_f32 v40, v88, v89
    v_cvt_pk_bf16_f32 v41, v90, v91
    v_exp_f32 v92, v92
    v_exp_f32 v93, v93
    v_exp_f32 v94, v94
    v_exp_f32 v95, v95
    v_cvt_pk_bf16_f32 v42, v92, v93
    v_cvt_pk_bf16_f32 v43, v94, v95
    s_setprio 2
    s_waitcnt lgkmcnt(0)
    v_mfma_f32_32x32x16_bf16 v[80:95], v[24:27], v[16:19], v[48:63]
    ds_read2st64_b64 v[24:27], v6 offset0:3 offset1:7
    v_mfma_f32_32x32x8_bf16 v[80:95], v[22:23], v[20:21], v[80:95]
    ds_read_b64 v[22:23], v6 offset:9728
    v_mfma_f32_32x32x16_bf16 v[64:79], v[28:31], v[36:39], v[64:79]
    ds_read_b128 v[28:31], v10 offset:10240
    v_mfma_f32_32x32x16_bf16 v[64:79], v[32:35], v[40:43], v[64:79]
    ds_read_b128 v[32:35], v10 offset:11264
    s_waitcnt vmcnt(0)
    s_barrier
    s_nop 3
    s_setprio 0
    v_exp_f32 v80, v80
    s_setprio 1
    v_exp_f32 v81, v81
    v_exp_f32 v82, v82
    v_exp_f32 v83, v83
    v_cvt_pk_bf16_f32 v36, v80, v81
    v_cvt_pk_bf16_f32 v37, v82, v83
    v_exp_f32 v84, v84
    v_exp_f32 v85, v85
    v_exp_f32 v86, v86
    v_exp_f32 v87, v87
    v_cvt_pk_bf16_f32 v38, v84, v85
    v_cvt_pk_bf16_f32 v39, v86, v87
    v_exp_f32 v88, v88
    v_exp_f32 v89, v89
    v_exp_f32 v90, v90
    v_exp_f32 v91, v91
    v_cvt_pk_bf16_f32 v40, v88, v89
    v_cvt_pk_bf16_f32 v41, v90, v91
    v_exp_f32 v92, v92
    v_exp_f32 v93, v93
    v_exp_f32 v94, v94
    v_exp_f32 v95, v95
    v_cvt_pk_bf16_f32 v42, v92, v93
    v_cvt_pk_bf16_f32 v43, v94, v95
    s_setprio 2
    s_waitcnt lgkmcnt(0)
    v_mfma_f32_32x32x16_bf16 v[80:95], v[24:27], v[16:19], v[48:63]
    ds_read2st64_b64 v[24:27], v7 offset0:3 offset1:7
    s_add_u32 m0, s43, s44
    s_nop 0
    buffer_load_dwordx4 v2, s[12:15], s25 offen sc1 lds
    v_mfma_f32_32x32x8_bf16 v[80:95], v[22:23], v[20:21], v[80:95]
    ds_read_b64 v[22:23], v7 offset:9728
    v_mfma_f32_32x32x16_bf16 v[64:79], v[28:31], v[36:39], v[64:79]
    ds_read_b128 v[28:31], v10 offset:12288
    s_add_u32 m0, s43, s45
    s_mov_b64 exec, 0xffff
    buffer_load_dwordx4 v2, s[12:15], s26 offen sc1 lds
    s_mov_b64 exec, -1
    v_mfma_f32_32x32x16_bf16 v[64:79], v[32:35], v[40:43], v[64:79]
    ds_read_b128 v[32:35], v10 offset:13312
    v_add_u32 v6, s36, v6
    v_add_u32 v7, s36, v7
    s_setprio 0
    v_exp_f32 v80, v80
    s_setprio 1
    v_exp_f32 v81, v81
    v_exp_f32 v82, v82
    v_exp_f32 v83, v83
    v_cvt_pk_bf16_f32 v36, v80, v81
    v_cvt_pk_bf16_f32 v37, v82, v83
    v_exp_f32 v84, v84
    v_exp_f32 v85, v85
    v_exp_f32 v86, v86
    v_exp_f32 v87, v87
    v_cvt_pk_bf16_f32 v38, v84, v85
    v_cvt_pk_bf16_f32 v39, v86, v87
    v_exp_f32 v88, v88
    v_exp_f32 v89, v89
    v_exp_f32 v90, v90
    v_exp_f32 v91, v91
    v_cvt_pk_bf16_f32 v40, v88, v89
    v_cvt_pk_bf16_f32 v41, v90, v91
    v_exp_f32 v92, v92
    v_exp_f32 v93, v93
    v_exp_f32 v94, v94
    v_exp_f32 v95, v95
    v_cvt_pk_bf16_f32 v42, v92, v93
    v_cvt_pk_bf16_f32 v43, v94, v95
    s_setprio 2
    s_waitcnt lgkmcnt(0)
    v_mfma_f32_32x32x16_bf16 v[80:95], v[24:27], v[16:19], v[48:63]
    ds_read2st64_b64 v[24:27], v6 offset0:0 offset1:4
    s_add_u32 m0, s43, s46
    s_mov_b64 exec, s[68:69]
    buffer_load_dwordx4 v5, s[16:19], s27 offen sc1 lds
    s_mov_b64 exec, -1
    v_mfma_f32_32x32x8_bf16 v[80:95], v[22:23], v[20:21], v[80:95]
    ds_read_b64 v[22:23], v6 offset:8192
    v_mfma_f32_32x32x16_bf16 v[64:79], v[28:31], v[36:39], v[64:79]
    ds_read_b128 v[28:31], v10 offset:14336
    s_add_u32 m0, m0, 384
    s_mov_b64 exec, s[68:69]
    buffer_load_dwordx4 v5, s[16:19], s27 offen offset:640 sc1 lds
    s_mov_b64 exec, -1
    v_mfma_f32_32x32x16_bf16 v[64:79], v[32:35], v[40:43], v[64:79]
    ds_read_b128 v[32:35], v10 offset:15360
    v_add_u32 v10, s36, v10
    s_nop 0
    s_setprio 0
    v_exp_f32 v80, v80
    s_setprio 1
    v_exp_f32 v81, v81
    v_exp_f32 v82, v82
    v_exp_f32 v83, v83
    v_cvt_pk_bf16_f32 v36, v80, v81
    v_cvt_pk_bf16_f32 v37, v82, v83
    v_exp_f32 v84, v84
    v_exp_f32 v85, v85
    v_exp_f32 v86, v86
    v_exp_f32 v87, v87
    v_cvt_pk_bf16_f32 v38, v84, v85
    v_cvt_pk_bf16_f32 v39, v86, v87
    v_exp_f32 v88, v88
    v_exp_f32 v89, v89
    v_exp_f32 v90, v90
    v_exp_f32 v91, v91
    v_cvt_pk_bf16_f32 v40, v88, v89
    v_cvt_pk_bf16_f32 v41, v90, v91
    v_exp_f32 v92, v92
    v_exp_f32 v93, v93
    v_exp_f32 v94, v94
    v_exp_f32 v95, v95
    v_cvt_pk_bf16_f32 v42, v92, v93
    v_cvt_pk_bf16_f32 v43, v94, v95
    s_setprio 2
    s_waitcnt lgkmcnt(0)
    v_mfma_f32_32x32x16_bf16 v[80:95], v[24:27], v[16:19], v[48:63]
    ds_read2st64_b64 v[24:27], v7 offset0:0 offset1:4
    v_mfma_f32_32x32x8_bf16 v[80:95], v[22:23], v[20:21], v[80:95]
    ds_read_b64 v[22:23], v7 offset:8192
    v_mfma_f32_32x32x16_bf16 v[64:79], v[28:31], v[36:39], v[64:79]
    ds_read_b128 v[28:31], v10 offset:0
    s_add_u32 s47, s47, 1
    s_cmp_lt_u32 s47, 8
    v_mfma_f32_32x32x16_bf16 v[64:79], v[32:35], v[40:43], v[64:79]
    ds_read_b128 v[32:35], v10 offset:1024
    s_nop 3
    s_setprio 0
    s_cbranch_scc1 L_atl_36_para
    s_branch L_ato_52_para
    .p2align 6
L_atY_51_para:
    v_exp_f32 v80, v80
    s_setprio 1
    v_exp_f32 v81, v81
    v_exp_f32 v82, v82
    v_exp_f32 v83, v83
    v_cvt_pk_bf16_f32 v36, v80, v81
    v_cvt_pk_bf16_f32 v37, v82, v83
    v_exp_f32 v84, v84
    v_exp_f32 v85, v85
    v_exp_f32 v86, v86
    v_exp_f32 v87, v87
    v_cvt_pk_bf16_f32 v38, v84, v85
    v_cvt_pk_bf16_f32 v39, v86, v87
    v_exp_f32 v88, v88
    v_exp_f32 v89, v89
    v_exp_f32 v90, v90
    v_exp_f32 v91, v91
    v_cvt_pk_bf16_f32 v40, v88, v89
    v_cvt_pk_bf16_f32 v41, v90, v91
    v_exp_f32 v92, v92
    v_exp_f32 v93, v93
    v_exp_f32 v94, v94
    v_exp_f32 v95, v95
    v_cvt_pk_bf16_f32 v42, v92, v93
    v_cvt_pk_bf16_f32 v43, v94, v95
    s_setprio 2
    s_waitcnt lgkmcnt(0)
    v_mfma_f32_32x32x16_bf16 v[80:95], v[24:27], v[16:19], v[48:63]
    ds_read2st64_b64 v[24:27], v6 offset0:1 offset1:5
    s_lshl_b32 s26, s24, 11
    s_add_u32 s25, s26, s40
    s_add_u32 s26, s26, s41
    s_mul_i32 s27, s24, 10240
    v_mfma_f32_32x32x8_bf16 v[80:95], v[22:23], v[20:21], v[80:95]
    ds_read_b64 v[22:23], v6 offset:8704
    v_mfma_f32_32x32x16_bf16 v[64:79], v[28:31], v[36:39], v[64:79]
    ds_read_b128 v[28:31], v10 offset:2048
    s_add_u32 s27, s27, s42
    s_add_u32 s24, s24, 1
    s_and_b32 s24, s24, 7
    v_mfma_f32_32x32x16_bf16 v[64:79], v[32:35], v[40:43], v[64:79]
    ds_read_b128 v[32:35], v10 offset:3072
    s_nop 2
    s_setprio 0
    v_exp_f32 v80, v80
    s_setprio 1
    v_exp_f32 v81, v81
    v_exp_f32 v82, v82
    v_exp_f32 v83, v83
    v_cvt_pk_bf16_f32 v36, v80, v81
    v_cvt_pk_bf16_f32 v37, v82, v83
    v_exp_f32 v84, v84
    v_exp_f32 v85, v85
    v_exp_f32 v86, v86
    v_exp_f32 v87, v87
    v_cvt_pk_bf16_f32 v38, v84, v85
    v_cvt_pk_bf16_f32 v39, v86, v87
    v_exp_f32 v88, v88
    v_exp_f32 v89, v89
    v_exp_f32 v90, v90
    v_exp_f32 v91, v91
    v_cvt_pk_bf16_f32 v40, v88, v89
    v_cvt_pk_bf16_f32 v41, v90, v91
    v_exp_f32 v92, v92
    v_exp_f32 v93, v93
    v_exp_f32 v94, v94
    v_exp_f32 v95, v95
    v_cvt_pk_bf16_f32 v42, v92, v93
    v_cvt_pk_bf16_f32 v43, v94, v95
    s_setprio 2
    s_waitcnt lgkmcnt(0)
    v_mfma_f32_32x32x16_bf16 v[80:95], v[24:27], v[16:19], v[48:63]
    ds_read2st64_b64 v[24:27], v7 offset0:1 offset1:5
    s_add_u32 s43, s43, 26624
    s_cmp_eq_u32 s43, 79872
    s_cselect_b32 s43, 0, s43
    v_mfma_f32_32x32x8_bf16 v[80:95], v[22:23], v[20:21], v[80:95]
    ds_read_b64 v[22:23], v7 offset:8704
    v_mfma_f32_32x32x16_bf16 v[64:79], v[28:31], v[36:39], v[64:79]
    ds_read_b128 v[28:31], v10 offset:4096
    s_cmp_eq_u32 s47, 2
    s_cselect_b32 s36, s77, s76
    s_cmp_eq_u32 s47, 5
    s_cselect_b32 s36, s77, s36
    v_mfma_f32_32x32x16_bf16 v[64:79], v[32:35], v[40:43], v[64:79]
    ds_read_b128 v[32:35], v10 offset:5120
    s_nop 1
    s_setprio 0
    v_exp_f32 v80, v80
    s_setprio 1
    v_exp_f32 v81, v81
    v_exp_f32 v82, v82
    v_exp_f32 v83, v83
    v_cvt_pk_bf16_f32 v36, v80, v81
    v_cvt_pk_bf16_f32 v37, v82, v83
    v_exp_f32 v84, v84
    v_exp_f32 v85, v85
    v_exp_f32 v86, v86
    v_exp_f32 v87, v87
    v_cvt_pk_bf16_f32 v38, v84, v85
    v_cvt_pk_bf16_f32 v39, v86, v87
    v_exp_f32 v88, v88
    v_exp_f32 v89, v89
    v_exp_f32 v90, v90
    v_exp_f32 v91, v91
    v_cvt_pk_bf16_f32 v40, v88, v89
    v_cvt_pk_bf16_f32 v41, v90, v91
    v_exp_f32 v92, v92
    v_exp_f32 v93, v93
    v_exp_f32 v94, v94
    v_exp_f32 v95, v95
    v_cvt_pk_bf16_f32 v42, v92, v93
    v_cvt_pk_bf16_f32 v43, v94, v95
    s_setprio 2
    s_waitcnt lgkmcnt(0)
    v_mfma_f32_32x32x16_bf16 v[80:95], v[24:27], v[16:19], v[48:63]
    ds_read2st64_b64 v[24:27], v6 offset0:2 offset1:6
    v_mfma_f32_32x32x8_bf16 v[80:95], v[22:23], v[20:21], v[80:95]
    ds_read_b64 v[22:23], v6 offset:9216
    v_mfma_f32_32x32x16_bf16 v[64:79], v[28:31], v[36:39], v[64:79]
    ds_read_b128 v[28:31], v10 offset:6144
    s_cmp_ge_u32 s47, 6
    s_cselect_b32 s25, 2621440, s25
    s_cselect_b32 s26, 2621440, s26
    s_cselect_b32 s27, 2621440, s27
    v_mfma_f32_32x32x16_bf16 v[64:79], v[32:35], v[40:43], v[64:79]
    ds_read_b128 v[32:35], v10 offset:7168
    s_nop 1
    s_setprio 0
    v_exp_f32 v80, v80
    s_setprio 1
    v_exp_f32 v81, v81
    v_exp_f32 v82, v82
    v_exp_f32 v83, v83
    v_cvt_pk_bf16_f32 v36, v80, v81
    v_cvt_pk_bf16_f32 v37, v82, v83
    v_exp_f32 v84, v84
    v_exp_f32 v85, v85
    v_exp_f32 v86, v86
    v_exp_f32 v87, v87
    v_cvt_pk_bf16_f32 v38, v84, v85
    v_cvt_pk_bf16_f32 v39, v86, v87
    v_exp_f32 v88, v88
    v_exp_f32 v89, v89
    v_exp_f32 v90, v90
    v_exp_f32 v91, v91
    v_cvt_pk_bf16_f32 v40, v88, v89
    v_cvt_pk_bf16_f32 v41, v90, v91
    v_exp_f32 v92, v92
    v_exp_f32 v93, v93
    v_exp_f32 v94, v94
    v_exp_f32 v95, v95
    v_cvt_pk_bf16_f32 v42, v92, v93
    v_cvt_pk_bf16_f32 v43, v94, v95
    s_setprio 2
    s_waitcnt lgkmcnt(0)
    v_mfma_f32_32x32x16_bf16 v[80:95], v[24:27], v[16:19], v[48:63]
    ds_read2st64_b64 v[24:27], v7 offset0:2 offset1:6
    v_mfma_f32_32x32x8_bf16 v[80:95], v[22:23], v[20:21], v[80:95]
    ds_read_b64 v[22:23], v7 offset:9216
    v_mfma_f32_32x32x16_bf16 v[64:79], v[28:31], v[36:39], v[64:79]
    ds_read_b128 v[28:31], v10 offset:8192
    v_mfma_f32_32x32x16_bf16 v[64:79], v[32:35], v[40:43], v[64:79]
    ds_read_b128 v[32:35], v10 offset:9216
    s_nop 5
    s_setprio 0
    v_exp_f32 v80, v80
    s_setprio 1
    v_exp_f32 v81, v81
    v_exp_f32 v82, v82
    v_exp_f32 v83, v83
    v_cvt_pk_bf16_f32 v36, v80, v81
    v_cvt_pk_bf16_f32 v37, v82, v83
    v_exp_f32 v84, v84
    v_exp_f32 v85, v85
    v_exp_f32 v86, v86
    v_exp_f32 v87, v87
    v_cvt_pk_bf16_f32 v38, v84, v85
    v_cvt_pk_bf16_f32 v39, v86, v87
    v_exp_f32 v88, v88
    v_exp_f32 v89, v89
    v_exp_f32 v90, v90
    v_exp_f32 v91, v91
    v_cvt_pk_bf16_f32 v40, v88, v89
    v_cvt_pk_bf16_f32 v41, v90, v91
    v_exp_f32 v92, v92
    v_exp_f32 v93, v93
    v_exp_f32 v94, v94
    v_exp_f32 v95, v95
    v_cvt_pk_bf16_f32 v42, v92, v93
    v_cvt_pk_bf16_f32 v43, v94, v95
    s_setprio 2
    s_waitcnt vmcnt(0)
    s_cmp_lg_u32 s3, 0
    s_cbranch_scc1 L_atc_34_para
L_atcr_35_para:
    s_barrier
    s_waitcnt lgkmcnt(0)
    v_mfma_f32_32x32x16_bf16 v[80:95], v[24:27], v[16:19], v[48:63]
    ds_read2st64_b64 v[24:27], v6 offset0:3 offset1:7
    v_mfma_f32_32x32x8_bf16 v[80:95], v[22:23], v[20:21], v[80:95]
    ds_read_b64 v[22:23], v6 offset:9728
    v_mfma_f32_32x32x16_bf16 v[64:79], v[28:31], v[36:39], v[64:79]
    ds_read_b128 v[28:31], v10 offset:10240
    v_mfma_f32_32x32x16_bf16 v[64:79], v[32:35], v[40:43], v[64:79]
    ds_read_b128 v[32:35], v10 offset:11264
    s_nop 5
    s_setprio 0
    v_exp_f32 v80, v80
    s_setprio 1
    v_exp_f32 v81, v81
    v_exp_f32 v82, v82
    v_exp_f32 v83, v83
    v_cvt_pk_bf16_f32 v36, v80, v81
    v_cvt_pk_bf16_f32 v37, v82, v83
    v_exp_f32 v84, v84
    v_exp_f32 v85, v85
    v_exp_f32 v86, v86
    v_exp_f32 v87, v87
    v_cvt_pk_bf16_f32 v38, v84, v85
    v_cvt_pk_bf16_f32 v39, v86, v87
    v_exp_f32 v88, v88
    v_exp_f32 v89, v89
    v_exp_f32 v90, v90
    v_exp_f32 v91, v91
    v_cvt_pk_bf16_f32 v40, v88, v89
    v_cvt_pk_bf16_f32 v41, v90, v91
    v_exp_f32 v92, v92
    v_exp_f32 v93, v93
    v_exp_f32 v94, v94
    v_exp_f32 v95, v95
    v_cvt_pk_bf16_f32 v42, v92, v93
    v_cvt_pk_bf16_f32 v43, v94, v95
    s_setprio 2
    s_waitcnt lgkmcnt(0)
    v_mfma_f32_32x32x16_bf16 v[80:95], v[24:27], v[16:19], v[48:63]
    ds_read2st64_b64 v[24:27], v7 offset0:3 offset1:7
    s_add_u32 m0, s43, s44
    s_nop 0
    buffer_load_dwordx4 v2, s[12:15], s25 offen sc1 lds
    v_mfma_f32_32x32x8_bf16 v[80:95], v[22:23], v[20:21], v[80:95]
    ds_read_b64 v[22:23], v7 offset:9728
    v_mfma_f32_32x32x16_bf16 v[64:79], v[28:31], v[36:39], v[64:79]
    ds_read_b128 v[28:31], v10 offset:12288
    s_add_u32 m0, s43, s45
    s_mov_b64 exec, 0xffff
    buffer_load_dwordx4 v2, s[12:15], s26 offen sc1 lds
    s_mov_b64 exec, -1
    v_mfma_f32_32x32x16_bf16 v[64:79], v[32:35], v[40:43], v[64:79]
    ds_read_b128 v[32:35], v10 offset:13312
    v_add_u32 v6, s36, v6
    v_add_u32 v7, s36, v7
    s_setprio 0
    v_exp_f32 v80, v80
    s_setprio 1
    v_exp_f32 v81, v81
    v_exp_f32 v82, v82
    v_exp_f32 v83, v83
    v_cvt_pk_bf16_f32 v36, v80, v81
    v_cvt_pk_bf16_f32 v37, v82, v83
    v_exp_f32 v84, v84
    v_exp_f32 v85, v85
    v_exp_f32 v86, v86
    v_exp_f32 v87, v87
    v_cvt_pk_bf16_f32 v38, v84, v85
    v_cvt_pk_bf16_f32 v39, v86, v87
    v_exp_f32 v88, v88
    v_exp_f32 v89, v89
    v_exp_f32 v90, v90
    v_exp_f32 v91, v91
    v_cvt_pk_bf16_f32 v40, v88, v89
    v_cvt_pk_bf16_f32 v41, v90, v91
    v_exp_f32 v92, v92
    v_exp_f32 v93, v93
    v_exp_f32 v94, v94
    v_exp_f32 v95, v95
    v_cvt_pk_bf16_f32 v42, v92, v93
    v_cvt_pk_bf16_f32 v43, v94, v95
    s_setprio 2
    s_waitcnt lgkmcnt(0)
    v_mfma_f32_32x32x16_bf16 v[80:95], v[24:27], v[16:19], v[48:63]
    ds_read2st64_b64 v[24:27], v6 offset0:0 offset1:4
    s_add_u32 m0, s43, s46
    s_mov_b64 exec, s[68:69]
    buffer_load_dwordx4 v5, s[16:19], s27 offen sc1 lds
    s_mov_b64 exec, -1
    v_mfma_f32_32x32x8_bf16 v[80:95], v[22:23], v[20:21], v[80:95]
    ds_read_b64 v[22:23], v6 offset:8192
    v_mfma_f32_32x32x16_bf16 v[64:79], v[28:31], v[36:39], v[64:79]
    ds_read_b128 v[28:31], v10 offset:14336
    s_add_u32 m0, m0, 384
    s_mov_b64 exec, s[68:69]
    buffer_load_dwordx4 v5, s[16:19], s27 offen offset:640 sc1 lds
    s_mov_b64 exec, -1
    v_mfma_f32_32x32x16_bf16 v[64:79], v[32:35], v[40:43], v[64:79]
    ds_read_b128 v[32:35], v10 offset:15360
    v_add_u32 v10, s36, v10
    s_nop 0
    s_setprio 0
    v_exp_f32 v80, v80
    s_setprio 1
    v_exp_f32 v81, v81
    v_exp_f32 v82, v82
    v_exp_f32 v83, v83
    v_cvt_pk_bf16_f32 v36, v80, v81
    v_cvt_pk_bf16_f32 v37, v82, v83
    v_exp_f32 v84, v84
    v_exp_f32 v85, v85
    v_exp_f32 v86, v86
    v_exp_f32 v87, v87
    v_cvt_pk_bf16_f32 v38, v84, v85
    v_cvt_pk_bf16_f32 v39, v86, v87
    v_exp_f32 v88, v88
    v_exp_f32 v89, v89
    v_exp_f32 v90, v90
    v_exp_f32 v91, v91
    v_cvt_pk_bf16_f32 v40, v88, v89
    v_cvt_pk_bf16_f32 v41, v90, v91
    v_exp_f32 v92, v92
    v_exp_f32 v93, v93
    v_exp_f32 v94, v94
    v_exp_f32 v95, v95
    v_cvt_pk_bf16_f32 v42, v92, v93
    v_cvt_pk_bf16_f32 v43, v94, v95
    s_setprio 2
    s_waitcnt lgkmcnt(0)
    v_mfma_f32_32x32x16_bf16 v[80:95], v[24:27], v[16:19], v[48:63]
    ds_read2st64_b64 v[24:27], v7 offset0:0 offset1:4
    v_mfma_f32_32x32x8_bf16 v[80:95], v[22:23], v[20:21], v[80:95]
    ds_read_b64 v[22:23], v7 offset:8192
    v_mfma_f32_32x32x16_bf16 v[64:79], v[28:31], v[36:39], v[64:79]
    ds_read_b128 v[28:31], v10 offset:0
    s_add_u32 s47, s47, 1
    s_cmp_lt_u32 s47, 8
    v_mfma_f32_32x32x16_bf16 v[64:79], v[32:35], v[40:43], v[64:79]
    ds_read_b128 v[32:35], v10 offset:1024
    s_nop 3
    s_setprio 0
    s_cbranch_scc1 L_atY_51_para
L_ato_52_para:
    s_setprio 3
    s_mul_i32 s72, s37, 40960
    s_lshl_b32 s73, s32, 10
    s_add_u32 s73, s73, s72
    s_lshr_b32 s74, s32, 2
    s_add_u32 s74, s74, 32
    s_lshl_b32 s74, s74, 10
    s_add_u32 s74, s74, s72
    s_and_b32 s75, s32, 1
    s_lshl_b32 s75, s75, 9
    s_add_u32 s74, s74, s75
    s_and_b32 s75, s32, 2
    s_lshl_b32 s75, s75, 2
    s_add_u32 s74, s74, s75
    s_waitcnt lgkmcnt(0)
    s_mov_b64 exec, s[70:71]
    v_mov_b32 v46, v76
    s_not_b64 exec, s[70:71]
    v_mov_b32 v46, v72
    s_mov_b64 exec, -1
    s_mov_b32 s72, 0x5d800000
    v_cmp_ngt_f32 vcc, s72, v46
    s_nop 1
    s_cbranch_vccnz L_ats_38_para
L_atf_37_para:
    v_rcp_f32 v44, v46
    s_nop 0
    v_mul_f32 v64, v64, v44
    v_mul_f32 v65, v65, v44
    v_mul_f32 v66, v66, v44
    v_mul_f32 v67, v67, v44
    v_mul_f32 v68, v68, v44
    v_mul_f32 v69, v69, v44
    v_mul_f32 v70, v70, v44
    v_mul_f32 v71, v71, v44
    v_mul_f32 v72, v72, v44
    v_mul_f32 v73, v73, v44
    v_mul_f32 v74, v74, v44
    v_mul_f32 v75, v75, v44
    v_cvt_pk_bf16_f32 v36, v64, v65
    v_cvt_pk_bf16_f32 v37, v66, v67
    v_cvt_pk_bf16_f32 v38, v68, v69
    v_cvt_pk_bf16_f32 v39, v70, v71
    v_cvt_pk_bf16_f32 v40, v72, v73
    v_cvt_pk_bf16_f32 v41, v74, v75
    buffer_store_dwordx4 v[36:39], v2, s[20:23], s73 offen sc1
    s_mov_b64 exec, s[70:71]
    buffer_store_dwordx2 v[40:41], v2, s[20:23], s74 offen sc1
    s_mov_b64 exec, -1
    s_waitcnt vmcnt(0)
    s_barrier
    s_cmp_lg_u32 s4, 4
    s_cbranch_scc1 L_ate_40_para
    s_lshl_b32 s78, s33, 5
    s_add_u32 s78, s78, s32
    s_add_u32 s78, s78, 1024
    s_lshl_b32 s78, s78, 7
    v_mov_b32 v44, s6
    v_mov_b32 v45, s7
    v_mov_b32 v46, 0
    s_mov_b64 exec, 1
    buffer_store_dwordx2 v[44:45], v46, s[28:31], s78 offen sc1
    s_mov_b64 exec, -1
L_ate_40_para:
    s_endpgm
L_atc_34_para:
    s_mov_b32 s3, 0
    s_mov_b32 s79, 100000
    s_branch L_pmid_55_para
L_poll_53_para:
    buffer_load_dwordx2 v[96:97], v15, s[28:31], 0 offen sc1
    s_waitcnt vmcnt(0)
L_pmid_55_para:
    v_cmp_ne_u64 vcc, s[6:7], v[96:97]
    s_nop 1
    s_and_b64 exec, exec, vcc
    s_cbranch_scc0 L_polled_54_para
    s_sleep 1
    s_sub_u32 s79, s79, 1
    s_cmp_lg_u32 s79, 0
    s_cbranch_scc1 L_poll_53_para
L_polled_54_para:
    s_mov_b64 exec, -1
    s_branch L_atcr_35_para
L_ats_38_para:
    v_lshlrev_b32 v7, 3, v3
    v_lshl_add_u32 v6, v4, 15, v7
    v_mov_b32 v48, 0xff61b1e6
    s_mov_b32 s40, s39
    s_mov_b32 s42, s39
    s_mov_b32 s47, 0
    v_mov_b32 v64, 0
    v_mov_b32 v65, 0
    v_mov_b32 v66, 0
    v_mov_b32 v67, 0
    v_mov_b32 v68, 0
    v_mov_b32 v69, 0
    v_mov_b32 v70, 0
    v_mov_b32 v71, 0
    v_mov_b32 v72, 0
    v_mov_b32 v73, 0
    v_mov_b32 v74, 0
    v_mov_b32 v75, 0
    v_mov_b32 v76, 0
    v_mov_b32 v77, 0
    v_mov_b32 v78, 0
    v_mov_b32 v79, 0
    v_mov_b32 v28, 0x3f803f80
    v_mov_b32 v29, 0x3f803f80
    v_mov_b32 v30, 0x3f803f80
    v_mov_b32 v31, 0x3f803f80
    v_mov_b32 v32, 0x3f803f80
    v_mov_b32 v33, 0x3f803f80
    v_mov_b32 v34, 0x3f803f80
    v_mov_b32 v35, 0x3f803f80
L_atsl_39_para:
    s_add_u32 s41, s40, 16384
    s_add_u32 s43, s40, 65536
    buffer_load_dwordx2 v[24:25], v6, s[12:15], s40 offen sc1
    buffer_load_dwordx2 v[26:27], v6, s[12:15], s41 offen sc1
    buffer_load_dwordx2 v[22:23], v7, s[12:15], s43 offen sc1
    s_mov_b64 exec, s[68:69]
    buffer_load_dwordx4 v[28:31], v5, s[16:19], s42 offen sc1
    buffer_load_dwordx4 v[32:35], v5, s[16:19], s42 offen offset:640 sc1
    s_mov_b64 exec, -1
    s_waitcnt vmcnt(0)
    v_mfma_f32_32x32x16_bf16 v[80:95], v[24:27], v[16:19], 0
    v_mfma_f32_32x32x8_bf16 v[80:95], v[22:23], v[20:21], v[80:95]
    s_nop 15
    s_nop 3
    v_max3_f32 v44, v80, v81, v48
    v_max3_f32 v44, v44, v82, v83
    v_max3_f32 v44, v44, v84, v85
    v_max3_f32 v44, v44, v86, v87
    v_max3_f32 v44, v44, v88, v89
    v_max3_f32 v44, v44, v90, v91
    v_max3_f32 v44, v44, v92, v93
    v_max3_f32 v44, v44, v94, v95
    v_mov_b32 v45, v44
    s_nop 1
    v_permlane32_swap_b32 v44, v45
    s_nop 1
    v_max_f32 v44, v44, v45
    v_sub_f32 v45, v48, v44
    v_exp_f32 v45, v45
    v_mov_b32 v48, v44
    v_mul_f32 v64, v64, v45
    v_mul_f32 v65, v65, v45
    v_mul_f32 v66, v66, v45
    v_mul_f32 v67, v67, v45
    v_mul_f32 v68, v68, v45
    v_mul_f32 v69, v69, v45
    v_mul_f32 v70, v70, v45
    v_mul_f32 v71, v71, v45
    v_mul_f32 v72, v72, v45
    v_mul_f32 v73, v73, v45
    v_mul_f32 v74, v74, v45
    v_mul_f32 v75, v75, v45
    v_mul_f32 v76, v76, v45
    v_mul_f32 v77, v77, v45
    v_mul_f32 v78, v78, v45
    v_mul_f32 v79, v79, v45
    v_sub_f32 v80, v80, v44
    v_sub_f32 v81, v81, v44
    v_sub_f32 v82, v82, v44
    v_sub_f32 v83, v83, v44
    v_sub_f32 v84, v84, v44
    v_sub_f32 v85, v85, v44
    v_sub_f32 v86, v86, v44
    v_sub_f32 v87, v87, v44
    v_sub_f32 v88, v88, v44
    v_sub_f32 v89, v89, v44
    v_sub_f32 v90, v90, v44
    v_sub_f32 v91, v91, v44
    v_sub_f32 v92, v92, v44
    v_sub_f32 v93, v93, v44
    v_sub_f32 v94, v94, v44
    v_sub_f32 v95, v95, v44
    v_exp_f32 v80, v80
    v_exp_f32 v81, v81
    v_exp_f32 v82, v82
    v_exp_f32 v83, v83
    v_exp_f32 v84, v84
    v_exp_f32 v85, v85
    v_exp_f32 v86, v86
    v_exp_f32 v87, v87
    v_exp_f32 v88, v88
    v_exp_f32 v89, v89
    v_exp_f32 v90, v90
    v_exp_f32 v91, v91
    v_exp_f32 v92, v92
    v_exp_f32 v93, v93
    v_exp_f32 v94, v94
    v_exp_f32 v95, v95
    s_nop 0
    v_cvt_pk_bf16_f32 v36, v80, v81
    v_cvt_pk_bf16_f32 v37, v82, v83
    v_cvt_pk_bf16_f32 v38, v84, v85
    v_cvt_pk_bf16_f32 v39, v86, v87
    v_cvt_pk_bf16_f32 v40, v88, v89
    v_cvt_pk_bf16_f32 v41, v90, v91
    v_cvt_pk_bf16_f32 v42, v92, v93
    v_cvt_pk_bf16_f32 v43, v94, v95
    s_nop 1
    v_mfma_f32_32x32x16_bf16 v[64:79], v[28:31], v[36:39], v[64:79]
    v_mfma_f32_32x32x16_bf16 v[64:79], v[32:35], v[40:43], v[64:79]
    s_nop 15
    s_nop 3
    s_add_u32 s40, s40, 256
    s_add_u32 s42, s42, 1280
    s_add_u32 s47, s47, 1
    s_cmp_lt_u32 s47, 64
    s_cbranch_scc1 L_atsl_39_para
    v_mov_b32 v46, v76
    s_branch L_atf_37_para
L_code_end:
.section .rodata,"a"
.p2align 6
.amdhsa_kernel parallel_sum__softmax_full_mha__glu_gated_swiglu__prompt_kernel
  .amdhsa_next_free_vgpr 128
  .amdhsa_next_free_sgpr 80
  .amdhsa_accum_offset 128
  .amdhsa_group_segment_fixed_size 0
  .amdhsa_kernarg_size 80
  .amdhsa_user_sgpr_count 2
  .amdhsa_user_sgpr_kernarg_segment_ptr 1
  .amdhsa_system_sgpr_workgroup_id_x 1
.end_amdhsa_kernel
```
